```python
import torch

def _softmax(x, axis=-1):
    return torch.softmax(x, dim=axis)

def _gelu(x):
    return torch.nn.functional.gelu(x, approximate='tanh')

def _silu(x):
    return torch.nn.functional.silu(x)

def _sigmoid(x):
    return torch.sigmoid(x)

def _layernorm(x, axis=-1, eps=1e-05):
    m = x.mean(dim=axis, keepdim=True)
    v = x.var(dim=axis, keepdim=True, unbiased=False)
    return (x - m) / torch.sqrt(v + eps)

def _scatter_add(tgt, idx, src, axis=0):
    return tgt.clone().index_add_(axis, idx, src)

def _segment_sum(src, seg, n):
    out = torch.zeros((n,) + src.shape[1:], dtype=src.dtype)
    return out.index_add_(0, seg, src)

def _pad(x, pw):
    flat = tuple((v for pair in reversed(pw) for v in pair))
    return torch.nn.functional.pad(x, flat)
kernel_name = 'adaLN_cond__ssm_conv_h3__glu_gated_reglu__prompt'

def setup_inputs():

    _w = lambda a: (lambda t: t.to(torch.bfloat16) if t.is_floating_point() else t)(torch.as_tensor(a))

    def _A_setup():
        B, S, D = (1, 2048, 576)
        ks = 4
        return {'q': _w((lambda *s: torch.randn(*s, dtype=torch.bfloat16) * 0.05)(B, S, D)), 'k': _w((lambda *s: torch.randn(*s, dtype=torch.bfloat16) * 0.8)(B, S, D)), 'v': _w((lambda *s: torch.randn(*s, dtype=torch.bfloat16) * 0.8)(B, S, D)), 'shift_k': _w((lambda *s: torch.randn(*s, dtype=torch.bfloat16) * 0.8)(D, ks) * 0.5), 'ssm_k': _w((lambda *s: torch.randn(*s, dtype=torch.bfloat16) * 0.8)(D, S) * (1.0 / S ** 0.5)), 'ssm_D': _w((lambda *s: torch.randn(*s, dtype=torch.bfloat16) * 0.8)(D))}
    _A_in = _A_setup()

    def _B_setup():
        B, S, D, F = (1, 2048, 576, 4608)
        return {'x': _w((lambda *s: torch.randn(*s, dtype=torch.bfloat16) * 0.05)(B, S, D)), 'W_gate': _w((lambda *s: torch.randn(*s, dtype=torch.bfloat16) * 0.8)(D, F) * (2.0 / D) ** 0.5), 'W_up': _w((lambda *s: torch.randn(*s, dtype=torch.bfloat16) * 0.8)(D, F) * (2.0 / D) ** 0.5), 'W_down': _w((lambda *s: torch.randn(*s, dtype=torch.bfloat16) * 0.8)(F, D) * (1.0 / F) ** 0.5)}
    _B_in = _B_setup()
    return {'A_q': _A_in['q'], 'A_k': _A_in['k'], 'A_v': _A_in['v'], 'A_shift_k': _A_in['shift_k'], 'A_ssm_k': _A_in['ssm_k'], 'A_ssm_D': _A_in['ssm_D'], 'B_x': _B_in['x'], 'B_W_gate': _B_in['W_gate'], 'B_W_up': _B_in['W_up'], 'B_W_down': _B_in['W_down'], 'c': _w((lambda *s: torch.randn(*s, dtype=torch.bfloat16) * 0.2)(1, 576) * 8.0), 'w_mod': _w((lambda *s: torch.randn(*s, dtype=torch.bfloat16) * 0.2)(576, 6 * 576) * 576 ** (-0.5) * 8.0)}

def reference(A_q, A_k, A_v, A_shift_k, A_ssm_k, A_ssm_D, B_x, B_W_gate, B_W_up, B_W_down, c, w_mod):

    def _A_ref(q, k, v, shift_k, ssm_k, ssm_D):
        B, S, D = q.shape
        ks = shift_k.shape[-1]
        k_pad = _pad(k, ((0, 0), (ks - 1, 0), (0, 0)))
        k_shift = torch.zeros_like(k)
        for t in range(ks):
            k_shift = k_shift + k_pad[:, t:t + S, :] * shift_k[:, ks - 1 - t][None, None, :]
        kv = k_shift * v
        L = 2 * S
        kv_pad = _pad(kv, ((0, 0), (0, S), (0, 0)))
        kf_pad = _pad(ssm_k, ((0, 0), (0, S)))
        kv_f = (lambda x, axes=(-2, -1): torch.fft.rfft2(x.float(), dim=axes))(kv_pad[:, None, :, :], axes=(1, 2))
        kf_f = (lambda x, axes=(-2, -1): torch.fft.rfft2(x.float(), dim=axes))(kf_pad[:, None, :], axes=(1, 2))
        kf_f = (lambda x, *d: x.permute(*d))(kf_f, 1, 2, 0)
        y_f = kv_f * kf_f[None, :, :, :]
        y = (lambda x, s, axes=(-2, -1): torch.fft.irfft2(x, s=s, dim=axes).to(torch.bfloat16))(y_f, (1, L), axes=(1, 2))[:, 0, :S, :]
        y = y + kv * ssm_D[None, None, :]
        return q * y

    def _B_ref(x, W_gate, W_up, W_down):
        gate = torch.einsum('bsd,df->bsf', x, W_gate)
        up = torch.einsum('bsd,df->bsf', x, W_up)
        gate = gate * (lambda x, dt: x.to(dt))(gate > 0, gate.dtype)
        h = gate * up
        return torch.einsum('bsf,fd->bsd', h, W_down)
    x = A_q
    mod = (_silu(c) @ w_mod).reshape(c.shape[0], 6, 1, -1)
    sa, ca, ga, sb, cb, gb = (mod[:, 0].clone(), mod[:, 1].clone(), mod[:, 2].clone(), mod[:, 3].clone(), mod[:, 4].clone(), mod[:, 5].clone())
    h = _layernorm(x, axis=-1) * (1 + ca) + sa
    x = x + ga * _A_ref(h, A_k, A_v, A_shift_k, A_ssm_k, A_ssm_D)
    h = _layernorm(x, axis=-1) * (1 + cb) + sb
    x = x + gb * _B_ref(h, B_W_gate, B_W_up, B_W_down)
    return x
```

```asm
; @launch kernel=mega_kernel grid=(256,1,1) block=(256,1,1) lds=147456
.amdgcn_target "amdgcn-amd-amdhsa--gfx950"
.text
.p2align 8
code_begin:
.globl mega_kernel
.p2align 8
.type mega_kernel,@function
mega_kernel:
  s_cmp_ge_u32 s2, 256
  s_cbranch_scc1 mega_kernel_exit1
  s_load_dwordx4 s[4:7], s[0:1], 8
  s_load_dwordx2 s[8:9], s[0:1], 24
  s_load_dwordx4 s[48:51], s[0:1], 80
  s_load_dwordx4 s[52:55], s[0:1], 104
  s_load_dwordx2 s[64:65], s[0:1], 32
  s_load_dwordx2 s[66:67], s[0:1], 0
  s_memrealtime s[56:57]
  s_mov_b32 s40, 0xffff0000
  v_and_b32 v1, 63, v0
  v_lshrrev_b32 v2, 6, v0
  s_nop 0
  v_readfirstlane_b32 s18, v2
  v_and_b32 v4, 7, v0
  v_lshrrev_b32 v5, 3, v0
  s_waitcnt lgkmcnt(0)
  s_mov_b32 s10, s54
  s_mov_b32 s11, s55
  s_add_u32 s12, s10, 13139968
  s_addc_u32 s13, s11, 0
  v_mov_b32 v252, 0
  s_cmp_lg_u32 s18, 0
  s_cbranch_scc1 mega_kernel_nonce_skip5
  s_cmp_lg_u32 s2, 255
  s_cbranch_scc1 mega_kernel_nonce_skip5
  s_or_b32 s56, s56, 1
  s_lshl_b32 s56, s56, 4
  s_mov_b64 exec, 1
  v_mov_b32 v250, s56
  global_store_dword v252, v250, s[52:53] sc1
  s_mov_b64 exec, -1
mega_kernel_nonce_skip5:
  s_cmp_ge_u32 s2, 252
  s_cbranch_scc1 mega_kernel_p0idle3
  s_cmp_ge_u32 s2, 198
  s_cbranch_scc1 mega_kernel_p0mod2
  s_mov_b32 s20, s4
  s_mov_b32 s21, s5
  s_mov_b32 s22, 2359296
  s_mov_b32 s23, 0x00020000
  s_mov_b32 s24, s6
  s_mov_b32 s25, s7
  s_mov_b32 s26, 2359296
  s_mov_b32 s27, 0x00020000
  s_mov_b32 s28, s8
  s_mov_b32 s29, s9
  s_mov_b32 s30, 4608
  s_mov_b32 s31, 0x00020000
  s_mov_b32 s32, s10
  s_mov_b32 s33, s11
  s_mov_b32 s34, 5242880
  s_mov_b32 s35, 0x00020000
  s_mul_i32 s16, s2, 2979
  s_lshr_b32 s16, s16, 16
  s_mul_i32 s17, s16, 22
  s_sub_u32 s17, s2, s17
  v_and_b32 v4, 15, v0
  v_lshrrev_b32 v5, 4, v0
  s_mul_i32 s36, s17, 110592
  v_mul_u32_u24 v3, 6912, v5
  s_lshl_b32 s37, s16, 7
  s_add_u32 s36, s36, s37
  v_lshl_add_u32 v3, v4, 3, v3
  v_add_u32 v3, s36, v3
  v_add_u32 v6, 0xffffee00, v3
  v_add_u32 v7, 0xfffff280, v3
  v_add_u32 v8, 0xfffff700, v3
  v_add_u32 v9, 0xfffffb80, v3
  v_add_u32 v10, 3456, v3
  buffer_load_dwordx2 v[16:17], v6, s[20:23], 0 offen offset:0
  buffer_load_dwordx2 v[18:19], v7, s[20:23], 0 offen offset:0
  buffer_load_dwordx2 v[20:21], v8, s[20:23], 0 offen offset:0
  buffer_load_dwordx2 v[22:23], v9, s[20:23], 0 offen offset:0
  buffer_load_dwordx2 v[24:25], v3, s[20:23], 0 offen offset:0
  buffer_load_dwordx2 v[26:27], v3, s[20:23], 0 offen offset:1152
  buffer_load_dwordx2 v[28:29], v3, s[20:23], 0 offen offset:2304
  buffer_load_dwordx2 v[30:31], v10, s[20:23], 0 offen offset:0
  buffer_load_dwordx2 v[32:33], v10, s[20:23], 0 offen offset:1152
  buffer_load_dwordx2 v[34:35], v10, s[20:23], 0 offen offset:2304
  buffer_load_dwordx2 v[36:37], v9, s[24:27], 0 offen offset:0
  buffer_load_dwordx2 v[38:39], v3, s[24:27], 0 offen offset:0
  buffer_load_dwordx2 v[40:41], v3, s[24:27], 0 offen offset:1152
  buffer_load_dwordx2 v[42:43], v3, s[24:27], 0 offen offset:2304
  buffer_load_dwordx2 v[44:45], v10, s[24:27], 0 offen offset:0
  buffer_load_dwordx2 v[46:47], v10, s[24:27], 0 offen offset:1152
  buffer_load_dwordx2 v[48:49], v10, s[24:27], 0 offen offset:2304
  s_lshl_b32 s36, s16, 9
  v_lshl_add_u32 v11, v4, 5, s36
  buffer_load_dwordx4 v[52:55], v11, s[28:31], 0 offen offset:0
  buffer_load_dwordx4 v[56:59], v11, s[28:31], 0 offen offset:16
  v_sub_u32 v11, 15, v5
  v_mul_u32_u24 v11, 3, v11
  v_add_u32 v15, 0, v11
  v_lshrrev_b32 v12, 2, v15
  v_xor_b32 v12, v12, v4
  v_lshlrev_b32 v12, 4, v12
  v_and_b32 v15, 3, v15
  v_lshl_add_u32 v12, v15, 2, v12
  v_lshl_add_u32 v12, v4, 10, v12
  v_add_u32 v12, 110592, v12
  v_add_u32 v15, 1, v11
  v_lshrrev_b32 v13, 2, v15
  v_xor_b32 v13, v13, v4
  v_lshlrev_b32 v13, 4, v13
  v_and_b32 v15, 3, v15
  v_lshl_add_u32 v13, v15, 2, v13
  v_lshl_add_u32 v13, v4, 10, v13
  v_add_u32 v13, 110592, v13
  v_add_u32 v15, 2, v11
  v_lshrrev_b32 v14, 2, v15
  v_xor_b32 v14, v14, v4
  v_lshlrev_b32 v14, 4, v14
  v_and_b32 v15, 3, v15
  v_lshl_add_u32 v14, v15, 2, v14
  v_lshl_add_u32 v14, v4, 10, v14
  v_add_u32 v14, 110592, v14
  s_waitcnt vmcnt(0)
  global_load_dword v253, v252, s[52:53] sc1
  s_cmp_ge_u32 s2, 144
  s_cbranch_scc1 mega_kernel_noconv_early6
  s_mul_i32 s14, s18, 26112
  s_lshl_b32 s15, s2, 2
  s_add_u32 s15, s15, s18
  v_mov_b32 v244, 0
  v_mov_b32 v245, 0
  v_mov_b32 v246, 0
  v_mov_b32 v247, 0
  v_bfe_u32 v240, v1, 2, 2
  v_and_b32 v241, 3, v1
  v_mul_u32_u24 v240, 4160, v240
  v_lshl_add_u32 v240, v241, 4, v240
  v_add_u32 v240, s14, v240
  ds_write_b128 v240, v[244:247] offset:4096
  v_lshrrev_b32 v240, 5, v1
  v_mul_u32_u24 v240, 4640, v240
  v_and_b32 v241, 31, v1
  v_lshl_add_u32 v240, v241, 4, v240
  v_add_u32 v240, s14, v240
  ds_write_b128 v240, v[244:247] offset:16640
  s_lshl_b32 s36, s15, 12
  v_lshlrev_b32 v240, 4, v1
  s_add_u32 s60, s64, s36
  s_addc_u32 s61, s65, 0
  s_mov_b32 s62, 4096
  s_mov_b32 s63, 0x00020000
  s_waitcnt lgkmcnt(0)
  s_add_u32 m0, s14, 17096
  s_nop 0
  buffer_load_dwordx4 v240, s[60:63], 0 offen offset:0 lds
  buffer_load_dwordx4 v240, s[60:63], 0 offen offset:1024 lds
  buffer_load_dwordx4 v240, s[60:63], 0 offen offset:2048 lds
  buffer_load_dwordx4 v240, s[60:63], 0 offen offset:3072 lds
  s_add_u32 m0, s14, 21728
  s_nop 0
  buffer_load_dwordx4 v240, s[60:63], 0 offen offset:0 lds
  buffer_load_dwordx4 v240, s[60:63], 0 offen offset:1024 lds
  buffer_load_dwordx4 v240, s[60:63], 0 offen offset:2048 lds
  buffer_load_dwordx4 v240, s[60:63], 0 offen offset:3072 lds
mega_kernel_noconv_early6:
  s_mov_b32 s56, s66
  s_mov_b32 s57, s67
  s_mov_b32 s58, 2359296
  s_mov_b32 s59, 0x00020000
  v_mov_b32 v200, 0
  v_mov_b32 v201, 0
  v_mov_b32 v202, 0
  v_mov_b32 v203, 0
  v_mov_b32 v204, 0
  v_mov_b32 v205, 0
  v_mov_b32 v206, 0
  v_mov_b32 v207, 0
  v_mov_b32 v208, 0
  v_mov_b32 v209, 0
  v_mov_b32 v210, 0
  v_mov_b32 v211, 0
  v_mov_b32 v212, 0
  v_mov_b32 v213, 0
  v_mov_b32 v214, 0
  v_mov_b32 v215, 0
  v_mov_b32 v216, 0
  v_mov_b32 v217, 0
  s_lshl_b32 s68, s2, 3
  s_lshl_b32 s37, s18, 1
  s_add_u32 s68, s68, s37
  s_mul_i32 s68, s68, 1152
  v_lshlrev_b32 v236, 1, v1
  buffer_load_short_d16_hi v200, v236, s[56:59], s68 offen offset:0
  buffer_load_short_d16_hi v202, v236, s[56:59], s68 offen offset:128
  buffer_load_short_d16_hi v204, v236, s[56:59], s68 offen offset:256
  buffer_load_short_d16_hi v206, v236, s[56:59], s68 offen offset:384
  buffer_load_short_d16_hi v208, v236, s[56:59], s68 offen offset:512
  buffer_load_short_d16_hi v210, v236, s[56:59], s68 offen offset:640
  buffer_load_short_d16_hi v212, v236, s[56:59], s68 offen offset:768
  buffer_load_short_d16_hi v214, v236, s[56:59], s68 offen offset:896
  buffer_load_short_d16_hi v216, v236, s[56:59], s68 offen offset:1024
  buffer_load_short_d16_hi v201, v236, s[56:59], s68 offen offset:1152
  buffer_load_short_d16_hi v203, v236, s[56:59], s68 offen offset:1280
  buffer_load_short_d16_hi v205, v236, s[56:59], s68 offen offset:1408
  buffer_load_short_d16_hi v207, v236, s[56:59], s68 offen offset:1536
  buffer_load_short_d16_hi v209, v236, s[56:59], s68 offen offset:1664
  buffer_load_short_d16_hi v211, v236, s[56:59], s68 offen offset:1792
  buffer_load_short_d16_hi v213, v236, s[56:59], s68 offen offset:1920
  buffer_load_short_d16_hi v215, v236, s[56:59], s68 offen offset:2048
  buffer_load_short_d16_hi v217, v236, s[56:59], s68 offen offset:2176
  v_lshlrev_b32 v60, 16, v52
  v_and_b32 v64, s40, v52
  v_lshlrev_b32 v68, 16, v53
  v_and_b32 v72, s40, v53
  v_lshlrev_b32 v61, 16, v54
  v_and_b32 v65, s40, v54
  v_lshlrev_b32 v69, 16, v55
  v_and_b32 v73, s40, v55
  v_lshlrev_b32 v62, 16, v56
  v_and_b32 v66, s40, v56
  v_lshlrev_b32 v70, 16, v57
  v_and_b32 v74, s40, v57
  v_lshlrev_b32 v63, 16, v58
  v_and_b32 v67, s40, v58
  v_lshlrev_b32 v71, 16, v59
  v_and_b32 v75, s40, v59
  v_lshlrev_b32 v76, 16, v16
  v_and_b32 v77, s40, v16
  v_lshlrev_b32 v78, 16, v17
  v_and_b32 v79, s40, v17
  v_lshlrev_b32 v80, 16, v18
  v_and_b32 v81, s40, v18
  v_lshlrev_b32 v82, 16, v19
  v_and_b32 v83, s40, v19
  v_lshlrev_b32 v84, 16, v20
  v_and_b32 v85, s40, v20
  v_lshlrev_b32 v86, 16, v21
  v_and_b32 v87, s40, v21
  v_lshlrev_b32 v88, 16, v22
  v_and_b32 v89, s40, v22
  v_lshlrev_b32 v90, 16, v23
  v_and_b32 v91, s40, v23
  v_lshlrev_b32 v92, 16, v24
  v_and_b32 v93, s40, v24
  v_lshlrev_b32 v94, 16, v25
  v_and_b32 v95, s40, v25
  v_lshlrev_b32 v96, 16, v26
  v_and_b32 v97, s40, v26
  v_lshlrev_b32 v98, 16, v27
  v_and_b32 v99, s40, v27
  v_lshlrev_b32 v100, 16, v28
  v_and_b32 v101, s40, v28
  v_lshlrev_b32 v102, 16, v29
  v_and_b32 v103, s40, v29
  v_lshlrev_b32 v104, 16, v30
  v_and_b32 v105, s40, v30
  v_lshlrev_b32 v106, 16, v31
  v_and_b32 v107, s40, v31
  v_lshlrev_b32 v108, 16, v32
  v_and_b32 v109, s40, v32
  v_lshlrev_b32 v110, 16, v33
  v_and_b32 v111, s40, v33
  v_lshlrev_b32 v112, 16, v34
  v_and_b32 v113, s40, v34
  v_lshlrev_b32 v114, 16, v35
  v_and_b32 v115, s40, v35
  v_pk_mul_f32 v[144:145], v[76:77], v[72:73]
  v_pk_mul_f32 v[146:147], v[80:81], v[68:69]
  v_pk_mul_f32 v[148:149], v[84:85], v[64:65]
  v_pk_mul_f32 v[150:151], v[88:89], v[60:61]
  v_lshlrev_b32 v156, 16, v36
  v_and_b32 v157, s40, v36
  v_cvt_pk_bf16_f32 v152, v144, v145
  v_lshlrev_b32 v144, 16, v152
  v_and_b32 v145, s40, v152
  v_cvt_pk_bf16_f32 v153, v146, v147
  v_lshlrev_b32 v146, 16, v153
  v_and_b32 v147, s40, v153
  v_cvt_pk_bf16_f32 v154, v148, v149
  v_lshlrev_b32 v148, 16, v154
  v_and_b32 v149, s40, v154
  v_cvt_pk_bf16_f32 v155, v150, v151
  v_lshlrev_b32 v150, 16, v155
  v_and_b32 v151, s40, v155
  v_pk_add_f32 v[144:145], v[144:145], v[146:147]
  v_cvt_pk_bf16_f32 v152, v144, v145
  v_lshlrev_b32 v144, 16, v152
  v_and_b32 v145, s40, v152
  v_pk_add_f32 v[144:145], v[144:145], v[148:149]
  v_cvt_pk_bf16_f32 v152, v144, v145
  v_lshlrev_b32 v144, 16, v152
  v_and_b32 v145, s40, v152
  v_pk_add_f32 v[144:145], v[144:145], v[150:151]
  v_cvt_pk_bf16_f32 v152, v144, v145
  v_lshlrev_b32 v144, 16, v152
  v_and_b32 v145, s40, v152
  v_pk_mul_f32 v[116:117], v[144:145], v[156:157]
  v_pk_mul_f32 v[144:145], v[78:79], v[74:75]
  v_pk_mul_f32 v[146:147], v[82:83], v[70:71]
  v_pk_mul_f32 v[148:149], v[86:87], v[66:67]
  v_pk_mul_f32 v[150:151], v[90:91], v[62:63]
  v_lshlrev_b32 v156, 16, v37
  v_and_b32 v157, s40, v37
  v_cvt_pk_bf16_f32 v152, v144, v145
  v_lshlrev_b32 v144, 16, v152
  v_and_b32 v145, s40, v152
  v_cvt_pk_bf16_f32 v153, v146, v147
  v_lshlrev_b32 v146, 16, v153
  v_and_b32 v147, s40, v153
  v_cvt_pk_bf16_f32 v154, v148, v149
  v_lshlrev_b32 v148, 16, v154
  v_and_b32 v149, s40, v154
  v_cvt_pk_bf16_f32 v155, v150, v151
  v_lshlrev_b32 v150, 16, v155
  v_and_b32 v151, s40, v155
  v_pk_add_f32 v[144:145], v[144:145], v[146:147]
  v_cvt_pk_bf16_f32 v152, v144, v145
  v_lshlrev_b32 v144, 16, v152
  v_and_b32 v145, s40, v152
  v_pk_add_f32 v[144:145], v[144:145], v[148:149]
  v_cvt_pk_bf16_f32 v152, v144, v145
  v_lshlrev_b32 v144, 16, v152
  v_and_b32 v145, s40, v152
  v_pk_add_f32 v[144:145], v[144:145], v[150:151]
  v_cvt_pk_bf16_f32 v152, v144, v145
  v_lshlrev_b32 v144, 16, v152
  v_and_b32 v145, s40, v152
  v_pk_mul_f32 v[118:119], v[144:145], v[156:157]
  v_pk_mul_f32 v[144:145], v[80:81], v[72:73]
  v_pk_mul_f32 v[146:147], v[84:85], v[68:69]
  v_pk_mul_f32 v[148:149], v[88:89], v[64:65]
  v_pk_mul_f32 v[150:151], v[92:93], v[60:61]
  v_lshlrev_b32 v156, 16, v38
  v_and_b32 v157, s40, v38
  v_cvt_pk_bf16_f32 v152, v144, v145
  v_lshlrev_b32 v144, 16, v152
  v_and_b32 v145, s40, v152
  v_cvt_pk_bf16_f32 v153, v146, v147
  v_lshlrev_b32 v146, 16, v153
  v_and_b32 v147, s40, v153
  v_cvt_pk_bf16_f32 v154, v148, v149
  v_lshlrev_b32 v148, 16, v154
  v_and_b32 v149, s40, v154
  v_cvt_pk_bf16_f32 v155, v150, v151
  v_lshlrev_b32 v150, 16, v155
  v_and_b32 v151, s40, v155
  v_pk_add_f32 v[144:145], v[144:145], v[146:147]
  v_cvt_pk_bf16_f32 v152, v144, v145
  v_lshlrev_b32 v144, 16, v152
  v_and_b32 v145, s40, v152
  v_pk_add_f32 v[144:145], v[144:145], v[148:149]
  v_cvt_pk_bf16_f32 v152, v144, v145
  v_lshlrev_b32 v144, 16, v152
  v_and_b32 v145, s40, v152
  v_pk_add_f32 v[144:145], v[144:145], v[150:151]
  v_cvt_pk_bf16_f32 v152, v144, v145
  v_lshlrev_b32 v144, 16, v152
  v_and_b32 v145, s40, v152
  v_pk_mul_f32 v[120:121], v[144:145], v[156:157]
  v_pk_mul_f32 v[144:145], v[82:83], v[74:75]
  v_pk_mul_f32 v[146:147], v[86:87], v[70:71]
  v_pk_mul_f32 v[148:149], v[90:91], v[66:67]
  v_pk_mul_f32 v[150:151], v[94:95], v[62:63]
  v_lshlrev_b32 v156, 16, v39
  v_and_b32 v157, s40, v39
  v_cvt_pk_bf16_f32 v152, v144, v145
  v_lshlrev_b32 v144, 16, v152
  v_and_b32 v145, s40, v152
  v_cvt_pk_bf16_f32 v153, v146, v147
  v_lshlrev_b32 v146, 16, v153
  v_and_b32 v147, s40, v153
  v_cvt_pk_bf16_f32 v154, v148, v149
  v_lshlrev_b32 v148, 16, v154
  v_and_b32 v149, s40, v154
  v_cvt_pk_bf16_f32 v155, v150, v151
  v_lshlrev_b32 v150, 16, v155
  v_and_b32 v151, s40, v155
  v_pk_add_f32 v[144:145], v[144:145], v[146:147]
  v_cvt_pk_bf16_f32 v152, v144, v145
  v_lshlrev_b32 v144, 16, v152
  v_and_b32 v145, s40, v152
  v_pk_add_f32 v[144:145], v[144:145], v[148:149]
  v_cvt_pk_bf16_f32 v152, v144, v145
  v_lshlrev_b32 v144, 16, v152
  v_and_b32 v145, s40, v152
  v_pk_add_f32 v[144:145], v[144:145], v[150:151]
  v_cvt_pk_bf16_f32 v152, v144, v145
  v_lshlrev_b32 v144, 16, v152
  v_and_b32 v145, s40, v152
  v_pk_mul_f32 v[122:123], v[144:145], v[156:157]
  v_pk_mul_f32 v[144:145], v[84:85], v[72:73]
  v_pk_mul_f32 v[146:147], v[88:89], v[68:69]
  v_pk_mul_f32 v[148:149], v[92:93], v[64:65]
  v_pk_mul_f32 v[150:151], v[96:97], v[60:61]
  v_lshlrev_b32 v156, 16, v40
  v_and_b32 v157, s40, v40
  v_cvt_pk_bf16_f32 v152, v144, v145
  v_lshlrev_b32 v144, 16, v152
  v_and_b32 v145, s40, v152
  v_cvt_pk_bf16_f32 v153, v146, v147
  v_lshlrev_b32 v146, 16, v153
  v_and_b32 v147, s40, v153
  v_cvt_pk_bf16_f32 v154, v148, v149
  v_lshlrev_b32 v148, 16, v154
  v_and_b32 v149, s40, v154
  v_cvt_pk_bf16_f32 v155, v150, v151
  v_lshlrev_b32 v150, 16, v155
  v_and_b32 v151, s40, v155
  v_pk_add_f32 v[144:145], v[144:145], v[146:147]
  v_cvt_pk_bf16_f32 v152, v144, v145
  v_lshlrev_b32 v144, 16, v152
  v_and_b32 v145, s40, v152
  v_pk_add_f32 v[144:145], v[144:145], v[148:149]
  v_cvt_pk_bf16_f32 v152, v144, v145
  v_lshlrev_b32 v144, 16, v152
  v_and_b32 v145, s40, v152
  v_pk_add_f32 v[144:145], v[144:145], v[150:151]
  v_cvt_pk_bf16_f32 v152, v144, v145
  v_lshlrev_b32 v144, 16, v152
  v_and_b32 v145, s40, v152
  v_pk_mul_f32 v[124:125], v[144:145], v[156:157]
  v_pk_mul_f32 v[144:145], v[86:87], v[74:75]
  v_pk_mul_f32 v[146:147], v[90:91], v[70:71]
  v_pk_mul_f32 v[148:149], v[94:95], v[66:67]
  v_pk_mul_f32 v[150:151], v[98:99], v[62:63]
  v_lshlrev_b32 v156, 16, v41
  v_and_b32 v157, s40, v41
  v_cvt_pk_bf16_f32 v152, v144, v145
  v_lshlrev_b32 v144, 16, v152
  v_and_b32 v145, s40, v152
  v_cvt_pk_bf16_f32 v153, v146, v147
  v_lshlrev_b32 v146, 16, v153
  v_and_b32 v147, s40, v153
  v_cvt_pk_bf16_f32 v154, v148, v149
  v_lshlrev_b32 v148, 16, v154
  v_and_b32 v149, s40, v154
  v_cvt_pk_bf16_f32 v155, v150, v151
  v_lshlrev_b32 v150, 16, v155
  v_and_b32 v151, s40, v155
  v_pk_add_f32 v[144:145], v[144:145], v[146:147]
  v_cvt_pk_bf16_f32 v152, v144, v145
  v_lshlrev_b32 v144, 16, v152
  v_and_b32 v145, s40, v152
  v_pk_add_f32 v[144:145], v[144:145], v[148:149]
  v_cvt_pk_bf16_f32 v152, v144, v145
  v_lshlrev_b32 v144, 16, v152
  v_and_b32 v145, s40, v152
  v_pk_add_f32 v[144:145], v[144:145], v[150:151]
  v_cvt_pk_bf16_f32 v152, v144, v145
  v_lshlrev_b32 v144, 16, v152
  v_and_b32 v145, s40, v152
  v_pk_mul_f32 v[126:127], v[144:145], v[156:157]
  v_pk_mul_f32 v[144:145], v[88:89], v[72:73]
  v_pk_mul_f32 v[146:147], v[92:93], v[68:69]
  v_pk_mul_f32 v[148:149], v[96:97], v[64:65]
  v_pk_mul_f32 v[150:151], v[100:101], v[60:61]
  v_lshlrev_b32 v156, 16, v42
  v_and_b32 v157, s40, v42
  v_cvt_pk_bf16_f32 v152, v144, v145
  v_lshlrev_b32 v144, 16, v152
  v_and_b32 v145, s40, v152
  v_cvt_pk_bf16_f32 v153, v146, v147
  v_lshlrev_b32 v146, 16, v153
  v_and_b32 v147, s40, v153
  v_cvt_pk_bf16_f32 v154, v148, v149
  v_lshlrev_b32 v148, 16, v154
  v_and_b32 v149, s40, v154
  v_cvt_pk_bf16_f32 v155, v150, v151
  v_lshlrev_b32 v150, 16, v155
  v_and_b32 v151, s40, v155
  v_pk_add_f32 v[144:145], v[144:145], v[146:147]
  v_cvt_pk_bf16_f32 v152, v144, v145
  v_lshlrev_b32 v144, 16, v152
  v_and_b32 v145, s40, v152
  v_pk_add_f32 v[144:145], v[144:145], v[148:149]
  v_cvt_pk_bf16_f32 v152, v144, v145
  v_lshlrev_b32 v144, 16, v152
  v_and_b32 v145, s40, v152
  v_pk_add_f32 v[144:145], v[144:145], v[150:151]
  v_cvt_pk_bf16_f32 v152, v144, v145
  v_lshlrev_b32 v144, 16, v152
  v_and_b32 v145, s40, v152
  v_pk_mul_f32 v[128:129], v[144:145], v[156:157]
  v_pk_mul_f32 v[144:145], v[90:91], v[74:75]
  v_pk_mul_f32 v[146:147], v[94:95], v[70:71]
  v_pk_mul_f32 v[148:149], v[98:99], v[66:67]
  v_pk_mul_f32 v[150:151], v[102:103], v[62:63]
  v_lshlrev_b32 v156, 16, v43
  v_and_b32 v157, s40, v43
  v_cvt_pk_bf16_f32 v152, v144, v145
  v_lshlrev_b32 v144, 16, v152
  v_and_b32 v145, s40, v152
  v_cvt_pk_bf16_f32 v153, v146, v147
  v_lshlrev_b32 v146, 16, v153
  v_and_b32 v147, s40, v153
  v_cvt_pk_bf16_f32 v154, v148, v149
  v_lshlrev_b32 v148, 16, v154
  v_and_b32 v149, s40, v154
  v_cvt_pk_bf16_f32 v155, v150, v151
  v_lshlrev_b32 v150, 16, v155
  v_and_b32 v151, s40, v155
  v_pk_add_f32 v[144:145], v[144:145], v[146:147]
  v_cvt_pk_bf16_f32 v152, v144, v145
  v_lshlrev_b32 v144, 16, v152
  v_and_b32 v145, s40, v152
  v_pk_add_f32 v[144:145], v[144:145], v[148:149]
  v_cvt_pk_bf16_f32 v152, v144, v145
  v_lshlrev_b32 v144, 16, v152
  v_and_b32 v145, s40, v152
  v_pk_add_f32 v[144:145], v[144:145], v[150:151]
  v_cvt_pk_bf16_f32 v152, v144, v145
  v_lshlrev_b32 v144, 16, v152
  v_and_b32 v145, s40, v152
  v_pk_mul_f32 v[130:131], v[144:145], v[156:157]
  v_pk_mul_f32 v[144:145], v[92:93], v[72:73]
  v_pk_mul_f32 v[146:147], v[96:97], v[68:69]
  v_pk_mul_f32 v[148:149], v[100:101], v[64:65]
  v_pk_mul_f32 v[150:151], v[104:105], v[60:61]
  v_lshlrev_b32 v156, 16, v44
  v_and_b32 v157, s40, v44
  v_cvt_pk_bf16_f32 v152, v144, v145
  v_lshlrev_b32 v144, 16, v152
  v_and_b32 v145, s40, v152
  v_cvt_pk_bf16_f32 v153, v146, v147
  v_lshlrev_b32 v146, 16, v153
  v_and_b32 v147, s40, v153
  v_cvt_pk_bf16_f32 v154, v148, v149
  v_lshlrev_b32 v148, 16, v154
  v_and_b32 v149, s40, v154
  v_cvt_pk_bf16_f32 v155, v150, v151
  v_lshlrev_b32 v150, 16, v155
  v_and_b32 v151, s40, v155
  v_pk_add_f32 v[144:145], v[144:145], v[146:147]
  v_cvt_pk_bf16_f32 v152, v144, v145
  v_lshlrev_b32 v144, 16, v152
  v_and_b32 v145, s40, v152
  v_pk_add_f32 v[144:145], v[144:145], v[148:149]
  v_cvt_pk_bf16_f32 v152, v144, v145
  v_lshlrev_b32 v144, 16, v152
  v_and_b32 v145, s40, v152
  v_pk_add_f32 v[144:145], v[144:145], v[150:151]
  v_cvt_pk_bf16_f32 v152, v144, v145
  v_lshlrev_b32 v144, 16, v152
  v_and_b32 v145, s40, v152
  v_pk_mul_f32 v[132:133], v[144:145], v[156:157]
  v_pk_mul_f32 v[144:145], v[94:95], v[74:75]
  v_pk_mul_f32 v[146:147], v[98:99], v[70:71]
  v_pk_mul_f32 v[148:149], v[102:103], v[66:67]
  v_pk_mul_f32 v[150:151], v[106:107], v[62:63]
  v_lshlrev_b32 v156, 16, v45
  v_and_b32 v157, s40, v45
  v_cvt_pk_bf16_f32 v152, v144, v145
  v_lshlrev_b32 v144, 16, v152
  v_and_b32 v145, s40, v152
  v_cvt_pk_bf16_f32 v153, v146, v147
  v_lshlrev_b32 v146, 16, v153
  v_and_b32 v147, s40, v153
  v_cvt_pk_bf16_f32 v154, v148, v149
  v_lshlrev_b32 v148, 16, v154
  v_and_b32 v149, s40, v154
  v_cvt_pk_bf16_f32 v155, v150, v151
  v_lshlrev_b32 v150, 16, v155
  v_and_b32 v151, s40, v155
  v_pk_add_f32 v[144:145], v[144:145], v[146:147]
  v_cvt_pk_bf16_f32 v152, v144, v145
  v_lshlrev_b32 v144, 16, v152
  v_and_b32 v145, s40, v152
  v_pk_add_f32 v[144:145], v[144:145], v[148:149]
  v_cvt_pk_bf16_f32 v152, v144, v145
  v_lshlrev_b32 v144, 16, v152
  v_and_b32 v145, s40, v152
  v_pk_add_f32 v[144:145], v[144:145], v[150:151]
  v_cvt_pk_bf16_f32 v152, v144, v145
  v_lshlrev_b32 v144, 16, v152
  v_and_b32 v145, s40, v152
  v_pk_mul_f32 v[134:135], v[144:145], v[156:157]
  v_pk_mul_f32 v[144:145], v[96:97], v[72:73]
  v_pk_mul_f32 v[146:147], v[100:101], v[68:69]
  v_pk_mul_f32 v[148:149], v[104:105], v[64:65]
  v_pk_mul_f32 v[150:151], v[108:109], v[60:61]
  v_lshlrev_b32 v156, 16, v46
  v_and_b32 v157, s40, v46
  v_cvt_pk_bf16_f32 v152, v144, v145
  v_lshlrev_b32 v144, 16, v152
  v_and_b32 v145, s40, v152
  v_cvt_pk_bf16_f32 v153, v146, v147
  v_lshlrev_b32 v146, 16, v153
  v_and_b32 v147, s40, v153
  v_cvt_pk_bf16_f32 v154, v148, v149
  v_lshlrev_b32 v148, 16, v154
  v_and_b32 v149, s40, v154
  v_cvt_pk_bf16_f32 v155, v150, v151
  v_lshlrev_b32 v150, 16, v155
  v_and_b32 v151, s40, v155
  v_pk_add_f32 v[144:145], v[144:145], v[146:147]
  v_cvt_pk_bf16_f32 v152, v144, v145
  v_lshlrev_b32 v144, 16, v152
  v_and_b32 v145, s40, v152
  v_pk_add_f32 v[144:145], v[144:145], v[148:149]
  v_cvt_pk_bf16_f32 v152, v144, v145
  v_lshlrev_b32 v144, 16, v152
  v_and_b32 v145, s40, v152
  v_pk_add_f32 v[144:145], v[144:145], v[150:151]
  v_cvt_pk_bf16_f32 v152, v144, v145
  v_lshlrev_b32 v144, 16, v152
  v_and_b32 v145, s40, v152
  v_pk_mul_f32 v[136:137], v[144:145], v[156:157]
  v_pk_mul_f32 v[144:145], v[98:99], v[74:75]
  v_pk_mul_f32 v[146:147], v[102:103], v[70:71]
  v_pk_mul_f32 v[148:149], v[106:107], v[66:67]
  v_pk_mul_f32 v[150:151], v[110:111], v[62:63]
  v_lshlrev_b32 v156, 16, v47
  v_and_b32 v157, s40, v47
  v_cvt_pk_bf16_f32 v152, v144, v145
  v_lshlrev_b32 v144, 16, v152
  v_and_b32 v145, s40, v152
  v_cvt_pk_bf16_f32 v153, v146, v147
  v_lshlrev_b32 v146, 16, v153
  v_and_b32 v147, s40, v153
  v_cvt_pk_bf16_f32 v154, v148, v149
  v_lshlrev_b32 v148, 16, v154
  v_and_b32 v149, s40, v154
  v_cvt_pk_bf16_f32 v155, v150, v151
  v_lshlrev_b32 v150, 16, v155
  v_and_b32 v151, s40, v155
  v_pk_add_f32 v[144:145], v[144:145], v[146:147]
  v_cvt_pk_bf16_f32 v152, v144, v145
  v_lshlrev_b32 v144, 16, v152
  v_and_b32 v145, s40, v152
  v_pk_add_f32 v[144:145], v[144:145], v[148:149]
  v_cvt_pk_bf16_f32 v152, v144, v145
  v_lshlrev_b32 v144, 16, v152
  v_and_b32 v145, s40, v152
  v_pk_add_f32 v[144:145], v[144:145], v[150:151]
  v_cvt_pk_bf16_f32 v152, v144, v145
  v_lshlrev_b32 v144, 16, v152
  v_and_b32 v145, s40, v152
  v_pk_mul_f32 v[138:139], v[144:145], v[156:157]
  v_pk_mul_f32 v[144:145], v[100:101], v[72:73]
  v_pk_mul_f32 v[146:147], v[104:105], v[68:69]
  v_pk_mul_f32 v[148:149], v[108:109], v[64:65]
  v_pk_mul_f32 v[150:151], v[112:113], v[60:61]
  v_lshlrev_b32 v156, 16, v48
  v_and_b32 v157, s40, v48
  v_cvt_pk_bf16_f32 v152, v144, v145
  v_lshlrev_b32 v144, 16, v152
  v_and_b32 v145, s40, v152
  v_cvt_pk_bf16_f32 v153, v146, v147
  v_lshlrev_b32 v146, 16, v153
  v_and_b32 v147, s40, v153
  v_cvt_pk_bf16_f32 v154, v148, v149
  v_lshlrev_b32 v148, 16, v154
  v_and_b32 v149, s40, v154
  v_cvt_pk_bf16_f32 v155, v150, v151
  v_lshlrev_b32 v150, 16, v155
  v_and_b32 v151, s40, v155
  v_pk_add_f32 v[144:145], v[144:145], v[146:147]
  v_cvt_pk_bf16_f32 v152, v144, v145
  v_lshlrev_b32 v144, 16, v152
  v_and_b32 v145, s40, v152
  v_pk_add_f32 v[144:145], v[144:145], v[148:149]
  v_cvt_pk_bf16_f32 v152, v144, v145
  v_lshlrev_b32 v144, 16, v152
  v_and_b32 v145, s40, v152
  v_pk_add_f32 v[144:145], v[144:145], v[150:151]
  v_cvt_pk_bf16_f32 v152, v144, v145
  v_lshlrev_b32 v144, 16, v152
  v_and_b32 v145, s40, v152
  v_pk_mul_f32 v[140:141], v[144:145], v[156:157]
  v_pk_mul_f32 v[144:145], v[102:103], v[74:75]
  v_pk_mul_f32 v[146:147], v[106:107], v[70:71]
  v_pk_mul_f32 v[148:149], v[110:111], v[66:67]
  v_pk_mul_f32 v[150:151], v[114:115], v[62:63]
  v_lshlrev_b32 v156, 16, v49
  v_and_b32 v157, s40, v49
  v_cvt_pk_bf16_f32 v152, v144, v145
  v_lshlrev_b32 v144, 16, v152
  v_and_b32 v145, s40, v152
  v_cvt_pk_bf16_f32 v153, v146, v147
  v_lshlrev_b32 v146, 16, v153
  v_and_b32 v147, s40, v153
  v_cvt_pk_bf16_f32 v154, v148, v149
  v_lshlrev_b32 v148, 16, v154
  v_and_b32 v149, s40, v154
  v_cvt_pk_bf16_f32 v155, v150, v151
  v_lshlrev_b32 v150, 16, v155
  v_and_b32 v151, s40, v155
  v_pk_add_f32 v[144:145], v[144:145], v[146:147]
  v_cvt_pk_bf16_f32 v152, v144, v145
  v_lshlrev_b32 v144, 16, v152
  v_and_b32 v145, s40, v152
  v_pk_add_f32 v[144:145], v[144:145], v[148:149]
  v_cvt_pk_bf16_f32 v152, v144, v145
  v_lshlrev_b32 v144, 16, v152
  v_and_b32 v145, s40, v152
  v_pk_add_f32 v[144:145], v[144:145], v[150:151]
  v_cvt_pk_bf16_f32 v152, v144, v145
  v_lshlrev_b32 v144, 16, v152
  v_and_b32 v145, s40, v152
  v_pk_mul_f32 v[142:143], v[144:145], v[156:157]
  v_cvt_pk_bf16_f32 v144, v140, v136
  v_cvt_pk_bf16_f32 v145, v136, v132
  ds_write_b32 v12, v144 offset:0
  ds_write_b32 v12, v145 offset:16384
  v_cvt_pk_bf16_f32 v146, v132, v128
  v_cvt_pk_bf16_f32 v147, v128, v124
  ds_write_b32 v13, v146 offset:0
  ds_write_b32 v13, v147 offset:16384
  v_cvt_pk_bf16_f32 v148, v124, v120
  v_cvt_pk_bf16_f32 v149, v120, v116
  ds_write_b32 v14, v148 offset:0
  ds_write_b32 v14, v149 offset:16384
  v_cvt_pk_bf16_f32 v150, v141, v137
  v_cvt_pk_bf16_f32 v151, v137, v133
  ds_write_b32 v12, v150 offset:256
  ds_write_b32 v12, v151 offset:16640
  v_cvt_pk_bf16_f32 v144, v133, v129
  v_cvt_pk_bf16_f32 v145, v129, v125
  ds_write_b32 v13, v144 offset:256
  ds_write_b32 v13, v145 offset:16640
  v_cvt_pk_bf16_f32 v146, v125, v121
  v_cvt_pk_bf16_f32 v147, v121, v117
  ds_write_b32 v14, v146 offset:256
  ds_write_b32 v14, v147 offset:16640
  v_cvt_pk_bf16_f32 v148, v142, v138
  v_cvt_pk_bf16_f32 v149, v138, v134
  ds_write_b32 v12, v148 offset:512
  ds_write_b32 v12, v149 offset:16896
  v_cvt_pk_bf16_f32 v150, v134, v130
  v_cvt_pk_bf16_f32 v151, v130, v126
  ds_write_b32 v13, v150 offset:512
  ds_write_b32 v13, v151 offset:16896
  v_cvt_pk_bf16_f32 v144, v126, v122
  v_cvt_pk_bf16_f32 v145, v122, v118
  ds_write_b32 v14, v144 offset:512
  ds_write_b32 v14, v145 offset:16896
  v_cvt_pk_bf16_f32 v146, v143, v139
  v_cvt_pk_bf16_f32 v147, v139, v135
  ds_write_b32 v12, v146 offset:768
  ds_write_b32 v12, v147 offset:17152
  v_cvt_pk_bf16_f32 v148, v135, v131
  v_cvt_pk_bf16_f32 v149, v131, v127
  ds_write_b32 v13, v148 offset:768
  ds_write_b32 v13, v149 offset:17152
  v_cvt_pk_bf16_f32 v150, v127, v123
  v_cvt_pk_bf16_f32 v151, v123, v119
  ds_write_b32 v14, v150 offset:768
  ds_write_b32 v14, v151 offset:17152
  s_cmp_lg_u32 s18, 0
  s_cbranch_scc1 mega_kernel_nres7
  s_mov_b32 s36, 0
  s_waitcnt vmcnt(18)
mega_kernel_npoll8:
  s_add_u32 s36, s36, 1
  v_readfirstlane_b32 s3, v253
  s_cmp_ge_u32 s36, 1048576
  s_cbranch_scc1 mega_kernel_ndone9
  s_cmp_lg_u32 s3, 0
  s_cbranch_scc1 mega_kernel_ndone9
  global_load_dword v253, v252, s[52:53] sc1
  s_waitcnt vmcnt(0)
  s_branch mega_kernel_npoll8
mega_kernel_ndone9:
  v_mov_b32 v250, s3
  v_mov_b32 v251, 147440
  ds_write_b32 v251, v250
mega_kernel_nres7:
  v_lshrrev_b32 v8, 2, v5
  v_xor_b32 v8, v4, v8
  v_lshlrev_b32 v8, 4, v8
  v_lshl_add_u32 v8, v5, 8, v8
  v_add_u32 v8, 110592, v8
  s_mul_i32 s36, s16, 278528
  s_mul_i32 s37, s17, 192
  s_sub_u32 s36, s36, s37
  s_add_u32 s36, s36, 3904
  v_mul_u32_u24 v9, 4352, v5
  v_lshl_add_u32 v9, v4, 4, v9
  v_add_u32 v9, s36, v9
  v_cmp_gt_u32 vcc, 12, v4
  s_waitcnt lgkmcnt(0)
  s_barrier
  v_xor_b32 v10, 0, v8
  v_xor_b32 v11, 64, v8
  v_xor_b32 v12, 128, v8
  v_xor_b32 v13, 192, v8
  v_mov_b32 v250, 147440
  ds_read_b32 v250, v250
  ds_read_b128 v[16:19], v10 offset:0
  ds_read_b128 v[20:23], v11 offset:4096
  ds_read_b128 v[24:27], v12 offset:8192
  ds_read_b128 v[28:31], v13 offset:12288
  ds_read_b128 v[32:35], v10 offset:16384
  ds_read_b128 v[36:39], v11 offset:20480
  ds_read_b128 v[40:43], v12 offset:24576
  ds_read_b128 v[44:47], v13 offset:28672
  s_mov_b64 exec, vcc
  v_add_u32 v15, 0, v9
  s_waitcnt lgkmcnt(7)
  buffer_store_dwordx4 v[16:19], v15, s[32:35], 0 offen sc1
  v_add_u32 v15, 69632, v9
  s_waitcnt lgkmcnt(6)
  buffer_store_dwordx4 v[20:23], v15, s[32:35], 0 offen sc1
  v_add_u32 v15, 139264, v9
  s_waitcnt lgkmcnt(5)
  buffer_store_dwordx4 v[24:27], v15, s[32:35], 0 offen sc1
  v_add_u32 v15, 208896, v9
  s_waitcnt lgkmcnt(4)
  buffer_store_dwordx4 v[28:31], v15, s[32:35], 0 offen sc1
  v_add_u32 v15, 2621440, v9
  s_waitcnt lgkmcnt(3)
  buffer_store_dwordx4 v[32:35], v15, s[32:35], 0 offen sc1
  v_add_u32 v15, 2691072, v9
  s_waitcnt lgkmcnt(2)
  buffer_store_dwordx4 v[36:39], v15, s[32:35], 0 offen sc1
  v_add_u32 v15, 2760704, v9
  s_waitcnt lgkmcnt(1)
  buffer_store_dwordx4 v[40:43], v15, s[32:35], 0 offen sc1
  v_add_u32 v15, 2830336, v9
  s_waitcnt lgkmcnt(0)
  buffer_store_dwordx4 v[44:47], v15, s[32:35], 0 offen sc1
  s_mov_b64 exec, -1
  v_readfirstlane_b32 s3, v250
  s_branch mega_kernel_p0done4
mega_kernel_p0mod2:
  s_sub_u32 s16, s2, 198
  s_cmp_lt_u32 s2, 198
  s_cbranch_scc1 mega_kernel_noct10
  s_cmp_ge_u32 s2, 214
  s_cbranch_scc1 mega_kernel_noct10
  s_getpc_b64 s[36:37]
  s_add_u32 s36, s36, code_begin@rel32@lo+4
  s_addc_u32 s37, s37, code_begin@rel32@hi+12
  v_lshlrev_b32 v2, 7, v0
  v_min_u32 v3, code_end-code_begin-4, v2
  v_add_u32 v2, 32768, v2
  v_min_u32 v2, code_end-code_begin-4, v2
  global_load_dword v254, v3, s[36:37]
  global_load_dword v255, v2, s[36:37]
mega_kernel_noct10:
  s_mov_b32 s56, s66
  s_mov_b32 s57, s67
  s_mov_b32 s58, 2359296
  s_mov_b32 s59, 0x00020000
  v_mov_b32 v200, 0
  v_mov_b32 v201, 0
  v_mov_b32 v202, 0
  v_mov_b32 v203, 0
  v_mov_b32 v204, 0
  v_mov_b32 v205, 0
  v_mov_b32 v206, 0
  v_mov_b32 v207, 0
  v_mov_b32 v208, 0
  v_mov_b32 v209, 0
  v_mov_b32 v210, 0
  v_mov_b32 v211, 0
  v_mov_b32 v212, 0
  v_mov_b32 v213, 0
  v_mov_b32 v214, 0
  v_mov_b32 v215, 0
  v_mov_b32 v216, 0
  v_mov_b32 v217, 0
  s_lshl_b32 s68, s2, 3
  s_lshl_b32 s37, s18, 1
  s_add_u32 s68, s68, s37
  s_mul_i32 s68, s68, 1152
  v_lshlrev_b32 v236, 1, v1
  buffer_load_short_d16_hi v200, v236, s[56:59], s68 offen offset:0
  buffer_load_short_d16_hi v202, v236, s[56:59], s68 offen offset:128
  buffer_load_short_d16_hi v204, v236, s[56:59], s68 offen offset:256
  buffer_load_short_d16_hi v206, v236, s[56:59], s68 offen offset:384
  buffer_load_short_d16_hi v208, v236, s[56:59], s68 offen offset:512
  buffer_load_short_d16_hi v210, v236, s[56:59], s68 offen offset:640
  buffer_load_short_d16_hi v212, v236, s[56:59], s68 offen offset:768
  buffer_load_short_d16_hi v214, v236, s[56:59], s68 offen offset:896
  buffer_load_short_d16_hi v216, v236, s[56:59], s68 offen offset:1024
  buffer_load_short_d16_hi v201, v236, s[56:59], s68 offen offset:1152
  buffer_load_short_d16_hi v203, v236, s[56:59], s68 offen offset:1280
  buffer_load_short_d16_hi v205, v236, s[56:59], s68 offen offset:1408
  buffer_load_short_d16_hi v207, v236, s[56:59], s68 offen offset:1536
  buffer_load_short_d16_hi v209, v236, s[56:59], s68 offen offset:1664
  buffer_load_short_d16_hi v211, v236, s[56:59], s68 offen offset:1792
  buffer_load_short_d16_hi v213, v236, s[56:59], s68 offen offset:1920
  buffer_load_short_d16_hi v215, v236, s[56:59], s68 offen offset:2048
  buffer_load_short_d16_hi v217, v236, s[56:59], s68 offen offset:2176
  s_waitcnt vmcnt(0)
  s_mov_b32 s20, s48
  s_mov_b32 s21, s49
  s_mov_b32 s22, 1152
  s_mov_b32 s23, 0x00020000
  s_mov_b32 s24, s50
  s_mov_b32 s25, s51
  s_mov_b32 s26, 3981312
  s_mov_b32 s27, 0x00020000
  s_add_u32 s28, s10, 13107200
  s_addc_u32 s29, s11, 0
  s_mov_b32 s30, 32768
  s_mov_b32 s31, 0x00020000
  s_movk_i32 s37, 6912
  v_mul_lo_u32 v3, v5, s37
  s_lshl_b32 s36, s16, 7
  v_lshl_add_u32 v6, v4, 4, s36
  v_add_u32 v3, v3, v6
  v_lshlrev_b32 v6, 1, v5
  v_mov_b32 v8, 0
  v_mov_b32 v9, 0
  v_mov_b32 v10, 0
  v_mov_b32 v11, 0
  v_mov_b32 v12, 0
  v_mov_b32 v13, 0
  v_mov_b32 v14, 0
  v_mov_b32 v15, 0
  v_mov_b32 v16, 0
  v_mov_b32 v17, 0
  v_mov_b32 v18, 0
  v_mov_b32 v19, 0
  v_mov_b32 v20, 0
  v_mov_b32 v21, 0
  v_mov_b32 v22, 0
  v_mov_b32 v23, 0
  v_mov_b32 v24, 0
  v_mov_b32 v25, 0
  buffer_load_short_d16_hi v8, v6, s[20:23], 0 offen offset:0
  buffer_load_short_d16_hi v9, v6, s[20:23], 0 offen offset:64
  buffer_load_short_d16_hi v10, v6, s[20:23], 0 offen offset:128
  buffer_load_short_d16_hi v11, v6, s[20:23], 0 offen offset:192
  buffer_load_short_d16_hi v12, v6, s[20:23], 0 offen offset:256
  buffer_load_short_d16_hi v13, v6, s[20:23], 0 offen offset:320
  buffer_load_short_d16_hi v14, v6, s[20:23], 0 offen offset:384
  buffer_load_short_d16_hi v15, v6, s[20:23], 0 offen offset:448
  buffer_load_short_d16_hi v16, v6, s[20:23], 0 offen offset:512
  buffer_load_short_d16_hi v17, v6, s[20:23], 0 offen offset:576
  buffer_load_short_d16_hi v18, v6, s[20:23], 0 offen offset:640
  buffer_load_short_d16_hi v19, v6, s[20:23], 0 offen offset:704
  buffer_load_short_d16_hi v20, v6, s[20:23], 0 offen offset:768
  buffer_load_short_d16_hi v21, v6, s[20:23], 0 offen offset:832
  buffer_load_short_d16_hi v22, v6, s[20:23], 0 offen offset:896
  buffer_load_short_d16_hi v23, v6, s[20:23], 0 offen offset:960
  buffer_load_short_d16_hi v24, v6, s[20:23], 0 offen offset:1024
  buffer_load_short_d16_hi v25, v6, s[20:23], 0 offen offset:1088
  s_mov_b32 s36, 0
  buffer_load_dwordx4 v[32:35], v3, s[24:27], s36 offen
  s_add_u32 s36, s36, 221184
  buffer_load_dwordx4 v[36:39], v3, s[24:27], s36 offen
  s_add_u32 s36, s36, 221184
  buffer_load_dwordx4 v[40:43], v3, s[24:27], s36 offen
  s_add_u32 s36, s36, 221184
  buffer_load_dwordx4 v[44:47], v3, s[24:27], s36 offen
  s_add_u32 s36, s36, 221184
  buffer_load_dwordx4 v[48:51], v3, s[24:27], s36 offen
  s_add_u32 s36, s36, 221184
  buffer_load_dwordx4 v[52:55], v3, s[24:27], s36 offen
  s_add_u32 s36, s36, 221184
  buffer_load_dwordx4 v[56:59], v3, s[24:27], s36 offen
  s_add_u32 s36, s36, 221184
  buffer_load_dwordx4 v[60:63], v3, s[24:27], s36 offen
  s_add_u32 s36, s36, 221184
  buffer_load_dwordx4 v[64:67], v3, s[24:27], s36 offen
  s_add_u32 s36, s36, 221184
  buffer_load_dwordx4 v[68:71], v3, s[24:27], s36 offen
  s_add_u32 s36, s36, 221184
  buffer_load_dwordx4 v[72:75], v3, s[24:27], s36 offen
  s_add_u32 s36, s36, 221184
  buffer_load_dwordx4 v[76:79], v3, s[24:27], s36 offen
  s_add_u32 s36, s36, 221184
  buffer_load_dwordx4 v[80:83], v3, s[24:27], s36 offen
  s_add_u32 s36, s36, 221184
  buffer_load_dwordx4 v[84:87], v3, s[24:27], s36 offen
  s_add_u32 s36, s36, 221184
  buffer_load_dwordx4 v[88:91], v3, s[24:27], s36 offen
  s_add_u32 s36, s36, 221184
  buffer_load_dwordx4 v[92:95], v3, s[24:27], s36 offen
  s_add_u32 s36, s36, 221184
  buffer_load_dwordx4 v[96:99], v3, s[24:27], s36 offen
  s_add_u32 s36, s36, 221184
  buffer_load_dwordx4 v[100:103], v3, s[24:27], s36 offen
  s_mov_b32 s37, 0xbfb8aa3b
  s_waitcnt vmcnt(18)
  v_mul_f32 v104, s37, v8
  v_mul_f32 v105, s37, v9
  v_mul_f32 v106, s37, v10
  v_mul_f32 v107, s37, v11
  v_mul_f32 v108, s37, v12
  v_mul_f32 v109, s37, v13
  v_mul_f32 v110, s37, v14
  v_mul_f32 v111, s37, v15
  v_mul_f32 v112, s37, v16
  v_mul_f32 v113, s37, v17
  v_mul_f32 v114, s37, v18
  v_mul_f32 v115, s37, v19
  v_mul_f32 v116, s37, v20
  v_mul_f32 v117, s37, v21
  v_mul_f32 v118, s37, v22
  v_mul_f32 v119, s37, v23
  v_mul_f32 v120, s37, v24
  v_mul_f32 v121, s37, v25
  v_exp_f32 v104, v104
  v_exp_f32 v105, v105
  v_exp_f32 v106, v106
  v_exp_f32 v107, v107
  v_exp_f32 v108, v108
  v_exp_f32 v109, v109
  v_exp_f32 v110, v110
  v_exp_f32 v111, v111
  v_exp_f32 v112, v112
  v_exp_f32 v113, v113
  v_exp_f32 v114, v114
  v_exp_f32 v115, v115
  v_exp_f32 v116, v116
  v_exp_f32 v117, v117
  v_exp_f32 v118, v118
  v_exp_f32 v119, v119
  v_exp_f32 v120, v120
  v_exp_f32 v121, v121
  v_add_f32 v104, 1.0, v104
  v_add_f32 v105, 1.0, v105
  v_add_f32 v106, 1.0, v106
  v_add_f32 v107, 1.0, v107
  v_add_f32 v108, 1.0, v108
  v_add_f32 v109, 1.0, v109
  v_add_f32 v110, 1.0, v110
  v_add_f32 v111, 1.0, v111
  v_add_f32 v112, 1.0, v112
  v_add_f32 v113, 1.0, v113
  v_add_f32 v114, 1.0, v114
  v_add_f32 v115, 1.0, v115
  v_add_f32 v116, 1.0, v116
  v_add_f32 v117, 1.0, v117
  v_add_f32 v118, 1.0, v118
  v_add_f32 v119, 1.0, v119
  v_add_f32 v120, 1.0, v120
  v_add_f32 v121, 1.0, v121
  v_rcp_f32 v104, v104
  v_rcp_f32 v105, v105
  v_rcp_f32 v106, v106
  v_rcp_f32 v107, v107
  v_rcp_f32 v108, v108
  v_rcp_f32 v109, v109
  v_rcp_f32 v110, v110
  v_rcp_f32 v111, v111
  v_rcp_f32 v112, v112
  v_rcp_f32 v113, v113
  v_rcp_f32 v114, v114
  v_rcp_f32 v115, v115
  v_rcp_f32 v116, v116
  v_rcp_f32 v117, v117
  v_rcp_f32 v118, v118
  v_rcp_f32 v119, v119
  v_rcp_f32 v120, v120
  v_rcp_f32 v121, v121
  s_nop 0
  v_mul_f32 v8, v8, v104
  v_mul_f32 v9, v9, v105
  v_mul_f32 v10, v10, v106
  v_mul_f32 v11, v11, v107
  v_mul_f32 v12, v12, v108
  v_mul_f32 v13, v13, v109
  v_mul_f32 v14, v14, v110
  v_mul_f32 v15, v15, v111
  v_mul_f32 v16, v16, v112
  v_mul_f32 v17, v17, v113
  v_mul_f32 v18, v18, v114
  v_mul_f32 v19, v19, v115
  v_mul_f32 v20, v20, v116
  v_mul_f32 v21, v21, v117
  v_mul_f32 v22, v22, v118
  v_mul_f32 v23, v23, v119
  v_mul_f32 v24, v24, v120
  v_mul_f32 v25, v25, v121
  v_cvt_pk_bf16_f32 v104, v8, v9
  v_lshlrev_b32 v8, 16, v104
  v_and_b32 v9, s40, v104
  v_cvt_pk_bf16_f32 v106, v10, v11
  v_lshlrev_b32 v10, 16, v106
  v_and_b32 v11, s40, v106
  v_cvt_pk_bf16_f32 v108, v12, v13
  v_lshlrev_b32 v12, 16, v108
  v_and_b32 v13, s40, v108
  v_cvt_pk_bf16_f32 v110, v14, v15
  v_lshlrev_b32 v14, 16, v110
  v_and_b32 v15, s40, v110
  v_cvt_pk_bf16_f32 v112, v16, v17
  v_lshlrev_b32 v16, 16, v112
  v_and_b32 v17, s40, v112
  v_cvt_pk_bf16_f32 v114, v18, v19
  v_lshlrev_b32 v18, 16, v114
  v_and_b32 v19, s40, v114
  v_cvt_pk_bf16_f32 v116, v20, v21
  v_lshlrev_b32 v20, 16, v116
  v_and_b32 v21, s40, v116
  v_cvt_pk_bf16_f32 v118, v22, v23
  v_lshlrev_b32 v22, 16, v118
  v_and_b32 v23, s40, v118
  v_cvt_pk_bf16_f32 v120, v24, v25
  v_lshlrev_b32 v24, 16, v120
  v_and_b32 v25, s40, v120
  v_mov_b32 v124, 0
  v_mov_b32 v125, 0
  v_mov_b32 v126, 0
  v_mov_b32 v127, 0
  v_mov_b32 v128, 0
  v_mov_b32 v129, 0
  v_mov_b32 v130, 0
  v_mov_b32 v131, 0
  s_waitcnt vmcnt(17)
  v_lshlrev_b32 v104, 16, v32
  v_and_b32 v105, s40, v32
  v_lshlrev_b32 v106, 16, v33
  v_and_b32 v107, s40, v33
  v_lshlrev_b32 v108, 16, v34
  v_and_b32 v109, s40, v34
  v_lshlrev_b32 v110, 16, v35
  v_and_b32 v111, s40, v35
  v_fmac_f32 v124, v8, v104
  v_fmac_f32 v125, v8, v105
  v_fmac_f32 v126, v8, v106
  v_fmac_f32 v127, v8, v107
  v_fmac_f32 v128, v8, v108
  v_fmac_f32 v129, v8, v109
  v_fmac_f32 v130, v8, v110
  v_fmac_f32 v131, v8, v111
  s_waitcnt vmcnt(16)
  v_lshlrev_b32 v104, 16, v36
  v_and_b32 v105, s40, v36
  v_lshlrev_b32 v106, 16, v37
  v_and_b32 v107, s40, v37
  v_lshlrev_b32 v108, 16, v38
  v_and_b32 v109, s40, v38
  v_lshlrev_b32 v110, 16, v39
  v_and_b32 v111, s40, v39
  v_fmac_f32 v124, v9, v104
  v_fmac_f32 v125, v9, v105
  v_fmac_f32 v126, v9, v106
  v_fmac_f32 v127, v9, v107
  v_fmac_f32 v128, v9, v108
  v_fmac_f32 v129, v9, v109
  v_fmac_f32 v130, v9, v110
  v_fmac_f32 v131, v9, v111
  s_waitcnt vmcnt(15)
  v_lshlrev_b32 v104, 16, v40
  v_and_b32 v105, s40, v40
  v_lshlrev_b32 v106, 16, v41
  v_and_b32 v107, s40, v41
  v_lshlrev_b32 v108, 16, v42
  v_and_b32 v109, s40, v42
  v_lshlrev_b32 v110, 16, v43
  v_and_b32 v111, s40, v43
  v_fmac_f32 v124, v10, v104
  v_fmac_f32 v125, v10, v105
  v_fmac_f32 v126, v10, v106
  v_fmac_f32 v127, v10, v107
  v_fmac_f32 v128, v10, v108
  v_fmac_f32 v129, v10, v109
  v_fmac_f32 v130, v10, v110
  v_fmac_f32 v131, v10, v111
  s_waitcnt vmcnt(14)
  v_lshlrev_b32 v104, 16, v44
  v_and_b32 v105, s40, v44
  v_lshlrev_b32 v106, 16, v45
  v_and_b32 v107, s40, v45
  v_lshlrev_b32 v108, 16, v46
  v_and_b32 v109, s40, v46
  v_lshlrev_b32 v110, 16, v47
  v_and_b32 v111, s40, v47
  v_fmac_f32 v124, v11, v104
  v_fmac_f32 v125, v11, v105
  v_fmac_f32 v126, v11, v106
  v_fmac_f32 v127, v11, v107
  v_fmac_f32 v128, v11, v108
  v_fmac_f32 v129, v11, v109
  v_fmac_f32 v130, v11, v110
  v_fmac_f32 v131, v11, v111
  s_waitcnt vmcnt(13)
  v_lshlrev_b32 v104, 16, v48
  v_and_b32 v105, s40, v48
  v_lshlrev_b32 v106, 16, v49
  v_and_b32 v107, s40, v49
  v_lshlrev_b32 v108, 16, v50
  v_and_b32 v109, s40, v50
  v_lshlrev_b32 v110, 16, v51
  v_and_b32 v111, s40, v51
  v_fmac_f32 v124, v12, v104
  v_fmac_f32 v125, v12, v105
  v_fmac_f32 v126, v12, v106
  v_fmac_f32 v127, v12, v107
  v_fmac_f32 v128, v12, v108
  v_fmac_f32 v129, v12, v109
  v_fmac_f32 v130, v12, v110
  v_fmac_f32 v131, v12, v111
  s_waitcnt vmcnt(12)
  v_lshlrev_b32 v104, 16, v52
  v_and_b32 v105, s40, v52
  v_lshlrev_b32 v106, 16, v53
  v_and_b32 v107, s40, v53
  v_lshlrev_b32 v108, 16, v54
  v_and_b32 v109, s40, v54
  v_lshlrev_b32 v110, 16, v55
  v_and_b32 v111, s40, v55
  v_fmac_f32 v124, v13, v104
  v_fmac_f32 v125, v13, v105
  v_fmac_f32 v126, v13, v106
  v_fmac_f32 v127, v13, v107
  v_fmac_f32 v128, v13, v108
  v_fmac_f32 v129, v13, v109
  v_fmac_f32 v130, v13, v110
  v_fmac_f32 v131, v13, v111
  s_waitcnt vmcnt(11)
  v_lshlrev_b32 v104, 16, v56
  v_and_b32 v105, s40, v56
  v_lshlrev_b32 v106, 16, v57
  v_and_b32 v107, s40, v57
  v_lshlrev_b32 v108, 16, v58
  v_and_b32 v109, s40, v58
  v_lshlrev_b32 v110, 16, v59
  v_and_b32 v111, s40, v59
  v_fmac_f32 v124, v14, v104
  v_fmac_f32 v125, v14, v105
  v_fmac_f32 v126, v14, v106
  v_fmac_f32 v127, v14, v107
  v_fmac_f32 v128, v14, v108
  v_fmac_f32 v129, v14, v109
  v_fmac_f32 v130, v14, v110
  v_fmac_f32 v131, v14, v111
  s_waitcnt vmcnt(10)
  v_lshlrev_b32 v104, 16, v60
  v_and_b32 v105, s40, v60
  v_lshlrev_b32 v106, 16, v61
  v_and_b32 v107, s40, v61
  v_lshlrev_b32 v108, 16, v62
  v_and_b32 v109, s40, v62
  v_lshlrev_b32 v110, 16, v63
  v_and_b32 v111, s40, v63
  v_fmac_f32 v124, v15, v104
  v_fmac_f32 v125, v15, v105
  v_fmac_f32 v126, v15, v106
  v_fmac_f32 v127, v15, v107
  v_fmac_f32 v128, v15, v108
  v_fmac_f32 v129, v15, v109
  v_fmac_f32 v130, v15, v110
  v_fmac_f32 v131, v15, v111
  s_waitcnt vmcnt(9)
  v_lshlrev_b32 v104, 16, v64
  v_and_b32 v105, s40, v64
  v_lshlrev_b32 v106, 16, v65
  v_and_b32 v107, s40, v65
  v_lshlrev_b32 v108, 16, v66
  v_and_b32 v109, s40, v66
  v_lshlrev_b32 v110, 16, v67
  v_and_b32 v111, s40, v67
  v_fmac_f32 v124, v16, v104
  v_fmac_f32 v125, v16, v105
  v_fmac_f32 v126, v16, v106
  v_fmac_f32 v127, v16, v107
  v_fmac_f32 v128, v16, v108
  v_fmac_f32 v129, v16, v109
  v_fmac_f32 v130, v16, v110
  v_fmac_f32 v131, v16, v111
  s_waitcnt vmcnt(8)
  v_lshlrev_b32 v104, 16, v68
  v_and_b32 v105, s40, v68
  v_lshlrev_b32 v106, 16, v69
  v_and_b32 v107, s40, v69
  v_lshlrev_b32 v108, 16, v70
  v_and_b32 v109, s40, v70
  v_lshlrev_b32 v110, 16, v71
  v_and_b32 v111, s40, v71
  v_fmac_f32 v124, v17, v104
  v_fmac_f32 v125, v17, v105
  v_fmac_f32 v126, v17, v106
  v_fmac_f32 v127, v17, v107
  v_fmac_f32 v128, v17, v108
  v_fmac_f32 v129, v17, v109
  v_fmac_f32 v130, v17, v110
  v_fmac_f32 v131, v17, v111
  s_waitcnt vmcnt(7)
  v_lshlrev_b32 v104, 16, v72
  v_and_b32 v105, s40, v72
  v_lshlrev_b32 v106, 16, v73
  v_and_b32 v107, s40, v73
  v_lshlrev_b32 v108, 16, v74
  v_and_b32 v109, s40, v74
  v_lshlrev_b32 v110, 16, v75
  v_and_b32 v111, s40, v75
  v_fmac_f32 v124, v18, v104
  v_fmac_f32 v125, v18, v105
  v_fmac_f32 v126, v18, v106
  v_fmac_f32 v127, v18, v107
  v_fmac_f32 v128, v18, v108
  v_fmac_f32 v129, v18, v109
  v_fmac_f32 v130, v18, v110
  v_fmac_f32 v131, v18, v111
  s_waitcnt vmcnt(6)
  v_lshlrev_b32 v104, 16, v76
  v_and_b32 v105, s40, v76
  v_lshlrev_b32 v106, 16, v77
  v_and_b32 v107, s40, v77
  v_lshlrev_b32 v108, 16, v78
  v_and_b32 v109, s40, v78
  v_lshlrev_b32 v110, 16, v79
  v_and_b32 v111, s40, v79
  v_fmac_f32 v124, v19, v104
  v_fmac_f32 v125, v19, v105
  v_fmac_f32 v126, v19, v106
  v_fmac_f32 v127, v19, v107
  v_fmac_f32 v128, v19, v108
  v_fmac_f32 v129, v19, v109
  v_fmac_f32 v130, v19, v110
  v_fmac_f32 v131, v19, v111
  s_waitcnt vmcnt(5)
  v_lshlrev_b32 v104, 16, v80
  v_and_b32 v105, s40, v80
  v_lshlrev_b32 v106, 16, v81
  v_and_b32 v107, s40, v81
  v_lshlrev_b32 v108, 16, v82
  v_and_b32 v109, s40, v82
  v_lshlrev_b32 v110, 16, v83
  v_and_b32 v111, s40, v83
  v_fmac_f32 v124, v20, v104
  v_fmac_f32 v125, v20, v105
  v_fmac_f32 v126, v20, v106
  v_fmac_f32 v127, v20, v107
  v_fmac_f32 v128, v20, v108
  v_fmac_f32 v129, v20, v109
  v_fmac_f32 v130, v20, v110
  v_fmac_f32 v131, v20, v111
  s_waitcnt vmcnt(4)
  v_lshlrev_b32 v104, 16, v84
  v_and_b32 v105, s40, v84
  v_lshlrev_b32 v106, 16, v85
  v_and_b32 v107, s40, v85
  v_lshlrev_b32 v108, 16, v86
  v_and_b32 v109, s40, v86
  v_lshlrev_b32 v110, 16, v87
  v_and_b32 v111, s40, v87
  v_fmac_f32 v124, v21, v104
  v_fmac_f32 v125, v21, v105
  v_fmac_f32 v126, v21, v106
  v_fmac_f32 v127, v21, v107
  v_fmac_f32 v128, v21, v108
  v_fmac_f32 v129, v21, v109
  v_fmac_f32 v130, v21, v110
  v_fmac_f32 v131, v21, v111
  s_waitcnt vmcnt(3)
  v_lshlrev_b32 v104, 16, v88
  v_and_b32 v105, s40, v88
  v_lshlrev_b32 v106, 16, v89
  v_and_b32 v107, s40, v89
  v_lshlrev_b32 v108, 16, v90
  v_and_b32 v109, s40, v90
  v_lshlrev_b32 v110, 16, v91
  v_and_b32 v111, s40, v91
  v_fmac_f32 v124, v22, v104
  v_fmac_f32 v125, v22, v105
  v_fmac_f32 v126, v22, v106
  v_fmac_f32 v127, v22, v107
  v_fmac_f32 v128, v22, v108
  v_fmac_f32 v129, v22, v109
  v_fmac_f32 v130, v22, v110
  v_fmac_f32 v131, v22, v111
  s_waitcnt vmcnt(2)
  v_lshlrev_b32 v104, 16, v92
  v_and_b32 v105, s40, v92
  v_lshlrev_b32 v106, 16, v93
  v_and_b32 v107, s40, v93
  v_lshlrev_b32 v108, 16, v94
  v_and_b32 v109, s40, v94
  v_lshlrev_b32 v110, 16, v95
  v_and_b32 v111, s40, v95
  v_fmac_f32 v124, v23, v104
  v_fmac_f32 v125, v23, v105
  v_fmac_f32 v126, v23, v106
  v_fmac_f32 v127, v23, v107
  v_fmac_f32 v128, v23, v108
  v_fmac_f32 v129, v23, v109
  v_fmac_f32 v130, v23, v110
  v_fmac_f32 v131, v23, v111
  s_waitcnt vmcnt(1)
  v_lshlrev_b32 v104, 16, v96
  v_and_b32 v105, s40, v96
  v_lshlrev_b32 v106, 16, v97
  v_and_b32 v107, s40, v97
  v_lshlrev_b32 v108, 16, v98
  v_and_b32 v109, s40, v98
  v_lshlrev_b32 v110, 16, v99
  v_and_b32 v111, s40, v99
  v_fmac_f32 v124, v24, v104
  v_fmac_f32 v125, v24, v105
  v_fmac_f32 v126, v24, v106
  v_fmac_f32 v127, v24, v107
  v_fmac_f32 v128, v24, v108
  v_fmac_f32 v129, v24, v109
  v_fmac_f32 v130, v24, v110
  v_fmac_f32 v131, v24, v111
  s_waitcnt vmcnt(0)
  v_lshlrev_b32 v104, 16, v100
  v_and_b32 v105, s40, v100
  v_lshlrev_b32 v106, 16, v101
  v_and_b32 v107, s40, v101
  v_lshlrev_b32 v108, 16, v102
  v_and_b32 v109, s40, v102
  v_lshlrev_b32 v110, 16, v103
  v_and_b32 v111, s40, v103
  v_fmac_f32 v124, v25, v104
  v_fmac_f32 v125, v25, v105
  v_fmac_f32 v126, v25, v106
  v_fmac_f32 v127, v25, v107
  v_fmac_f32 v128, v25, v108
  v_fmac_f32 v129, v25, v109
  v_fmac_f32 v130, v25, v110
  v_fmac_f32 v131, v25, v111
  s_cmp_lg_u32 s18, 0
  s_cbranch_scc1 mega_kernel_nres11
  s_mov_b32 s36, 0
  global_load_dword v253, v252, s[52:53] sc1
  s_waitcnt vmcnt(0)
mega_kernel_npoll12:
  s_add_u32 s36, s36, 1
  v_readfirstlane_b32 s3, v253
  s_cmp_ge_u32 s36, 1048576
  s_cbranch_scc1 mega_kernel_ndone13
  s_cmp_lg_u32 s3, 0
  s_cbranch_scc1 mega_kernel_ndone13
  global_load_dword v253, v252, s[52:53] sc1
  s_waitcnt vmcnt(0)
  s_branch mega_kernel_npoll12
mega_kernel_ndone13:
  v_mov_b32 v250, s3
  v_mov_b32 v251, 147440
  ds_write_b32 v251, v250
mega_kernel_nres11:
  v_lshlrev_b32 v6, 8, v5
  v_lshl_add_u32 v6, v4, 5, v6
  ds_write_b128 v6, v[124:127]
  ds_write_b128 v6, v[128:131] offset:16
  v_lshlrev_b32 v7, 2, v0
  s_waitcnt lgkmcnt(0)
  s_barrier
  v_mov_b32 v250, 147440
  ds_read_b32 v250, v250
  s_waitcnt lgkmcnt(0)
  v_readfirstlane_b32 s3, v250
  s_cmp_lg_u32 s18, 0
  s_cbranch_scc1 mega_kernel_p0done4
  ds_read_b32 v32, v7 offset:0
  ds_read_b32 v33, v7 offset:256
  ds_read_b32 v34, v7 offset:512
  ds_read_b32 v35, v7 offset:768
  ds_read_b32 v36, v7 offset:1024
  ds_read_b32 v37, v7 offset:1280
  ds_read_b32 v38, v7 offset:1536
  ds_read_b32 v39, v7 offset:1792
  ds_read_b32 v40, v7 offset:2048
  ds_read_b32 v41, v7 offset:2304
  ds_read_b32 v42, v7 offset:2560
  ds_read_b32 v43, v7 offset:2816
  ds_read_b32 v44, v7 offset:3072
  ds_read_b32 v45, v7 offset:3328
  ds_read_b32 v46, v7 offset:3584
  ds_read_b32 v47, v7 offset:3840
  ds_read_b32 v48, v7 offset:4096
  ds_read_b32 v49, v7 offset:4352
  ds_read_b32 v50, v7 offset:4608
  ds_read_b32 v51, v7 offset:4864
  ds_read_b32 v52, v7 offset:5120
  ds_read_b32 v53, v7 offset:5376
  ds_read_b32 v54, v7 offset:5632
  ds_read_b32 v55, v7 offset:5888
  ds_read_b32 v56, v7 offset:6144
  ds_read_b32 v57, v7 offset:6400
  ds_read_b32 v58, v7 offset:6656
  ds_read_b32 v59, v7 offset:6912
  ds_read_b32 v60, v7 offset:7168
  ds_read_b32 v61, v7 offset:7424
  ds_read_b32 v62, v7 offset:7680
  ds_read_b32 v63, v7 offset:7936
  s_waitcnt lgkmcnt(0)
  v_add_f32 v32, v32, v48
  v_add_f32 v33, v33, v49
  v_add_f32 v34, v34, v50
  v_add_f32 v35, v35, v51
  v_add_f32 v36, v36, v52
  v_add_f32 v37, v37, v53
  v_add_f32 v38, v38, v54
  v_add_f32 v39, v39, v55
  v_add_f32 v40, v40, v56
  v_add_f32 v41, v41, v57
  v_add_f32 v42, v42, v58
  v_add_f32 v43, v43, v59
  v_add_f32 v44, v44, v60
  v_add_f32 v45, v45, v61
  v_add_f32 v46, v46, v62
  v_add_f32 v47, v47, v63
  v_add_f32 v32, v32, v40
  v_add_f32 v33, v33, v41
  v_add_f32 v34, v34, v42
  v_add_f32 v35, v35, v43
  v_add_f32 v36, v36, v44
  v_add_f32 v37, v37, v45
  v_add_f32 v38, v38, v46
  v_add_f32 v39, v39, v47
  v_add_f32 v32, v32, v36
  v_add_f32 v33, v33, v37
  v_add_f32 v34, v34, v38
  v_add_f32 v35, v35, v39
  v_add_f32 v32, v32, v34
  v_add_f32 v33, v33, v35
  v_add_f32 v32, v32, v33
  s_mul_i32 s17, s16, 7282
  s_lshr_b32 s17, s17, 16
  s_mul_i32 s36, s17, 9
  s_sub_u32 s36, s16, s36
  v_cvt_pk_bf16_f32 v33, v32, v32
  v_and_b32 v32, s40, v33
  v_add_f32 v34, 1.0, v32
  v_cvt_pk_bf16_f32 v34, v34, v34
  s_cmp_eq_u32 s17, 1
  s_cselect_b32 s37, 1, 0
  s_cmp_eq_u32 s17, 4
  s_cselect_b32 s37, 1, s37
  s_cmp_eq_u32 s37, 1
  s_cselect_b64 vcc, -1, 0
  s_lshl_b32 s36, s36, 6
  v_add_u32 v8, s36, v0
  v_cndmask_b32 v33, v33, v34, vcc
  v_lshlrev_b32 v9, 4, v8
  s_lshl_b32 s37, s17, 1
  buffer_store_short v33, v9, s[28:31], s37 offen sc1
  s_cmp_lg_u32 s17, 5
  s_cbranch_scc1 mega_kernel_p0done4
  v_lshlrev_b32 v9, 2, v8
  s_movk_i32 s37, 0x4000
  buffer_store_dword v32, v9, s[28:31], s37 offen sc1
  s_branch mega_kernel_p0done4
mega_kernel_p0idle3:
  s_getpc_b64 s[4:5]
  s_add_u32 s4, s4, code_begin@rel32@lo+4
  s_addc_u32 s5, s5, code_begin@rel32@hi+12
  s_getpc_b64 s[6:7]
  s_add_u32 s6, s6, desc_begin@rel32@lo+4
  s_addc_u32 s7, s7, desc_begin@rel32@hi+12
  v_lshlrev_b32 v6, 7, v0
  v_min_u32 v7, code_end-code_begin-4, v6
  v_add_u32 v8, 32768, v6
  v_min_u32 v8, code_end-code_begin-4, v8
  v_lshlrev_b32 v9, 6, v4
  v_min_u32 v9, desc_end-desc_begin-4, v9
  global_load_dword v10, v7, s[4:5]
  global_load_dword v11, v8, s[4:5]
  global_load_dword v12, v9, s[6:7]
  s_add_u32 s20, s10, 13107200
  s_addc_u32 s21, s11, 0
  s_mov_b32 s22, 319488
  s_mov_b32 s23, 0x00020000
  s_sub_u32 s36, s2, 252
  s_lshl_b32 s36, s36, 15
  buffer_load_dword v13, v6, s[20:23], s36 offen sc1
  s_add_u32 s36, s36, 0x20000
  buffer_load_dword v14, v6, s[20:23], s36 offen sc1
  s_add_u32 s36, s36, 0x20000
  buffer_load_dword v15, v6, s[20:23], s36 offen sc1
  s_mov_b32 s56, s66
  s_mov_b32 s57, s67
  s_mov_b32 s58, 2359296
  s_mov_b32 s59, 0x00020000
  v_mov_b32 v200, 0
  v_mov_b32 v201, 0
  v_mov_b32 v202, 0
  v_mov_b32 v203, 0
  v_mov_b32 v204, 0
  v_mov_b32 v205, 0
  v_mov_b32 v206, 0
  v_mov_b32 v207, 0
  v_mov_b32 v208, 0
  v_mov_b32 v209, 0
  v_mov_b32 v210, 0
  v_mov_b32 v211, 0
  v_mov_b32 v212, 0
  v_mov_b32 v213, 0
  v_mov_b32 v214, 0
  v_mov_b32 v215, 0
  v_mov_b32 v216, 0
  v_mov_b32 v217, 0
  s_lshl_b32 s68, s2, 3
  s_lshl_b32 s37, s18, 1
  s_add_u32 s68, s68, s37
  s_mul_i32 s68, s68, 1152
  v_lshlrev_b32 v236, 1, v1
  buffer_load_short_d16_hi v200, v236, s[56:59], s68 offen offset:0
  buffer_load_short_d16_hi v202, v236, s[56:59], s68 offen offset:128
  buffer_load_short_d16_hi v204, v236, s[56:59], s68 offen offset:256
  buffer_load_short_d16_hi v206, v236, s[56:59], s68 offen offset:384
  buffer_load_short_d16_hi v208, v236, s[56:59], s68 offen offset:512
  buffer_load_short_d16_hi v210, v236, s[56:59], s68 offen offset:640
  buffer_load_short_d16_hi v212, v236, s[56:59], s68 offen offset:768
  buffer_load_short_d16_hi v214, v236, s[56:59], s68 offen offset:896
  buffer_load_short_d16_hi v216, v236, s[56:59], s68 offen offset:1024
  buffer_load_short_d16_hi v201, v236, s[56:59], s68 offen offset:1152
  buffer_load_short_d16_hi v203, v236, s[56:59], s68 offen offset:1280
  buffer_load_short_d16_hi v205, v236, s[56:59], s68 offen offset:1408
  buffer_load_short_d16_hi v207, v236, s[56:59], s68 offen offset:1536
  buffer_load_short_d16_hi v209, v236, s[56:59], s68 offen offset:1664
  buffer_load_short_d16_hi v211, v236, s[56:59], s68 offen offset:1792
  buffer_load_short_d16_hi v213, v236, s[56:59], s68 offen offset:1920
  buffer_load_short_d16_hi v215, v236, s[56:59], s68 offen offset:2048
  buffer_load_short_d16_hi v217, v236, s[56:59], s68 offen offset:2176
  s_cmp_lg_u32 s18, 0
  s_cbranch_scc1 mega_kernel_nres15
  s_mov_b32 s36, 0
  global_load_dword v253, v252, s[52:53] sc1
  s_waitcnt vmcnt(0)
mega_kernel_npoll16:
  s_add_u32 s36, s36, 1
  v_readfirstlane_b32 s3, v253
  s_cmp_ge_u32 s36, 1048576
  s_cbranch_scc1 mega_kernel_ndone17
  s_cmp_lg_u32 s3, 0
  s_cbranch_scc1 mega_kernel_ndone17
  global_load_dword v253, v252, s[52:53] sc1
  s_waitcnt vmcnt(0)
  s_branch mega_kernel_npoll16
mega_kernel_ndone17:
  v_mov_b32 v250, s3
  v_mov_b32 v251, 147440
  ds_write_b32 v251, v250
mega_kernel_nres15:
  s_waitcnt lgkmcnt(0)
  s_barrier
  v_mov_b32 v250, 147440
  ds_read_b32 v250, v250
  s_waitcnt lgkmcnt(0)
  v_readfirstlane_b32 s3, v250
mega_kernel_p0done4:
  s_load_dwordx4 s[4:7], s[0:1], 32
  s_load_dwordx4 s[48:51], s[0:1], 56
  s_load_dwordx2 s[8:9], s[0:1], 72
  s_lshl_b32 s36, s16, 5
  s_add_u32 s36, s36, s17
  s_lshl_b32 s36, s36, 2
  s_lshl_b32 s37, s2, 2
  s_add_u32 s37, s37, 1832
  s_cmp_lt_u32 s2, 198
  s_cselect_b32 s37, s36, s37
  s_waitcnt vmcnt(0) lgkmcnt(0)
  s_barrier
  s_cmp_lg_u32 s18, 0
  s_cbranch_scc1 mega_kernel_pubskip18
  s_mov_b64 exec, 4294967295
  v_mul_u32_u24 v2, 8960, v1
  v_add_u32 v2, s37, v2
  v_mov_b32 v3, s3
  global_store_dword v2, v3, s[12:13] sc1
  s_mov_b64 exec, -1
mega_kernel_pubskip18:
  s_mov_b32 s44, 0x3ae38e39
  s_mov_b32 s45, 0x3727c5ac
  s_cmp_ge_u32 s2, 144
  s_cbranch_scc1 mega_kernel_p1pf19
mega_kernel_ln121:
  v_pk_add_f32 v[244:245], v[200:201], v[202:203]
  v_pk_add_f32 v[244:245], v[244:245], v[204:205]
  v_pk_add_f32 v[244:245], v[244:245], v[206:207]
  v_pk_add_f32 v[244:245], v[244:245], v[208:209]
  v_pk_add_f32 v[244:245], v[244:245], v[210:211]
  v_pk_add_f32 v[244:245], v[244:245], v[212:213]
  v_pk_add_f32 v[244:245], v[244:245], v[214:215]
  v_pk_add_f32 v[244:245], v[244:245], v[216:217]
  s_nop 0
  s_nop 0
  v_add_f32 v244, v244, v244 quad_perm:[1,0,3,2] row_mask:0xf bank_mask:0xf
  v_add_f32 v245, v245, v245 quad_perm:[1,0,3,2] row_mask:0xf bank_mask:0xf
  s_nop 0
  v_add_f32 v244, v244, v244 quad_perm:[2,3,0,1] row_mask:0xf bank_mask:0xf
  v_add_f32 v245, v245, v245 quad_perm:[2,3,0,1] row_mask:0xf bank_mask:0xf
  s_nop 0
  v_add_f32 v244, v244, v244 row_half_mirror row_mask:0xf bank_mask:0xf
  v_add_f32 v245, v245, v245 row_half_mirror row_mask:0xf bank_mask:0xf
  s_nop 0
  v_add_f32 v244, v244, v244 row_mirror row_mask:0xf bank_mask:0xf
  v_add_f32 v245, v245, v245 row_mirror row_mask:0xf bank_mask:0xf
  v_mov_b32 v246, v244
  v_mov_b32 v247, v245
  s_nop 1
  v_permlane16_swap_b32 v244, v246
  v_permlane16_swap_b32 v245, v247
  v_add_f32 v244, v244, v246
  v_add_f32 v245, v245, v247
  v_mov_b32 v246, v244
  v_mov_b32 v247, v245
  s_nop 1
  v_permlane32_swap_b32 v244, v246
  v_permlane32_swap_b32 v245, v247
  v_add_f32 v244, v244, v246
  v_add_f32 v245, v245, v247
  v_mul_f32 v248, s44, v244
  v_mul_f32 v249, s44, v245
  v_pk_add_f32 v[218:219], v[200:201], v[248:249] neg_lo:[0,1] neg_hi:[0,1]
  v_pk_add_f32 v[220:221], v[202:203], v[248:249] neg_lo:[0,1] neg_hi:[0,1]
  v_pk_add_f32 v[222:223], v[204:205], v[248:249] neg_lo:[0,1] neg_hi:[0,1]
  v_pk_add_f32 v[224:225], v[206:207], v[248:249] neg_lo:[0,1] neg_hi:[0,1]
  v_pk_add_f32 v[226:227], v[208:209], v[248:249] neg_lo:[0,1] neg_hi:[0,1]
  v_pk_add_f32 v[228:229], v[210:211], v[248:249] neg_lo:[0,1] neg_hi:[0,1]
  v_pk_add_f32 v[230:231], v[212:213], v[248:249] neg_lo:[0,1] neg_hi:[0,1]
  v_pk_add_f32 v[232:233], v[214:215], v[248:249] neg_lo:[0,1] neg_hi:[0,1]
  v_pk_add_f32 v[234:235], v[216:217], v[248:249] neg_lo:[0,1] neg_hi:[0,1]
  v_pk_mul_f32 v[244:245], v[218:219], v[218:219]
  v_pk_fma_f32 v[244:245], v[220:221], v[220:221], v[244:245]
  v_pk_fma_f32 v[244:245], v[222:223], v[222:223], v[244:245]
  v_pk_fma_f32 v[244:245], v[224:225], v[224:225], v[244:245]
  v_pk_fma_f32 v[244:245], v[226:227], v[226:227], v[244:245]
  v_pk_fma_f32 v[244:245], v[228:229], v[228:229], v[244:245]
  v_pk_fma_f32 v[244:245], v[230:231], v[230:231], v[244:245]
  v_pk_fma_f32 v[244:245], v[232:233], v[232:233], v[244:245]
  v_pk_fma_f32 v[244:245], v[234:235], v[234:235], v[244:245]
  s_nop 0
  s_nop 0
  v_add_f32 v244, v244, v244 quad_perm:[1,0,3,2] row_mask:0xf bank_mask:0xf
  v_add_f32 v245, v245, v245 quad_perm:[1,0,3,2] row_mask:0xf bank_mask:0xf
  s_nop 0
  v_add_f32 v244, v244, v244 quad_perm:[2,3,0,1] row_mask:0xf bank_mask:0xf
  v_add_f32 v245, v245, v245 quad_perm:[2,3,0,1] row_mask:0xf bank_mask:0xf
  s_nop 0
  v_add_f32 v244, v244, v244 row_half_mirror row_mask:0xf bank_mask:0xf
  v_add_f32 v245, v245, v245 row_half_mirror row_mask:0xf bank_mask:0xf
  s_nop 0
  v_add_f32 v244, v244, v244 row_mirror row_mask:0xf bank_mask:0xf
  v_add_f32 v245, v245, v245 row_mirror row_mask:0xf bank_mask:0xf
  v_mov_b32 v246, v244
  v_mov_b32 v247, v245
  s_nop 1
  v_permlane16_swap_b32 v244, v246
  v_permlane16_swap_b32 v245, v247
  v_add_f32 v244, v244, v246
  v_add_f32 v245, v245, v247
  v_mov_b32 v246, v244
  v_mov_b32 v247, v245
  s_nop 1
  v_permlane32_swap_b32 v244, v246
  v_permlane32_swap_b32 v245, v247
  v_add_f32 v244, v244, v246
  v_add_f32 v245, v245, v247
  v_mul_f32 v244, s44, v244
  v_mul_f32 v245, s44, v245
  v_cvt_pk_bf16_f32 v240, v248, v249
  v_lshlrev_b32 v248, 16, v240
  v_and_b32 v249, s40, v240
  v_cvt_pk_bf16_f32 v241, v244, v245
  v_lshlrev_b32 v244, 16, v241
  v_and_b32 v245, s40, v241
  v_add_f32 v244, s45, v244
  v_add_f32 v245, s45, v245
  v_cvt_pk_bf16_f32 v240, v244, v245
  v_lshlrev_b32 v244, 16, v240
  v_and_b32 v245, s40, v240
  v_sqrt_f32 v244, v244
  v_sqrt_f32 v245, v245
  s_nop 0
  v_cvt_pk_bf16_f32 v240, v244, v245
  v_lshlrev_b32 v244, 16, v240
  v_and_b32 v245, s40, v240
  v_rcp_f32 v246, v244
  v_rcp_f32 v247, v245
  v_pk_add_f32 v[218:219], v[200:201], v[248:249] neg_lo:[0,1] neg_hi:[0,1]
  v_pk_add_f32 v[220:221], v[202:203], v[248:249] neg_lo:[0,1] neg_hi:[0,1]
  v_pk_add_f32 v[222:223], v[204:205], v[248:249] neg_lo:[0,1] neg_hi:[0,1]
  v_pk_add_f32 v[224:225], v[206:207], v[248:249] neg_lo:[0,1] neg_hi:[0,1]
  v_pk_add_f32 v[226:227], v[208:209], v[248:249] neg_lo:[0,1] neg_hi:[0,1]
  v_pk_add_f32 v[228:229], v[210:211], v[248:249] neg_lo:[0,1] neg_hi:[0,1]
  v_pk_add_f32 v[230:231], v[212:213], v[248:249] neg_lo:[0,1] neg_hi:[0,1]
  v_pk_add_f32 v[232:233], v[214:215], v[248:249] neg_lo:[0,1] neg_hi:[0,1]
  v_pk_add_f32 v[234:235], v[216:217], v[248:249] neg_lo:[0,1] neg_hi:[0,1]
  v_cvt_pk_bf16_f32 v240, v218, v219
  v_lshlrev_b32 v218, 16, v240
  v_and_b32 v219, s40, v240
  v_cvt_pk_bf16_f32 v241, v220, v221
  v_lshlrev_b32 v220, 16, v241
  v_and_b32 v221, s40, v241
  v_cvt_pk_bf16_f32 v242, v222, v223
  v_lshlrev_b32 v222, 16, v242
  v_and_b32 v223, s40, v242
  v_cvt_pk_bf16_f32 v243, v224, v225
  v_lshlrev_b32 v224, 16, v243
  v_and_b32 v225, s40, v243
  v_cvt_pk_bf16_f32 v240, v226, v227
  v_lshlrev_b32 v226, 16, v240
  v_and_b32 v227, s40, v240
  v_cvt_pk_bf16_f32 v241, v228, v229
  v_lshlrev_b32 v228, 16, v241
  v_and_b32 v229, s40, v241
  v_cvt_pk_bf16_f32 v242, v230, v231
  v_lshlrev_b32 v230, 16, v242
  v_and_b32 v231, s40, v242
  v_cvt_pk_bf16_f32 v243, v232, v233
  v_lshlrev_b32 v232, 16, v243
  v_and_b32 v233, s40, v243
  v_cvt_pk_bf16_f32 v240, v234, v235
  v_lshlrev_b32 v234, 16, v240
  v_and_b32 v235, s40, v240
  v_pk_mul_f32 v[240:241], v[218:219], v[246:247]
  v_pk_fma_f32 v[250:251], v[240:241], v[244:245], v[218:219] neg_lo:[1,0,0] neg_hi:[1,0,0]
  v_pk_fma_f32 v[218:219], v[250:251], v[246:247], v[240:241]
  v_pk_mul_f32 v[242:243], v[220:221], v[246:247]
  v_pk_fma_f32 v[250:251], v[242:243], v[244:245], v[220:221] neg_lo:[1,0,0] neg_hi:[1,0,0]
  v_pk_fma_f32 v[220:221], v[250:251], v[246:247], v[242:243]
  v_pk_mul_f32 v[240:241], v[222:223], v[246:247]
  v_pk_fma_f32 v[250:251], v[240:241], v[244:245], v[222:223] neg_lo:[1,0,0] neg_hi:[1,0,0]
  v_pk_fma_f32 v[222:223], v[250:251], v[246:247], v[240:241]
  v_pk_mul_f32 v[242:243], v[224:225], v[246:247]
  v_pk_fma_f32 v[250:251], v[242:243], v[244:245], v[224:225] neg_lo:[1,0,0] neg_hi:[1,0,0]
  v_pk_fma_f32 v[224:225], v[250:251], v[246:247], v[242:243]
  v_pk_mul_f32 v[240:241], v[226:227], v[246:247]
  v_pk_fma_f32 v[250:251], v[240:241], v[244:245], v[226:227] neg_lo:[1,0,0] neg_hi:[1,0,0]
  v_pk_fma_f32 v[226:227], v[250:251], v[246:247], v[240:241]
  v_pk_mul_f32 v[242:243], v[228:229], v[246:247]
  v_pk_fma_f32 v[250:251], v[242:243], v[244:245], v[228:229] neg_lo:[1,0,0] neg_hi:[1,0,0]
  v_pk_fma_f32 v[228:229], v[250:251], v[246:247], v[242:243]
  v_pk_mul_f32 v[240:241], v[230:231], v[246:247]
  v_pk_fma_f32 v[250:251], v[240:241], v[244:245], v[230:231] neg_lo:[1,0,0] neg_hi:[1,0,0]
  v_pk_fma_f32 v[230:231], v[250:251], v[246:247], v[240:241]
  v_pk_mul_f32 v[242:243], v[232:233], v[246:247]
  v_pk_fma_f32 v[250:251], v[242:243], v[244:245], v[232:233] neg_lo:[1,0,0] neg_hi:[1,0,0]
  v_pk_fma_f32 v[232:233], v[250:251], v[246:247], v[242:243]
  v_pk_mul_f32 v[240:241], v[234:235], v[246:247]
  v_pk_fma_f32 v[250:251], v[240:241], v[244:245], v[234:235] neg_lo:[1,0,0] neg_hi:[1,0,0]
  v_pk_fma_f32 v[234:235], v[250:251], v[246:247], v[240:241]
  v_cvt_pk_bf16_f32 v240, v218, v219
  v_lshlrev_b32 v218, 16, v240
  v_and_b32 v219, s40, v240
  v_cvt_pk_bf16_f32 v241, v220, v221
  v_lshlrev_b32 v220, 16, v241
  v_and_b32 v221, s40, v241
  v_cvt_pk_bf16_f32 v242, v222, v223
  v_lshlrev_b32 v222, 16, v242
  v_and_b32 v223, s40, v242
  v_cvt_pk_bf16_f32 v243, v224, v225
  v_lshlrev_b32 v224, 16, v243
  v_and_b32 v225, s40, v243
  v_cvt_pk_bf16_f32 v240, v226, v227
  v_lshlrev_b32 v226, 16, v240
  v_and_b32 v227, s40, v240
  v_cvt_pk_bf16_f32 v241, v228, v229
  v_lshlrev_b32 v228, 16, v241
  v_and_b32 v229, s40, v241
  v_cvt_pk_bf16_f32 v242, v230, v231
  v_lshlrev_b32 v230, 16, v242
  v_and_b32 v231, s40, v242
  v_cvt_pk_bf16_f32 v243, v232, v233
  v_lshlrev_b32 v232, 16, v243
  v_and_b32 v233, s40, v243
  v_cvt_pk_bf16_f32 v240, v234, v235
  v_lshlrev_b32 v234, 16, v240
  v_and_b32 v235, s40, v240
  s_cmp_ge_u32 s2, 144
  s_cbranch_scc1 mega_kernel_p1pf222
  v_and_b32 v17, 15, v1
  v_lshrrev_b32 v18, 4, v1
  v_lshrrev_b32 v19, 2, v17
  v_and_b32 v8, 3, v1
  s_movk_i32 s16, 4160
  s_movk_i32 s17, 4640
  s_lshl_b32 s37, s15, 1
  s_and_b32 s37, s37, 0xfffffffc
  v_lshlrev_b32 v11, 4, v1
  s_load_dword s41, s[6:7], s37
  s_mul_i32 s36, s15, 4352
  s_add_u32 s38, s10, s36
  s_addc_u32 s39, s11, 0
  s_add_u32 s24, s38, 0
  s_addc_u32 s25, s39, 0
  s_mov_b32 s26, 4096
  s_mov_b32 s27, 0x00020000
  s_add_u32 s28, s38, 2621440
  s_addc_u32 s29, s39, 0
  s_mov_b32 s30, 4096
  s_mov_b32 s31, 0x00020000
  s_add_u32 s32, s10, 5242880
  s_addc_u32 s33, s11, 0
  s_mov_b32 s34, 2359296
  s_mov_b32 s35, 0x00020000
  v_mul_u32_u24 v12, s16, v8
  v_sub_u32 v13, v18, v19
  v_lshl_add_u32 v12, v13, 4, v12
  v_add_u32 v12, 48, v12
  v_add_u32 v12, s14, v12
  v_and_b32 v13, 1, v1
  v_mul_u32_u24 v13, s17, v13
  v_lshrrev_b32 v14, 1, v17
  v_lshl_add_u32 v13, v14, 6, v13
  v_lshl_add_u32 v13, v18, 4, v13
  v_add_u32 v13, 16640, v13
  v_add_u32 v13, s14, v13
  v_and_b32 v15, 1, v1
  v_lshlrev_b32 v15, 3, v15
  v_lshl_add_u32 v16, v14, 6, v15
  v_lshl_add_u32 v16, v18, 4, v16
  v_sub_u32 v16, 13000, v16
  v_add_u32 v16, s14, v16
  v_lshrrev_b32 v9, 1, v18
  v_lshl_add_u32 v14, v14, 1, v9
  v_lshl_add_u32 v15, v14, 7, v15
  v_and_b32 v9, 1, v18
  v_lshl_add_u32 v15, v9, 4, v15
  s_lshl_b32 s36, s18, 5
  s_add_u32 s36, s36, 104448
  v_add_u32 v15, s36, v15
  v_mov_b32 v32, 0
  v_mov_b32 v33, 0
  v_mov_b32 v34, 0
  v_mov_b32 v35, 0
  v_mov_b32 v36, 0
  v_mov_b32 v37, 0
  v_mov_b32 v38, 0
  v_mov_b32 v39, 0
  v_mov_b32 v40, 0
  v_mov_b32 v41, 0
  v_mov_b32 v42, 0
  v_mov_b32 v43, 0
  v_mov_b32 v44, 0
  v_mov_b32 v45, 0
  v_mov_b32 v46, 0
  v_mov_b32 v47, 0
  v_mov_b32 v48, 0
  v_mov_b32 v49, 0
  v_mov_b32 v50, 0
  v_mov_b32 v51, 0
  v_mov_b32 v52, 0
  v_mov_b32 v53, 0
  v_mov_b32 v54, 0
  v_mov_b32 v55, 0
  v_mov_b32 v56, 0
  v_mov_b32 v57, 0
  v_mov_b32 v58, 0
  v_mov_b32 v59, 0
  v_mov_b32 v60, 0
  v_mov_b32 v61, 0
  v_mov_b32 v62, 0
  v_mov_b32 v63, 0
  s_lshr_b32 s36, s2, 4
  s_lshl_b32 s37, s36, 7
  s_cmp_lg_u32 s18, 0
  s_cbranch_scc1 mega_kernel_wskip23
  v_min_u32 v2, 21, v1
  v_lshlrev_b32 v2, 2, v2
  v_add_u32 v2, s37, v2
  s_and_b32 s36, s2, 31
  s_mul_i32 s36, s36, 8960
  v_add_u32 v2, s36, v2
  s_mov_b32 s36, 0
mega_kernel_poll24:
  global_load_dword v28, v2, s[12:13] sc1
  s_add_u32 s36, s36, 1
  s_waitcnt vmcnt(0)
  v_cmp_ne_u32 vcc, s3, v28
  s_cmp_ge_u32 s36, 1048576
  s_cbranch_scc1 mega_kernel_pdone25
  s_cbranch_vccz mega_kernel_pdone25
  s_sleep 1
  s_branch mega_kernel_poll24
mega_kernel_pdone25:
mega_kernel_wskip23:
  s_barrier
  s_add_u32 m0, s14, 12
  s_nop 0
  buffer_load_dwordx4 v11, s[28:31], 0 offen offset:0 sc1 lds
  buffer_load_dwordx4 v11, s[28:31], 0 offen offset:1024 sc1 lds
  buffer_load_dwordx4 v11, s[28:31], 0 offen offset:2048 sc1 lds
  buffer_load_dwordx4 v11, s[28:31], 0 offen offset:3072 sc1 lds
  s_add_u32 m0, s14, 4172
  s_nop 0
  buffer_load_dwordx4 v11, s[24:27], 0 offen offset:0 sc1 lds
  buffer_load_dwordx4 v11, s[24:27], 0 offen offset:1024 sc1 lds
  buffer_load_dwordx4 v11, s[24:27], 0 offen offset:2048 sc1 lds
  buffer_load_dwordx4 v11, s[24:27], 0 offen offset:3072 sc1 lds
  s_add_u32 m0, s14, 8336
  s_nop 0
  buffer_load_dwordx4 v11, s[28:31], 0 offen offset:0 sc1 lds
  buffer_load_dwordx4 v11, s[28:31], 0 offen offset:1024 sc1 lds
  buffer_load_dwordx4 v11, s[28:31], 0 offen offset:2048 sc1 lds
  buffer_load_dwordx4 v11, s[28:31], 0 offen offset:3072 sc1 lds
  s_add_u32 m0, s14, 12496
  s_nop 0
  buffer_load_dwordx4 v11, s[24:27], 0 offen offset:0 sc1 lds
  buffer_load_dwordx4 v11, s[24:27], 0 offen offset:1024 sc1 lds
  buffer_load_dwordx4 v11, s[24:27], 0 offen offset:2048 sc1 lds
  buffer_load_dwordx4 v11, s[24:27], 0 offen offset:3072 sc1 lds
  s_waitcnt vmcnt(0)
  ds_read_b128 v[64:67], v12 offset:3600
  ds_read_b128 v[96:99], v13 offset:0
  ds_read_b128 v[68:71], v12 offset:3088
  ds_read_b128 v[100:103], v13 offset:512
  ds_read_b128 v[72:75], v12 offset:2576
  ds_read_b128 v[104:107], v13 offset:1024
  ds_read_b128 v[76:79], v12 offset:2064
  ds_read_b128 v[108:111], v13 offset:1536
  ds_read_b128 v[80:83], v12 offset:1552
  ds_read_b128 v[112:115], v13 offset:2048
  ds_read_b128 v[84:87], v12 offset:1040
  ds_read_b128 v[116:119], v13 offset:2560
  ds_read_b128 v[88:91], v12 offset:528
  ds_read_b128 v[120:123], v13 offset:3072
  ds_read_b128 v[92:95], v12 offset:16
  ds_read_b128 v[124:127], v13 offset:3584
  s_mov_b32 s37, 0
mega_kernel_cloop27:
  s_waitcnt lgkmcnt(0)
  v_mfma_f32_16x16x32_bf16 v[32:35], v[64:67], v[96:99], v[32:35]
  ds_read_b128 v[128:131], v12 offset:3664
  v_mfma_f32_16x16x32_bf16 v[36:39], v[64:67], v[100:103], v[36:39]
  ds_read_b128 v[160:163], v13 offset:64
  v_mfma_f32_16x16x32_bf16 v[40:43], v[64:67], v[104:107], v[40:43]
  ds_read_b128 v[132:135], v12 offset:3152
  v_mfma_f32_16x16x32_bf16 v[44:47], v[64:67], v[108:111], v[44:47]
  ds_read_b128 v[164:167], v13 offset:576
  v_mfma_f32_16x16x32_bf16 v[48:51], v[64:67], v[112:115], v[48:51]
  ds_read_b128 v[136:139], v12 offset:2640
  v_mfma_f32_16x16x32_bf16 v[52:55], v[64:67], v[116:119], v[52:55]
  ds_read_b128 v[168:171], v13 offset:1088
  v_mfma_f32_16x16x32_bf16 v[56:59], v[64:67], v[120:123], v[56:59]
  ds_read_b128 v[140:143], v12 offset:2128
  v_mfma_f32_16x16x32_bf16 v[60:63], v[64:67], v[124:127], v[60:63]
  ds_read_b128 v[172:175], v13 offset:1600
  v_mfma_f32_16x16x32_bf16 v[36:39], v[68:71], v[96:99], v[36:39]
  ds_read_b128 v[144:147], v12 offset:1616
  v_mfma_f32_16x16x32_bf16 v[40:43], v[68:71], v[100:103], v[40:43]
  ds_read_b128 v[176:179], v13 offset:2112
  v_mfma_f32_16x16x32_bf16 v[44:47], v[68:71], v[104:107], v[44:47]
  ds_read_b128 v[148:151], v12 offset:1104
  v_mfma_f32_16x16x32_bf16 v[48:51], v[68:71], v[108:111], v[48:51]
  ds_read_b128 v[180:183], v13 offset:2624
  v_mfma_f32_16x16x32_bf16 v[52:55], v[68:71], v[112:115], v[52:55]
  ds_read_b128 v[152:155], v12 offset:592
  v_mfma_f32_16x16x32_bf16 v[56:59], v[68:71], v[116:119], v[56:59]
  ds_read_b128 v[184:187], v13 offset:3136
  v_mfma_f32_16x16x32_bf16 v[60:63], v[68:71], v[120:123], v[60:63]
  ds_read_b128 v[156:159], v12 offset:80
  v_mfma_f32_16x16x32_bf16 v[40:43], v[72:75], v[96:99], v[40:43]
  ds_read_b128 v[188:191], v13 offset:3648
  v_mfma_f32_16x16x32_bf16 v[44:47], v[72:75], v[100:103], v[44:47]
  v_mfma_f32_16x16x32_bf16 v[48:51], v[72:75], v[104:107], v[48:51]
  v_mfma_f32_16x16x32_bf16 v[52:55], v[72:75], v[108:111], v[52:55]
  v_mfma_f32_16x16x32_bf16 v[56:59], v[72:75], v[112:115], v[56:59]
  v_mfma_f32_16x16x32_bf16 v[60:63], v[72:75], v[116:119], v[60:63]
  v_mfma_f32_16x16x32_bf16 v[44:47], v[76:79], v[96:99], v[44:47]
  v_mfma_f32_16x16x32_bf16 v[48:51], v[76:79], v[100:103], v[48:51]
  v_mfma_f32_16x16x32_bf16 v[52:55], v[76:79], v[104:107], v[52:55]
  v_mfma_f32_16x16x32_bf16 v[56:59], v[76:79], v[108:111], v[56:59]
  v_mfma_f32_16x16x32_bf16 v[60:63], v[76:79], v[112:115], v[60:63]
  v_mfma_f32_16x16x32_bf16 v[48:51], v[80:83], v[96:99], v[48:51]
  v_mfma_f32_16x16x32_bf16 v[52:55], v[80:83], v[100:103], v[52:55]
  v_mfma_f32_16x16x32_bf16 v[56:59], v[80:83], v[104:107], v[56:59]
  v_mfma_f32_16x16x32_bf16 v[60:63], v[80:83], v[108:111], v[60:63]
  v_mfma_f32_16x16x32_bf16 v[52:55], v[84:87], v[96:99], v[52:55]
  v_mfma_f32_16x16x32_bf16 v[56:59], v[84:87], v[100:103], v[56:59]
  v_mfma_f32_16x16x32_bf16 v[60:63], v[84:87], v[104:107], v[60:63]
  v_mfma_f32_16x16x32_bf16 v[56:59], v[88:91], v[96:99], v[56:59]
  v_mfma_f32_16x16x32_bf16 v[60:63], v[88:91], v[100:103], v[60:63]
  v_mfma_f32_16x16x32_bf16 v[60:63], v[92:95], v[96:99], v[60:63]
  s_waitcnt lgkmcnt(0)
  v_mfma_f32_16x16x32_bf16 v[32:35], v[128:131], v[160:163], v[32:35]
  ds_read_b128 v[64:67], v12 offset:3728
  v_mfma_f32_16x16x32_bf16 v[36:39], v[128:131], v[164:167], v[36:39]
  ds_read_b128 v[96:99], v13 offset:128
  v_mfma_f32_16x16x32_bf16 v[40:43], v[128:131], v[168:171], v[40:43]
  ds_read_b128 v[68:71], v12 offset:3216
  v_mfma_f32_16x16x32_bf16 v[44:47], v[128:131], v[172:175], v[44:47]
  ds_read_b128 v[100:103], v13 offset:640
  v_mfma_f32_16x16x32_bf16 v[48:51], v[128:131], v[176:179], v[48:51]
  ds_read_b128 v[72:75], v12 offset:2704
  v_mfma_f32_16x16x32_bf16 v[52:55], v[128:131], v[180:183], v[52:55]
  ds_read_b128 v[104:107], v13 offset:1152
  v_mfma_f32_16x16x32_bf16 v[56:59], v[128:131], v[184:187], v[56:59]
  ds_read_b128 v[76:79], v12 offset:2192
  v_mfma_f32_16x16x32_bf16 v[60:63], v[128:131], v[188:191], v[60:63]
  ds_read_b128 v[108:111], v13 offset:1664
  v_mfma_f32_16x16x32_bf16 v[36:39], v[132:135], v[160:163], v[36:39]
  ds_read_b128 v[80:83], v12 offset:1680
  v_mfma_f32_16x16x32_bf16 v[40:43], v[132:135], v[164:167], v[40:43]
  ds_read_b128 v[112:115], v13 offset:2176
  v_mfma_f32_16x16x32_bf16 v[44:47], v[132:135], v[168:171], v[44:47]
  ds_read_b128 v[84:87], v12 offset:1168
  v_mfma_f32_16x16x32_bf16 v[48:51], v[132:135], v[172:175], v[48:51]
  ds_read_b128 v[116:119], v13 offset:2688
  v_mfma_f32_16x16x32_bf16 v[52:55], v[132:135], v[176:179], v[52:55]
  ds_read_b128 v[88:91], v12 offset:656
  v_mfma_f32_16x16x32_bf16 v[56:59], v[132:135], v[180:183], v[56:59]
  ds_read_b128 v[120:123], v13 offset:3200
  v_mfma_f32_16x16x32_bf16 v[60:63], v[132:135], v[184:187], v[60:63]
  ds_read_b128 v[92:95], v12 offset:144
  v_mfma_f32_16x16x32_bf16 v[40:43], v[136:139], v[160:163], v[40:43]
  ds_read_b128 v[124:127], v13 offset:3712
  v_mfma_f32_16x16x32_bf16 v[44:47], v[136:139], v[164:167], v[44:47]
  v_mfma_f32_16x16x32_bf16 v[48:51], v[136:139], v[168:171], v[48:51]
  v_mfma_f32_16x16x32_bf16 v[52:55], v[136:139], v[172:175], v[52:55]
  v_mfma_f32_16x16x32_bf16 v[56:59], v[136:139], v[176:179], v[56:59]
  v_mfma_f32_16x16x32_bf16 v[60:63], v[136:139], v[180:183], v[60:63]
  v_mfma_f32_16x16x32_bf16 v[44:47], v[140:143], v[160:163], v[44:47]
  v_mfma_f32_16x16x32_bf16 v[48:51], v[140:143], v[164:167], v[48:51]
  v_mfma_f32_16x16x32_bf16 v[52:55], v[140:143], v[168:171], v[52:55]
  v_mfma_f32_16x16x32_bf16 v[56:59], v[140:143], v[172:175], v[56:59]
  v_mfma_f32_16x16x32_bf16 v[60:63], v[140:143], v[176:179], v[60:63]
  v_mfma_f32_16x16x32_bf16 v[48:51], v[144:147], v[160:163], v[48:51]
  v_mfma_f32_16x16x32_bf16 v[52:55], v[144:147], v[164:167], v[52:55]
  v_mfma_f32_16x16x32_bf16 v[56:59], v[144:147], v[168:171], v[56:59]
  v_mfma_f32_16x16x32_bf16 v[60:63], v[144:147], v[172:175], v[60:63]
  v_mfma_f32_16x16x32_bf16 v[52:55], v[148:151], v[160:163], v[52:55]
  v_mfma_f32_16x16x32_bf16 v[56:59], v[148:151], v[164:167], v[56:59]
  v_mfma_f32_16x16x32_bf16 v[60:63], v[148:151], v[168:171], v[60:63]
  v_mfma_f32_16x16x32_bf16 v[56:59], v[152:155], v[160:163], v[56:59]
  v_mfma_f32_16x16x32_bf16 v[60:63], v[152:155], v[164:167], v[60:63]
  v_mfma_f32_16x16x32_bf16 v[60:63], v[156:159], v[160:163], v[60:63]
  v_add_u32 v12, 128, v12
  v_add_u32 v13, 128, v13
  s_add_u32 s37, s37, 1
  s_cmp_lt_u32 s37, 4
  s_cbranch_scc1 mega_kernel_cloop27
  s_waitcnt lgkmcnt(0)
  v_min_u32 v2, 53, v1
  v_lshlrev_b32 v2, 2, v2
  s_and_b32 s36, s2, 31
  s_mul_i32 s36, s36, 8960
  s_add_u32 s36, s36, 2624
  v_add_u32 v2, s36, v2
  global_load_dword v28, v2, s[12:13] sc1
  ds_read_b64 v[64:65], v16 offset:3584
  ds_read_b64 v[66:67], v16 offset:3072
  ds_read_b64 v[68:69], v16 offset:2560
  ds_read_b64 v[70:71], v16 offset:2048
  ds_read_b64 v[72:73], v16 offset:1536
  ds_read_b64 v[74:75], v16 offset:1024
  ds_read_b64 v[76:77], v16 offset:512
  ds_read_b64 v[78:79], v16 offset:0
  s_and_b32 s42, s15, 1
  s_lshl_b32 s43, s41, 16
  s_and_b32 s41, s41, s40
  s_cmp_eq_u32 s42, 0
  s_cselect_b32 s41, s43, s41
  s_waitcnt lgkmcnt(0)
  v_and_b32 v96, s40, v65
  v_lshlrev_b32 v97, 16, v65
  v_and_b32 v98, s40, v64
  v_lshlrev_b32 v99, 16, v64
  v_mul_f32 v96, s41, v96
  v_mul_f32 v97, s41, v97
  v_mul_f32 v98, s41, v98
  v_mul_f32 v99, s41, v99
  v_cvt_pk_bf16_f32 v100, v96, v97
  v_lshlrev_b32 v96, 16, v100
  v_and_b32 v97, s40, v100
  v_cvt_pk_bf16_f32 v101, v98, v99
  v_lshlrev_b32 v98, 16, v101
  v_and_b32 v99, s40, v101
  v_cvt_pk_bf16_f32 v100, v32, v33
  v_lshlrev_b32 v32, 16, v100
  v_and_b32 v33, s40, v100
  v_cvt_pk_bf16_f32 v101, v34, v35
  v_lshlrev_b32 v34, 16, v101
  v_and_b32 v35, s40, v101
  v_pk_add_f32 v[96:97], v[96:97], v[32:33]
  v_pk_add_f32 v[98:99], v[98:99], v[34:35]
  v_cvt_pk_bf16_f32 v102, v96, v97
  v_cvt_pk_bf16_f32 v103, v98, v99
  ds_write_b64 v15, v[102:103] offset:0
  v_and_b32 v104, s40, v67
  v_lshlrev_b32 v105, 16, v67
  v_and_b32 v106, s40, v66
  v_lshlrev_b32 v107, 16, v66
  v_mul_f32 v104, s41, v104
  v_mul_f32 v105, s41, v105
  v_mul_f32 v106, s41, v106
  v_mul_f32 v107, s41, v107
  v_cvt_pk_bf16_f32 v108, v104, v105
  v_lshlrev_b32 v104, 16, v108
  v_and_b32 v105, s40, v108
  v_cvt_pk_bf16_f32 v109, v106, v107
  v_lshlrev_b32 v106, 16, v109
  v_and_b32 v107, s40, v109
  v_cvt_pk_bf16_f32 v108, v36, v37
  v_lshlrev_b32 v36, 16, v108
  v_and_b32 v37, s40, v108
  v_cvt_pk_bf16_f32 v109, v38, v39
  v_lshlrev_b32 v38, 16, v109
  v_and_b32 v39, s40, v109
  v_pk_add_f32 v[104:105], v[104:105], v[36:37]
  v_pk_add_f32 v[106:107], v[106:107], v[38:39]
  v_cvt_pk_bf16_f32 v110, v104, v105
  v_cvt_pk_bf16_f32 v111, v106, v107
  ds_write_b64 v15, v[110:111] offset:2048
  v_and_b32 v96, s40, v69
  v_lshlrev_b32 v97, 16, v69
  v_and_b32 v98, s40, v68
  v_lshlrev_b32 v99, 16, v68
  v_mul_f32 v96, s41, v96
  v_mul_f32 v97, s41, v97
  v_mul_f32 v98, s41, v98
  v_mul_f32 v99, s41, v99
  v_cvt_pk_bf16_f32 v100, v96, v97
  v_lshlrev_b32 v96, 16, v100
  v_and_b32 v97, s40, v100
  v_cvt_pk_bf16_f32 v101, v98, v99
  v_lshlrev_b32 v98, 16, v101
  v_and_b32 v99, s40, v101
  v_cvt_pk_bf16_f32 v100, v40, v41
  v_lshlrev_b32 v40, 16, v100
  v_and_b32 v41, s40, v100
  v_cvt_pk_bf16_f32 v101, v42, v43
  v_lshlrev_b32 v42, 16, v101
  v_and_b32 v43, s40, v101
  v_pk_add_f32 v[96:97], v[96:97], v[40:41]
  v_pk_add_f32 v[98:99], v[98:99], v[42:43]
  v_cvt_pk_bf16_f32 v102, v96, v97
  v_cvt_pk_bf16_f32 v103, v98, v99
  ds_write_b64 v15, v[102:103] offset:4096
  v_and_b32 v104, s40, v71
  v_lshlrev_b32 v105, 16, v71
  v_and_b32 v106, s40, v70
  v_lshlrev_b32 v107, 16, v70
  v_mul_f32 v104, s41, v104
  v_mul_f32 v105, s41, v105
  v_mul_f32 v106, s41, v106
  v_mul_f32 v107, s41, v107
  v_cvt_pk_bf16_f32 v108, v104, v105
  v_lshlrev_b32 v104, 16, v108
  v_and_b32 v105, s40, v108
  v_cvt_pk_bf16_f32 v109, v106, v107
  v_lshlrev_b32 v106, 16, v109
  v_and_b32 v107, s40, v109
  v_cvt_pk_bf16_f32 v108, v44, v45
  v_lshlrev_b32 v44, 16, v108
  v_and_b32 v45, s40, v108
  v_cvt_pk_bf16_f32 v109, v46, v47
  v_lshlrev_b32 v46, 16, v109
  v_and_b32 v47, s40, v109
  v_pk_add_f32 v[104:105], v[104:105], v[44:45]
  v_pk_add_f32 v[106:107], v[106:107], v[46:47]
  v_cvt_pk_bf16_f32 v110, v104, v105
  v_cvt_pk_bf16_f32 v111, v106, v107
  ds_write_b64 v15, v[110:111] offset:6144
  v_and_b32 v96, s40, v73
  v_lshlrev_b32 v97, 16, v73
  v_and_b32 v98, s40, v72
  v_lshlrev_b32 v99, 16, v72
  v_mul_f32 v96, s41, v96
  v_mul_f32 v97, s41, v97
  v_mul_f32 v98, s41, v98
  v_mul_f32 v99, s41, v99
  v_cvt_pk_bf16_f32 v100, v96, v97
  v_lshlrev_b32 v96, 16, v100
  v_and_b32 v97, s40, v100
  v_cvt_pk_bf16_f32 v101, v98, v99
  v_lshlrev_b32 v98, 16, v101
  v_and_b32 v99, s40, v101
  v_cvt_pk_bf16_f32 v100, v48, v49
  v_lshlrev_b32 v48, 16, v100
  v_and_b32 v49, s40, v100
  v_cvt_pk_bf16_f32 v101, v50, v51
  v_lshlrev_b32 v50, 16, v101
  v_and_b32 v51, s40, v101
  v_pk_add_f32 v[96:97], v[96:97], v[48:49]
  v_pk_add_f32 v[98:99], v[98:99], v[50:51]
  v_cvt_pk_bf16_f32 v102, v96, v97
  v_cvt_pk_bf16_f32 v103, v98, v99
  ds_write_b64 v15, v[102:103] offset:8192
  v_and_b32 v104, s40, v75
  v_lshlrev_b32 v105, 16, v75
  v_and_b32 v106, s40, v74
  v_lshlrev_b32 v107, 16, v74
  v_mul_f32 v104, s41, v104
  v_mul_f32 v105, s41, v105
  v_mul_f32 v106, s41, v106
  v_mul_f32 v107, s41, v107
  v_cvt_pk_bf16_f32 v108, v104, v105
  v_lshlrev_b32 v104, 16, v108
  v_and_b32 v105, s40, v108
  v_cvt_pk_bf16_f32 v109, v106, v107
  v_lshlrev_b32 v106, 16, v109
  v_and_b32 v107, s40, v109
  v_cvt_pk_bf16_f32 v108, v52, v53
  v_lshlrev_b32 v52, 16, v108
  v_and_b32 v53, s40, v108
  v_cvt_pk_bf16_f32 v109, v54, v55
  v_lshlrev_b32 v54, 16, v109
  v_and_b32 v55, s40, v109
  v_pk_add_f32 v[104:105], v[104:105], v[52:53]
  v_pk_add_f32 v[106:107], v[106:107], v[54:55]
  v_cvt_pk_bf16_f32 v110, v104, v105
  v_cvt_pk_bf16_f32 v111, v106, v107
  ds_write_b64 v15, v[110:111] offset:10240
  v_and_b32 v96, s40, v77
  v_lshlrev_b32 v97, 16, v77
  v_and_b32 v98, s40, v76
  v_lshlrev_b32 v99, 16, v76
  v_mul_f32 v96, s41, v96
  v_mul_f32 v97, s41, v97
  v_mul_f32 v98, s41, v98
  v_mul_f32 v99, s41, v99
  v_cvt_pk_bf16_f32 v100, v96, v97
  v_lshlrev_b32 v96, 16, v100
  v_and_b32 v97, s40, v100
  v_cvt_pk_bf16_f32 v101, v98, v99
  v_lshlrev_b32 v98, 16, v101
  v_and_b32 v99, s40, v101
  v_cvt_pk_bf16_f32 v100, v56, v57
  v_lshlrev_b32 v56, 16, v100
  v_and_b32 v57, s40, v100
  v_cvt_pk_bf16_f32 v101, v58, v59
  v_lshlrev_b32 v58, 16, v101
  v_and_b32 v59, s40, v101
  v_pk_add_f32 v[96:97], v[96:97], v[56:57]
  v_pk_add_f32 v[98:99], v[98:99], v[58:59]
  v_cvt_pk_bf16_f32 v102, v96, v97
  v_cvt_pk_bf16_f32 v103, v98, v99
  ds_write_b64 v15, v[102:103] offset:12288
  v_and_b32 v104, s40, v79
  v_lshlrev_b32 v105, 16, v79
  v_and_b32 v106, s40, v78
  v_lshlrev_b32 v107, 16, v78
  v_mul_f32 v104, s41, v104
  v_mul_f32 v105, s41, v105
  v_mul_f32 v106, s41, v106
  v_mul_f32 v107, s41, v107
  v_cvt_pk_bf16_f32 v108, v104, v105
  v_lshlrev_b32 v104, 16, v108
  v_and_b32 v105, s40, v108
  v_cvt_pk_bf16_f32 v109, v106, v107
  v_lshlrev_b32 v106, 16, v109
  v_and_b32 v107, s40, v109
  v_cvt_pk_bf16_f32 v108, v60, v61
  v_lshlrev_b32 v60, 16, v108
  v_and_b32 v61, s40, v108
  v_cvt_pk_bf16_f32 v109, v62, v63
  v_lshlrev_b32 v62, 16, v109
  v_and_b32 v63, s40, v109
  v_pk_add_f32 v[104:105], v[104:105], v[60:61]
  v_pk_add_f32 v[106:107], v[106:107], v[62:63]
  v_cvt_pk_bf16_f32 v110, v104, v105
  v_cvt_pk_bf16_f32 v111, v106, v107
  ds_write_b64 v15, v[110:111] offset:14336
  s_waitcnt vmcnt(0)
  v_cmp_ne_u32 vcc, s3, v28
  s_mov_b32 s47, 0
  s_nop 3
  s_cbranch_vccnz mega_kernel_nomodp26
  s_add_u32 s56, s10, 13107200
  s_addc_u32 s57, s11, 0
  s_mov_b32 s58, 9216
  s_mov_b32 s59, 0x00020000
  s_movk_i32 s36, 4096
  s_movk_i32 s37, 8192
  v_lshlrev_b32 v29, 4, v1
  buffer_load_dwordx4 a[0:3], v29, s[56:59], 0 offen offset:0 sc1
  buffer_load_dwordx4 a[4:7], v29, s[56:59], 0 offen offset:1024 sc1
  buffer_load_dwordx4 a[8:11], v29, s[56:59], 0 offen offset:2048 sc1
  buffer_load_dwordx4 a[12:15], v29, s[56:59], 0 offen offset:3072 sc1
  buffer_load_dwordx4 a[16:19], v29, s[56:59], s36 offen offset:0 sc1
  buffer_load_dwordx4 a[20:23], v29, s[56:59], s36 offen offset:1024 sc1
  buffer_load_dwordx4 a[24:27], v29, s[56:59], s36 offen offset:2048 sc1
  buffer_load_dwordx4 a[28:31], v29, s[56:59], s36 offen offset:3072 sc1
  buffer_load_dwordx4 a[32:35], v29, s[56:59], s37 offen offset:0 sc1
  s_mov_b32 s47, 1
mega_kernel_nomodp26:
  v_lshlrev_b32 v4, 4, v0
  v_add_u32 v4, 104448, v4
  v_lshrrev_b32 v5, 3, v0
  v_mul_u32_u24 v5, 18432, v5
  v_and_b32 v6, 7, v0
  v_lshl_add_u32 v5, v6, 4, v5
  s_lshl_b32 s36, s2, 7
  s_waitcnt lgkmcnt(0)
  s_barrier
  ds_read_b128 v[32:35], v4 offset:0
  ds_read_b128 v[36:39], v4 offset:4096
  ds_read_b128 v[40:43], v4 offset:8192
  ds_read_b128 v[44:47], v4 offset:12288
  s_waitcnt lgkmcnt(3)
  buffer_store_dwordx4 v[32:35], v5, s[32:35], s36 offen sc1
  s_add_u32 s36, s36, 589824
  s_waitcnt lgkmcnt(2)
  buffer_store_dwordx4 v[36:39], v5, s[32:35], s36 offen sc1
  s_add_u32 s36, s36, 589824
  s_waitcnt lgkmcnt(1)
  buffer_store_dwordx4 v[40:43], v5, s[32:35], s36 offen sc1
  s_add_u32 s36, s36, 589824
  s_waitcnt lgkmcnt(0)
  buffer_store_dwordx4 v[44:47], v5, s[32:35], s36 offen sc1
  s_add_u32 s36, s36, 589824
  s_lshl_b32 s37, s2, 2
  s_add_u32 s37, s37, 2048
  s_waitcnt vmcnt(0) lgkmcnt(0)
  s_barrier
  s_cmp_lg_u32 s18, 0
  s_cbranch_scc1 mega_kernel_pubskip28
  s_mov_b64 exec, 4294967295
  v_mul_u32_u24 v2, 8960, v1
  v_add_u32 v2, s37, v2
  v_mov_b32 v3, s3
  global_store_dword v2, v3, s[12:13] sc1
  s_mov_b64 exec, -1
mega_kernel_pubskip28:
  s_branch mega_kernel_p1done20
mega_kernel_p1pf19:
  s_cmp_lt_u32 s2, 144
  s_cbranch_scc1 mega_kernel_noct29
  s_cmp_ge_u32 s2, 152
  s_cbranch_scc1 mega_kernel_noct29
  s_getpc_b64 s[36:37]
  s_add_u32 s36, s36, code_begin@rel32@lo+4
  s_addc_u32 s37, s37, code_begin@rel32@hi+12
  v_lshlrev_b32 v2, 7, v0
  v_min_u32 v3, code_end-code_begin-4, v2
  v_add_u32 v2, 32768, v2
  v_min_u32 v2, code_end-code_begin-4, v2
  global_load_dword v254, v3, s[36:37]
  global_load_dword v255, v2, s[36:37]
mega_kernel_noct29:
  s_mov_b32 s20, s48
  s_mov_b32 s21, s49
  s_mov_b32 s22, 5308416
  s_mov_b32 s23, 0x00020000
  s_sub_u32 s38, s2, 144
  s_lshl_b32 s38, s38, 2
  s_add_u32 s38, s38, s18
  s_lshl_b32 s38, s38, 13
  s_add_u32 s39, s38, 3670016
  v_lshlrev_b32 v4, 7, v1
  buffer_load_dword v254, v4, s[20:23], s38 offen
  buffer_load_dword v255, v4, s[20:23], s39 offen
  s_cmp_lg_u32 s18, 0
  s_cbranch_scc1 mega_kernel_wskip30
  v_min_u32 v2, 21, v1
  v_lshlrev_b32 v2, 2, v2
  v_add_u32 v2, 0, v2
  s_and_b32 s36, s2, 31
  s_mul_i32 s36, s36, 8960
  v_add_u32 v2, s36, v2
  s_mov_b32 s36, 0
mega_kernel_poll31:
  global_load_dword v28, v2, s[12:13] sc1
  s_add_u32 s36, s36, 1
  s_waitcnt vmcnt(0)
  v_cmp_ne_u32 vcc, s3, v28
  s_cmp_ge_u32 s36, 1048576
  s_cbranch_scc1 mega_kernel_pdone32
  s_cbranch_vccz mega_kernel_pdone32
  s_sleep 16
  s_branch mega_kernel_poll31
mega_kernel_pdone32:
mega_kernel_wskip30:
  s_barrier
  s_branch mega_kernel_ln121
mega_kernel_p1pf222:
  s_mov_b32 s42, s38
  s_mov_b32 s38, 0
mega_kernel_mpoll33:
  v_min_u32 v2, 53, v1
  v_lshlrev_b32 v2, 2, v2
  s_and_b32 s36, s2, 31
  s_mul_i32 s36, s36, 8960
  s_add_u32 s36, s36, 2624
  v_add_u32 v2, s36, v2
  global_load_dword v28, v2, s[12:13] sc1
  s_add_u32 s38, s38, 1
  s_waitcnt vmcnt(0)
  v_cmp_ne_u32 vcc, s3, v28
  s_cmp_ge_u32 s38, 1048576
  s_cbranch_scc1 mega_kernel_mdone34
  s_cbranch_vccz mega_kernel_mdone34
  s_sleep 8
  s_branch mega_kernel_mpoll33
mega_kernel_mdone34:
  s_add_u32 s56, s10, 13107200
  s_addc_u32 s57, s11, 0
  s_mov_b32 s58, 9216
  s_mov_b32 s59, 0x00020000
  s_movk_i32 s36, 4096
  s_movk_i32 s37, 8192
  v_lshlrev_b32 v29, 4, v1
  buffer_load_dwordx4 a[0:3], v29, s[56:59], 0 offen offset:0 sc1
  buffer_load_dwordx4 a[4:7], v29, s[56:59], 0 offen offset:1024 sc1
  buffer_load_dwordx4 a[8:11], v29, s[56:59], 0 offen offset:2048 sc1
  buffer_load_dwordx4 a[12:15], v29, s[56:59], 0 offen offset:3072 sc1
  buffer_load_dwordx4 a[16:19], v29, s[56:59], s36 offen offset:0 sc1
  buffer_load_dwordx4 a[20:23], v29, s[56:59], s36 offen offset:1024 sc1
  buffer_load_dwordx4 a[24:27], v29, s[56:59], s36 offen offset:2048 sc1
  buffer_load_dwordx4 a[28:31], v29, s[56:59], s36 offen offset:3072 sc1
  buffer_load_dwordx4 a[32:35], v29, s[56:59], s37 offen offset:0 sc1
  s_mov_b32 s47, 1
  s_mov_b32 s38, s42
  s_mov_b32 s24, s50
  s_mov_b32 s25, s51
  s_mov_b32 s26, 5308416
  s_mov_b32 s27, 0x00020000
  s_mov_b32 s28, s8
  s_mov_b32 s29, s9
  s_mov_b32 s30, 5308416
  s_mov_b32 s31, 0x00020000
  s_add_u32 s32, s10, 13631488
  s_addc_u32 s33, s11, 0
  s_mov_b32 s34, 18874368
  s_mov_b32 s35, 0x00020000
  buffer_load_dword v254, v4, s[24:27], s38 offen
  buffer_load_dword v255, v4, s[24:27], s39 offen
  s_sub_u32 s36, s2, 144
  s_lshl_b32 s36, s36, 2
  s_add_u32 s36, s36, s18
  s_lshl_b32 s36, s36, 2
  v_lshrrev_b32 v5, 4, v1
  v_add_u32 v5, s36, v5
  v_mul_u32_u24 v5, 18432, v5
  v_and_b32 v6, 15, v1
  v_lshl_add_u32 v5, v6, 7, v5
  v_add_u32 v5, 16384, v5
  buffer_load_dword v254, v5, s[32:35], 0 offen sc1
  s_sub_u32 s36, s2, 144
  s_lshr_b32 s36, s36, 3
  s_lshl_b32 s36, s36, 2
  s_add_u32 s36, s36, s18
  s_lshl_b32 s36, s36, 1
  v_lshrrev_b32 v5, 5, v1
  v_add_u32 v5, s36, v5
  v_and_b32 v6, 31, v1
  v_lshlrev_b32 v6, 7, v6
  s_bfe_u32 s36, s2, 0x10002
  s_mul_i32 s36, s36, 9437184
  s_and_b32 s37, s2, 3
  s_mul_i32 s37, s37, 36864
  s_add_u32 s36, s36, s37
  v_add_u32 v6, s36, v6
  s_movk_i32 s37, 7282
  s_mov_b32 s41, 110592
mega_kernel_p1done20:
  s_waitcnt lgkmcnt(0)
  s_mov_b32 s4, s48
  s_mov_b32 s5, s49
  s_mov_b32 s6, s50
  s_mov_b32 s7, s51
  s_and_b32 s16, s2, 7
  s_lshr_b32 s17, s2, 3
  s_lshr_b32 s19, s18, 1
  s_and_b32 s20, s18, 1
  s_and_b32 s53, s17, 3
  s_and_b32 s62, s16, 3
  s_lshr_b32 s37, s16, 2
  s_lshl_b32 s52, s62, 1
  s_bfe_u32 s36, s17, 0x10002
  s_add_u32 s52, s52, s36
  s_lshl_b32 s22, s37, 2
  s_lshr_b32 s36, s17, 3
  s_add_u32 s22, s22, s36
  s_lshl_b32 s23, s22, 4
  s_lshl_b32 s36, s18, 2
  s_add_u32 s23, s23, s36
  s_lshl_b32 s63, s37, 3
  s_lshr_b32 s36, s17, 2
  s_add_u32 s63, s63, s36
  s_lshl_b32 s64, s63, 3
  s_lshl_b32 s37, s18, 1
  s_add_u32 s64, s64, s37
  s_mul_i32 s36, s23, 18432
  v_lshl_add_u32 v4, v1, 4, s36
  v_add_u32 v5, 18432, v4
  v_add_u32 v6, 18432, v5
  v_add_u32 v7, 18432, v6
  s_mul_i32 s38, s52, 1152
  s_mul_i32 s37, s20, 294912
  s_add_u32 s38, s38, s37
  s_lshl_b32 s37, s53, 8
  s_add_u32 s39, s38, s37
  s_lshl_b32 s37, s53, 5
  s_add_u32 s41, s38, s37
  s_add_u32 s41, s41, 1024
  s_movk_i32 s37, 9216
  v_lshrrev_b32 v22, 4, v1
  v_and_b32 v23, 15, v1
  v_mul_lo_u32 v24, v22, s37
  v_add_u32 v24, s39, v24
  v_lshlrev_b32 v25, 1, v22
  v_xor_b32 v25, v23, v25
  v_lshl_add_u32 v8, v25, 4, v24
  v_xor_b32 v25, 8, v25
  v_lshl_add_u32 v9, v25, 4, v24
  v_add_u32 v9, 36864, v9
  v_lshrrev_b32 v22, 1, v1
  v_mul_lo_u32 v24, v22, s37
  v_and_b32 v23, 1, v1
  v_lshl_add_u32 v24, v23, 4, v24
  v_add_u32 v10, s41, v24
  s_mul_i32 s42, s19, 18432
  s_lshl_b32 s36, s20, 10
  s_add_u32 s43, s42, s36
  s_add_u32 s43, s43, 16384
  s_lshl_b32 s36, s20, 13
  s_add_u32 s42, s42, s36
  v_lshrrev_b32 v22, 2, v1
  v_and_b32 v23, 3, v1
  v_lshlrev_b32 v23, 3, v23
  v_lshl_add_u32 v24, v22, 8, v23
  v_and_b32 v25, 7, v22
  v_xor_b32 v26, 0, v25
  v_lshl_add_u32 v12, v26, 5, v24
  v_xor_b32 v26, 1, v25
  v_lshl_add_u32 v13, v26, 5, v24
  v_xor_b32 v26, 2, v25
  v_lshl_add_u32 v14, v26, 5, v24
  v_xor_b32 v26, 3, v25
  v_lshl_add_u32 v15, v26, 5, v24
  v_xor_b32 v26, 4, v25
  v_lshl_add_u32 v16, v26, 5, v24
  v_xor_b32 v26, 5, v25
  v_lshl_add_u32 v17, v26, 5, v24
  v_xor_b32 v26, 6, v25
  v_lshl_add_u32 v18, v26, 5, v24
  v_xor_b32 v26, 7, v25
  v_lshl_add_u32 v19, v26, 5, v24
  v_lshl_add_u32 v20, v22, 5, v23
  v_add_u32 v20, 16384, v20
  s_mov_b32 s54, 0
  s_mov_b32 s55, 0
  s_mov_b32 s46, 0
  s_mov_b32 s65, 73728
  s_mov_b32 s66, 589824
  s_cmp_eq_u32 s19, 0
  s_cselect_b32 s14, s4, s6
  s_cselect_b32 s15, s5, s7
  s_mov_b32 s24, s14
  s_mov_b32 s25, s15
  s_mov_b32 s26, 5308416
  s_mov_b32 s27, 0x00020000
  s_add_u32 s28, s10, 5242880
  s_addc_u32 s29, s11, 0
  s_mov_b32 s30, 2359296
  s_mov_b32 s31, 0x00020000
  s_cmp_eq_u32 s47, 1
  s_cbranch_scc1 mega_kernel_havemodp35
  s_mov_b32 s38, 0
mega_kernel_mpoll37:
  v_min_u32 v2, 53, v1
  v_lshlrev_b32 v2, 2, v2
  s_and_b32 s36, s2, 31
  s_mul_i32 s36, s36, 8960
  s_add_u32 s36, s36, 2624
  v_add_u32 v2, s36, v2
  global_load_dword v28, v2, s[12:13] sc1
  s_add_u32 s38, s38, 1
  s_waitcnt vmcnt(0)
  v_cmp_ne_u32 vcc, s3, v28
  s_cmp_ge_u32 s38, 1048576
  s_cbranch_scc1 mega_kernel_mdone38
  s_cbranch_vccz mega_kernel_mdone38
  s_sleep 8
  s_branch mega_kernel_mpoll37
mega_kernel_mdone38:
  s_add_u32 s56, s10, 13107200
  s_addc_u32 s57, s11, 0
  s_mov_b32 s58, 9216
  s_mov_b32 s59, 0x00020000
  s_movk_i32 s36, 4096
  s_movk_i32 s37, 8192
  v_lshlrev_b32 v29, 4, v1
  buffer_load_dwordx4 a[0:3], v29, s[56:59], 0 offen offset:0 sc1
  buffer_load_dwordx4 a[4:7], v29, s[56:59], 0 offen offset:1024 sc1
  buffer_load_dwordx4 a[8:11], v29, s[56:59], 0 offen offset:2048 sc1
  buffer_load_dwordx4 a[12:15], v29, s[56:59], 0 offen offset:3072 sc1
  buffer_load_dwordx4 a[16:19], v29, s[56:59], s36 offen offset:0 sc1
  buffer_load_dwordx4 a[20:23], v29, s[56:59], s36 offen offset:1024 sc1
  buffer_load_dwordx4 a[24:27], v29, s[56:59], s36 offen offset:2048 sc1
  buffer_load_dwordx4 a[28:31], v29, s[56:59], s36 offen offset:3072 sc1
  buffer_load_dwordx4 a[32:35], v29, s[56:59], s37 offen offset:0 sc1
  s_mov_b32 s47, 1
mega_kernel_havemodp35:
  s_lshr_b32 s38, s2, 1
  s_mul_i32 s38, s38, 18432
  s_and_b32 s36, s2, 1
  s_lshl_b32 s36, s36, 4
  s_add_u32 s38, s38, s36
  s_lshl_b32 s36, s18, 12
  s_add_u32 s38, s38, s36
  s_add_u32 s39, s38, 2048
  v_lshlrev_b32 v141, 5, v1
  v_lshlrev_b32 v142, 4, v1
  s_lshl_b32 s36, s18, 2
  s_add_u32 s36, s36, 110592
  v_add_u32 v142, s36, v142
  v_lshrrev_b32 v143, 5, v1
  v_lshlrev_b32 v143, 9, v143
  v_bfe_u32 v144, v1, 2, 2
  v_lshl_add_u32 v143, v144, 7, v143
  v_bfe_u32 v144, v1, 4, 1
  v_lshl_add_u32 v143, v144, 3, v143
  v_and_b32 v144, 3, v1
  v_lshl_add_u32 v143, v144, 1, v143
  s_lshl_b32 s36, s18, 5
  s_add_u32 s36, s36, 119808
  v_add_u32 v143, s36, v143
  s_cmp_ge_u32 s2, 144
  s_cbranch_scc1 mega_kernel_waitmodp36
  s_waitcnt vmcnt(0)
mega_kernel_waitmodp36:
  s_waitcnt vmcnt(3)
  v_accvgpr_read_b32 v100, a0
  v_accvgpr_read_b32 v101, a1
  v_accvgpr_read_b32 v102, a2
  v_accvgpr_read_b32 v104, a4
  v_accvgpr_read_b32 v105, a5
  v_accvgpr_read_b32 v106, a6
  v_accvgpr_read_b32 v108, a8
  v_accvgpr_read_b32 v109, a9
  v_accvgpr_read_b32 v110, a10
  v_accvgpr_read_b32 v112, a12
  v_accvgpr_read_b32 v113, a13
  v_accvgpr_read_b32 v114, a14
  v_accvgpr_read_b32 v116, a16
  v_accvgpr_read_b32 v117, a17
  v_accvgpr_read_b32 v118, a18
  v_accvgpr_read_b32 v120, a20
  v_accvgpr_read_b32 v121, a21
  v_accvgpr_read_b32 v122, a22
  v_accvgpr_read_b32 v124, a24
  v_accvgpr_read_b32 v125, a25
  v_accvgpr_read_b32 v126, a26
  v_accvgpr_read_b32 v128, a28
  v_accvgpr_read_b32 v129, a29
  v_accvgpr_read_b32 v130, a30
  v_accvgpr_read_b32 v132, a32
  v_accvgpr_read_b32 v133, a33
  v_accvgpr_read_b32 v134, a34
  v_and_b32 v86, s40, v100
  v_pk_mul_f32 v[218:219], v[218:219], v[86:87] op_sel_hi:[1,0]
  v_and_b32 v88, s40, v104
  v_pk_mul_f32 v[220:221], v[220:221], v[88:89] op_sel_hi:[1,0]
  v_and_b32 v86, s40, v108
  v_pk_mul_f32 v[222:223], v[222:223], v[86:87] op_sel_hi:[1,0]
  v_and_b32 v88, s40, v112
  v_pk_mul_f32 v[224:225], v[224:225], v[88:89] op_sel_hi:[1,0]
  v_and_b32 v86, s40, v116
  v_pk_mul_f32 v[226:227], v[226:227], v[86:87] op_sel_hi:[1,0]
  v_and_b32 v88, s40, v120
  v_pk_mul_f32 v[228:229], v[228:229], v[88:89] op_sel_hi:[1,0]
  v_and_b32 v86, s40, v124
  v_pk_mul_f32 v[230:231], v[230:231], v[86:87] op_sel_hi:[1,0]
  v_and_b32 v88, s40, v128
  v_pk_mul_f32 v[232:233], v[232:233], v[88:89] op_sel_hi:[1,0]
  v_and_b32 v86, s40, v132
  v_pk_mul_f32 v[234:235], v[234:235], v[86:87] op_sel_hi:[1,0]
  v_cvt_pk_bf16_f32 v86, v218, v219
  v_lshlrev_b32 v218, 16, v86
  v_and_b32 v219, s40, v86
  v_cvt_pk_bf16_f32 v87, v220, v221
  v_lshlrev_b32 v220, 16, v87
  v_and_b32 v221, s40, v87
  v_cvt_pk_bf16_f32 v88, v222, v223
  v_lshlrev_b32 v222, 16, v88
  v_and_b32 v223, s40, v88
  v_cvt_pk_bf16_f32 v89, v224, v225
  v_lshlrev_b32 v224, 16, v89
  v_and_b32 v225, s40, v89
  v_cvt_pk_bf16_f32 v86, v226, v227
  v_lshlrev_b32 v226, 16, v86
  v_and_b32 v227, s40, v86
  v_cvt_pk_bf16_f32 v87, v228, v229
  v_lshlrev_b32 v228, 16, v87
  v_and_b32 v229, s40, v87
  v_cvt_pk_bf16_f32 v88, v230, v231
  v_lshlrev_b32 v230, 16, v88
  v_and_b32 v231, s40, v88
  v_cvt_pk_bf16_f32 v89, v232, v233
  v_lshlrev_b32 v232, 16, v89
  v_and_b32 v233, s40, v89
  v_cvt_pk_bf16_f32 v86, v234, v235
  v_lshlrev_b32 v234, 16, v86
  v_and_b32 v235, s40, v86
  v_lshlrev_b32 v86, 16, v100
  v_pk_add_f32 v[218:219], v[218:219], v[86:87] op_sel_hi:[1,0]
  v_lshlrev_b32 v88, 16, v104
  v_pk_add_f32 v[220:221], v[220:221], v[88:89] op_sel_hi:[1,0]
  v_lshlrev_b32 v86, 16, v108
  v_pk_add_f32 v[222:223], v[222:223], v[86:87] op_sel_hi:[1,0]
  v_lshlrev_b32 v88, 16, v112
  v_pk_add_f32 v[224:225], v[224:225], v[88:89] op_sel_hi:[1,0]
  v_lshlrev_b32 v86, 16, v116
  v_pk_add_f32 v[226:227], v[226:227], v[86:87] op_sel_hi:[1,0]
  v_lshlrev_b32 v88, 16, v120
  v_pk_add_f32 v[228:229], v[228:229], v[88:89] op_sel_hi:[1,0]
  v_lshlrev_b32 v86, 16, v124
  v_pk_add_f32 v[230:231], v[230:231], v[86:87] op_sel_hi:[1,0]
  v_lshlrev_b32 v88, 16, v128
  v_pk_add_f32 v[232:233], v[232:233], v[88:89] op_sel_hi:[1,0]
  v_lshlrev_b32 v86, 16, v132
  v_pk_add_f32 v[234:235], v[234:235], v[86:87] op_sel_hi:[1,0]
  v_cvt_pk_bf16_f32 v86, v218, v219
  v_lshlrev_b32 v218, 16, v86
  v_and_b32 v219, s40, v86
  v_cvt_pk_bf16_f32 v87, v220, v221
  v_lshlrev_b32 v220, 16, v87
  v_and_b32 v221, s40, v87
  v_cvt_pk_bf16_f32 v88, v222, v223
  v_lshlrev_b32 v222, 16, v88
  v_and_b32 v223, s40, v88
  v_cvt_pk_bf16_f32 v89, v224, v225
  v_lshlrev_b32 v224, 16, v89
  v_and_b32 v225, s40, v89
  v_cvt_pk_bf16_f32 v86, v226, v227
  v_lshlrev_b32 v226, 16, v86
  v_and_b32 v227, s40, v86
  v_cvt_pk_bf16_f32 v87, v228, v229
  v_lshlrev_b32 v228, 16, v87
  v_and_b32 v229, s40, v87
  v_cvt_pk_bf16_f32 v88, v230, v231
  v_lshlrev_b32 v230, 16, v88
  v_and_b32 v231, s40, v88
  v_cvt_pk_bf16_f32 v89, v232, v233
  v_lshlrev_b32 v232, 16, v89
  v_and_b32 v233, s40, v89
  v_cvt_pk_bf16_f32 v86, v234, v235
  v_lshlrev_b32 v234, 16, v86
  v_and_b32 v235, s40, v86
  s_cmp_lt_u32 s2, 248
  s_cbranch_scc1 mega_kernel_noct39
  s_cmp_ge_u32 s2, 256
  s_cbranch_scc1 mega_kernel_noct39
  s_getpc_b64 s[36:37]
  s_add_u32 s36, s36, code_begin@rel32@lo+4
  s_addc_u32 s37, s37, code_begin@rel32@hi+12
  v_lshlrev_b32 v2, 7, v0
  v_min_u32 v3, code_end-code_begin-4, v2
  v_add_u32 v2, 32768, v2
  v_min_u32 v2, code_end-code_begin-4, v2
  global_load_dword v254, v3, s[36:37]
  global_load_dword v255, v2, s[36:37]
mega_kernel_noct39:
  s_cmp_lg_u32 s18, 0
  s_cbranch_scc1 mega_kernel_wskip40
  v_min_u32 v2, 35, v1
  v_lshlrev_b32 v2, 4, v2
  v_add_u32 v2, 2048, v2
  s_and_b32 s36, s2, 31
  s_mul_i32 s36, s36, 8960
  v_add_u32 v2, s36, v2
  s_mov_b32 s36, 0
mega_kernel_poll41:
  global_load_dwordx4 v[28:31], v2, s[12:13] sc1
  s_add_u32 s36, s36, 1
  s_waitcnt vmcnt(0)
  v_xor_b32 v28, s3, v28
  v_xor_b32 v29, s3, v29
  v_xor_b32 v30, s3, v30
  v_xor_b32 v31, s3, v31
  v_or3_b32 v28, v28, v29, v30
  v_or_b32 v28, v28, v31
  v_cmp_ne_u32 vcc, 0, v28
  s_cmp_ge_u32 s36, 1048576
  s_cbranch_scc1 mega_kernel_pdone42
  s_cbranch_vccz mega_kernel_pdone42
  s_sleep 12
  s_branch mega_kernel_poll41
mega_kernel_pdone42:
mega_kernel_wskip40:
  s_barrier
  s_lshl_b32 s37, s18, 11
  s_add_u32 m0, s37, 110592
  s_nop 0
  buffer_load_dwordx4 v141, s[28:31], s38 offen sc1 lds
  s_add_u32 m0, s37, 111616
  s_nop 0
  buffer_load_dwordx4 v141, s[28:31], s39 offen sc1 lds
  s_cmp_lg_u32 s18, 0
  s_cbranch_scc1 mega_kernel_no943
  s_add_u32 s38, s38, 16384
  s_mov_b32 m0, 118784
  s_nop 0
  buffer_load_dwordx4 v141, s[28:31], s38 offen sc1 lds
mega_kernel_no943:
  s_add_u32 s28, s10, 7864320
  s_addc_u32 s29, s11, 0
  s_mov_b32 s30, 2359296
  s_mov_b32 s31, 0x00020000
  s_add_u32 s32, s10, 10485760
  s_addc_u32 s33, s11, 0
  s_mov_b32 s34, 2359296
  s_mov_b32 s35, 0x00020000
  s_waitcnt vmcnt(0)
  s_barrier
  ds_read_b32 v50, v142 offset:0
  ds_read_b32 v51, v142 offset:1024
  ds_read_b32 v52, v142 offset:2048
  ds_read_b32 v53, v142 offset:3072
  ds_read_b32 v54, v142 offset:4096
  ds_read_b32 v55, v142 offset:5120
  ds_read_b32 v56, v142 offset:6144
  ds_read_b32 v57, v142 offset:7168
  ds_read_b32 v58, v142 offset:8192
  s_waitcnt lgkmcnt(8)
  v_lshlrev_b32 v86, 16, v50
  v_and_b32 v87, s40, v50
  v_pk_mul_f32 v[218:219], v[218:219], v[86:87]
  s_waitcnt lgkmcnt(7)
  v_lshlrev_b32 v88, 16, v51
  v_and_b32 v89, s40, v51
  v_pk_mul_f32 v[220:221], v[220:221], v[88:89]
  s_waitcnt lgkmcnt(6)
  v_lshlrev_b32 v86, 16, v52
  v_and_b32 v87, s40, v52
  v_pk_mul_f32 v[222:223], v[222:223], v[86:87]
  s_waitcnt lgkmcnt(5)
  v_lshlrev_b32 v88, 16, v53
  v_and_b32 v89, s40, v53
  v_pk_mul_f32 v[224:225], v[224:225], v[88:89]
  s_waitcnt lgkmcnt(4)
  v_lshlrev_b32 v86, 16, v54
  v_and_b32 v87, s40, v54
  v_pk_mul_f32 v[226:227], v[226:227], v[86:87]
  s_waitcnt lgkmcnt(3)
  v_lshlrev_b32 v88, 16, v55
  v_and_b32 v89, s40, v55
  v_pk_mul_f32 v[228:229], v[228:229], v[88:89]
  s_waitcnt lgkmcnt(2)
  v_lshlrev_b32 v86, 16, v56
  v_and_b32 v87, s40, v56
  v_pk_mul_f32 v[230:231], v[230:231], v[86:87]
  s_waitcnt lgkmcnt(1)
  v_lshlrev_b32 v88, 16, v57
  v_and_b32 v89, s40, v57
  v_pk_mul_f32 v[232:233], v[232:233], v[88:89]
  s_waitcnt lgkmcnt(0)
  v_lshlrev_b32 v86, 16, v58
  v_and_b32 v87, s40, v58
  v_pk_mul_f32 v[234:235], v[234:235], v[86:87]
  v_cvt_pk_bf16_f32 v86, v218, v219
  v_lshlrev_b32 v218, 16, v86
  v_and_b32 v219, s40, v86
  v_cvt_pk_bf16_f32 v87, v220, v221
  v_lshlrev_b32 v220, 16, v87
  v_and_b32 v221, s40, v87
  v_cvt_pk_bf16_f32 v88, v222, v223
  v_lshlrev_b32 v222, 16, v88
  v_and_b32 v223, s40, v88
  v_cvt_pk_bf16_f32 v89, v224, v225
  v_lshlrev_b32 v224, 16, v89
  v_and_b32 v225, s40, v89
  v_cvt_pk_bf16_f32 v86, v226, v227
  v_lshlrev_b32 v226, 16, v86
  v_and_b32 v227, s40, v86
  v_cvt_pk_bf16_f32 v87, v228, v229
  v_lshlrev_b32 v228, 16, v87
  v_and_b32 v229, s40, v87
  v_cvt_pk_bf16_f32 v88, v230, v231
  v_lshlrev_b32 v230, 16, v88
  v_and_b32 v231, s40, v88
  v_cvt_pk_bf16_f32 v89, v232, v233
  v_lshlrev_b32 v232, 16, v89
  v_and_b32 v233, s40, v89
  v_cvt_pk_bf16_f32 v86, v234, v235
  v_lshlrev_b32 v234, 16, v86
  v_and_b32 v235, s40, v86
  s_add_u32 s60, s55, s42
  s_mov_b32 s61, s54
  s_add_u32 m0, s60, 0
  s_nop 0
  buffer_load_dwordx4 v8, s[24:27], s61 offen lds
  s_add_u32 m0, s60, 1024
  s_nop 0
  buffer_load_dwordx4 v9, s[24:27], s61 offen lds
  s_add_u32 s61, s61, s65
  s_add_u32 m0, s60, 2048
  s_nop 0
  buffer_load_dwordx4 v8, s[24:27], s61 offen lds
  s_add_u32 m0, s60, 3072
  s_nop 0
  buffer_load_dwordx4 v9, s[24:27], s61 offen lds
  s_add_u32 s61, s61, s65
  s_add_u32 m0, s60, 4096
  s_nop 0
  buffer_load_dwordx4 v8, s[24:27], s61 offen lds
  v_lshlrev_b32 v86, 16, v101
  v_pk_mul_f32 v[218:219], v[218:219], v[86:87] op_sel_hi:[1,0]
  v_lshlrev_b32 v88, 16, v105
  v_pk_mul_f32 v[220:221], v[220:221], v[88:89] op_sel_hi:[1,0]
  v_lshlrev_b32 v86, 16, v109
  v_pk_mul_f32 v[222:223], v[222:223], v[86:87] op_sel_hi:[1,0]
  v_lshlrev_b32 v88, 16, v113
  v_pk_mul_f32 v[224:225], v[224:225], v[88:89] op_sel_hi:[1,0]
  v_lshlrev_b32 v86, 16, v117
  v_pk_mul_f32 v[226:227], v[226:227], v[86:87] op_sel_hi:[1,0]
  v_lshlrev_b32 v88, 16, v121
  v_pk_mul_f32 v[228:229], v[228:229], v[88:89] op_sel_hi:[1,0]
  v_lshlrev_b32 v86, 16, v125
  v_pk_mul_f32 v[230:231], v[230:231], v[86:87] op_sel_hi:[1,0]
  v_lshlrev_b32 v88, 16, v129
  v_pk_mul_f32 v[232:233], v[232:233], v[88:89] op_sel_hi:[1,0]
  v_lshlrev_b32 v86, 16, v133
  v_pk_mul_f32 v[234:235], v[234:235], v[86:87] op_sel_hi:[1,0]
  v_cvt_pk_bf16_f32 v86, v218, v219
  v_lshlrev_b32 v218, 16, v86
  v_and_b32 v219, s40, v86
  v_cvt_pk_bf16_f32 v87, v220, v221
  v_lshlrev_b32 v220, 16, v87
  v_and_b32 v221, s40, v87
  v_cvt_pk_bf16_f32 v88, v222, v223
  v_lshlrev_b32 v222, 16, v88
  v_and_b32 v223, s40, v88
  v_cvt_pk_bf16_f32 v89, v224, v225
  v_lshlrev_b32 v224, 16, v89
  v_and_b32 v225, s40, v89
  v_cvt_pk_bf16_f32 v86, v226, v227
  v_lshlrev_b32 v226, 16, v86
  v_and_b32 v227, s40, v86
  v_cvt_pk_bf16_f32 v87, v228, v229
  v_lshlrev_b32 v228, 16, v87
  v_and_b32 v229, s40, v87
  v_cvt_pk_bf16_f32 v88, v230, v231
  v_lshlrev_b32 v230, 16, v88
  v_and_b32 v231, s40, v88
  v_cvt_pk_bf16_f32 v89, v232, v233
  v_lshlrev_b32 v232, 16, v89
  v_and_b32 v233, s40, v89
  v_cvt_pk_bf16_f32 v86, v234, v235
  v_lshlrev_b32 v234, 16, v86
  v_and_b32 v235, s40, v86
  s_add_u32 m0, s60, 5120
  s_nop 0
  buffer_load_dwordx4 v9, s[24:27], s61 offen lds
  s_add_u32 s61, s61, s65
  s_add_u32 m0, s60, 6144
  s_nop 0
  buffer_load_dwordx4 v8, s[24:27], s61 offen lds
  s_add_u32 m0, s60, 7168
  s_nop 0
  buffer_load_dwordx4 v9, s[24:27], s61 offen lds
  s_add_u32 m0, s55, s43
  s_nop 0
  buffer_load_dwordx4 v10, s[24:27], s54 offen lds
  s_add_u32 s54, s54, s66
  s_add_u32 s55, s55, 36864
  s_cmp_ge_u32 s55, 147456
  s_cselect_b32 s55, 0, s55
  v_pk_add_f32 v[200:201], v[200:201], v[218:219]
  v_pk_add_f32 v[202:203], v[202:203], v[220:221]
  v_pk_add_f32 v[204:205], v[204:205], v[222:223]
  v_pk_add_f32 v[206:207], v[206:207], v[224:225]
  v_pk_add_f32 v[208:209], v[208:209], v[226:227]
  v_pk_add_f32 v[210:211], v[210:211], v[228:229]
  v_pk_add_f32 v[212:213], v[212:213], v[230:231]
  v_pk_add_f32 v[214:215], v[214:215], v[232:233]
  v_pk_add_f32 v[216:217], v[216:217], v[234:235]
  v_cvt_pk_bf16_f32 v86, v200, v201
  v_lshlrev_b32 v200, 16, v86
  v_and_b32 v201, s40, v86
  v_cvt_pk_bf16_f32 v87, v202, v203
  v_lshlrev_b32 v202, 16, v87
  v_and_b32 v203, s40, v87
  v_cvt_pk_bf16_f32 v88, v204, v205
  v_lshlrev_b32 v204, 16, v88
  v_and_b32 v205, s40, v88
  v_cvt_pk_bf16_f32 v89, v206, v207
  v_lshlrev_b32 v206, 16, v89
  v_and_b32 v207, s40, v89
  v_cvt_pk_bf16_f32 v86, v208, v209
  v_lshlrev_b32 v208, 16, v86
  v_and_b32 v209, s40, v86
  v_cvt_pk_bf16_f32 v87, v210, v211
  v_lshlrev_b32 v210, 16, v87
  v_and_b32 v211, s40, v87
  v_cvt_pk_bf16_f32 v88, v212, v213
  v_lshlrev_b32 v212, 16, v88
  v_and_b32 v213, s40, v88
  v_cvt_pk_bf16_f32 v89, v214, v215
  v_lshlrev_b32 v214, 16, v89
  v_and_b32 v215, s40, v89
  v_cvt_pk_bf16_f32 v86, v216, v217
  v_lshlrev_b32 v216, 16, v86
  v_and_b32 v217, s40, v86
  s_add_u32 s60, s55, s42
  s_mov_b32 s61, s54
  s_add_u32 m0, s60, 0
  s_nop 0
  buffer_load_dwordx4 v8, s[24:27], s61 offen lds
  s_add_u32 m0, s60, 1024
  s_nop 0
  buffer_load_dwordx4 v9, s[24:27], s61 offen lds
  s_add_u32 s61, s61, s65
  s_add_u32 m0, s60, 2048
  s_nop 0
  buffer_load_dwordx4 v8, s[24:27], s61 offen lds
  s_add_u32 m0, s60, 3072
  s_nop 0
  buffer_load_dwordx4 v9, s[24:27], s61 offen lds
  s_add_u32 s61, s61, s65
  s_add_u32 m0, s60, 4096
  s_nop 0
  buffer_load_dwordx4 v8, s[24:27], s61 offen lds
  v_pk_add_f32 v[90:91], v[200:201], v[202:203]
  v_pk_add_f32 v[90:91], v[90:91], v[204:205]
  v_pk_add_f32 v[90:91], v[90:91], v[206:207]
  v_pk_add_f32 v[90:91], v[90:91], v[208:209]
  v_pk_add_f32 v[90:91], v[90:91], v[210:211]
  v_pk_add_f32 v[90:91], v[90:91], v[212:213]
  v_pk_add_f32 v[90:91], v[90:91], v[214:215]
  v_pk_add_f32 v[90:91], v[90:91], v[216:217]
  s_nop 0
  s_nop 0
  v_add_f32 v90, v90, v90 quad_perm:[1,0,3,2] row_mask:0xf bank_mask:0xf
  v_add_f32 v91, v91, v91 quad_perm:[1,0,3,2] row_mask:0xf bank_mask:0xf
  s_nop 0
  v_add_f32 v90, v90, v90 quad_perm:[2,3,0,1] row_mask:0xf bank_mask:0xf
  v_add_f32 v91, v91, v91 quad_perm:[2,3,0,1] row_mask:0xf bank_mask:0xf
  s_nop 0
  v_add_f32 v90, v90, v90 row_half_mirror row_mask:0xf bank_mask:0xf
  v_add_f32 v91, v91, v91 row_half_mirror row_mask:0xf bank_mask:0xf
  s_nop 0
  v_add_f32 v90, v90, v90 row_mirror row_mask:0xf bank_mask:0xf
  v_add_f32 v91, v91, v91 row_mirror row_mask:0xf bank_mask:0xf
  v_mov_b32 v92, v90
  v_mov_b32 v93, v91
  s_nop 1
  v_permlane16_swap_b32 v90, v92
  v_permlane16_swap_b32 v91, v93
  v_add_f32 v90, v90, v92
  v_add_f32 v91, v91, v93
  v_mov_b32 v92, v90
  v_mov_b32 v93, v91
  s_nop 1
  v_permlane32_swap_b32 v90, v92
  v_permlane32_swap_b32 v91, v93
  v_add_f32 v90, v90, v92
  v_add_f32 v91, v91, v93
  v_mul_f32 v94, s44, v90
  v_mul_f32 v95, s44, v91
  v_pk_add_f32 v[218:219], v[200:201], v[94:95] neg_lo:[0,1] neg_hi:[0,1]
  v_pk_add_f32 v[220:221], v[202:203], v[94:95] neg_lo:[0,1] neg_hi:[0,1]
  v_pk_add_f32 v[222:223], v[204:205], v[94:95] neg_lo:[0,1] neg_hi:[0,1]
  v_pk_add_f32 v[224:225], v[206:207], v[94:95] neg_lo:[0,1] neg_hi:[0,1]
  v_pk_add_f32 v[226:227], v[208:209], v[94:95] neg_lo:[0,1] neg_hi:[0,1]
  v_pk_add_f32 v[228:229], v[210:211], v[94:95] neg_lo:[0,1] neg_hi:[0,1]
  v_pk_add_f32 v[230:231], v[212:213], v[94:95] neg_lo:[0,1] neg_hi:[0,1]
  v_pk_add_f32 v[232:233], v[214:215], v[94:95] neg_lo:[0,1] neg_hi:[0,1]
  v_pk_add_f32 v[234:235], v[216:217], v[94:95] neg_lo:[0,1] neg_hi:[0,1]
  v_pk_mul_f32 v[90:91], v[218:219], v[218:219]
  v_pk_fma_f32 v[90:91], v[220:221], v[220:221], v[90:91]
  v_pk_fma_f32 v[90:91], v[222:223], v[222:223], v[90:91]
  v_pk_fma_f32 v[90:91], v[224:225], v[224:225], v[90:91]
  v_pk_fma_f32 v[90:91], v[226:227], v[226:227], v[90:91]
  v_pk_fma_f32 v[90:91], v[228:229], v[228:229], v[90:91]
  v_pk_fma_f32 v[90:91], v[230:231], v[230:231], v[90:91]
  v_pk_fma_f32 v[90:91], v[232:233], v[232:233], v[90:91]
  v_pk_fma_f32 v[90:91], v[234:235], v[234:235], v[90:91]
  s_nop 0
  s_nop 0
  v_add_f32 v90, v90, v90 quad_perm:[1,0,3,2] row_mask:0xf bank_mask:0xf
  v_add_f32 v91, v91, v91 quad_perm:[1,0,3,2] row_mask:0xf bank_mask:0xf
  s_nop 0
  v_add_f32 v90, v90, v90 quad_perm:[2,3,0,1] row_mask:0xf bank_mask:0xf
  v_add_f32 v91, v91, v91 quad_perm:[2,3,0,1] row_mask:0xf bank_mask:0xf
  s_nop 0
  v_add_f32 v90, v90, v90 row_half_mirror row_mask:0xf bank_mask:0xf
  v_add_f32 v91, v91, v91 row_half_mirror row_mask:0xf bank_mask:0xf
  s_nop 0
  v_add_f32 v90, v90, v90 row_mirror row_mask:0xf bank_mask:0xf
  v_add_f32 v91, v91, v91 row_mirror row_mask:0xf bank_mask:0xf
  v_mov_b32 v92, v90
  v_mov_b32 v93, v91
  s_nop 1
  v_permlane16_swap_b32 v90, v92
  v_permlane16_swap_b32 v91, v93
  v_add_f32 v90, v90, v92
  v_add_f32 v91, v91, v93
  v_mov_b32 v92, v90
  v_mov_b32 v93, v91
  s_nop 1
  v_permlane32_swap_b32 v90, v92
  v_permlane32_swap_b32 v91, v93
  v_add_f32 v90, v90, v92
  v_add_f32 v91, v91, v93
  v_mul_f32 v90, s44, v90
  v_mul_f32 v91, s44, v91
  v_cvt_pk_bf16_f32 v86, v94, v95
  v_lshlrev_b32 v94, 16, v86
  v_and_b32 v95, s40, v86
  v_cvt_pk_bf16_f32 v87, v90, v91
  v_lshlrev_b32 v90, 16, v87
  v_and_b32 v91, s40, v87
  v_add_f32 v90, s45, v90
  v_add_f32 v91, s45, v91
  v_cvt_pk_bf16_f32 v86, v90, v91
  v_lshlrev_b32 v90, 16, v86
  v_and_b32 v91, s40, v86
  v_sqrt_f32 v90, v90
  v_sqrt_f32 v91, v91
  s_nop 0
  v_cvt_pk_bf16_f32 v86, v90, v91
  v_lshlrev_b32 v90, 16, v86
  v_and_b32 v91, s40, v86
  v_rcp_f32 v92, v90
  v_rcp_f32 v93, v91
  v_pk_add_f32 v[218:219], v[200:201], v[94:95] neg_lo:[0,1] neg_hi:[0,1]
  v_pk_add_f32 v[220:221], v[202:203], v[94:95] neg_lo:[0,1] neg_hi:[0,1]
  v_pk_add_f32 v[222:223], v[204:205], v[94:95] neg_lo:[0,1] neg_hi:[0,1]
  v_pk_add_f32 v[224:225], v[206:207], v[94:95] neg_lo:[0,1] neg_hi:[0,1]
  v_pk_add_f32 v[226:227], v[208:209], v[94:95] neg_lo:[0,1] neg_hi:[0,1]
  v_pk_add_f32 v[228:229], v[210:211], v[94:95] neg_lo:[0,1] neg_hi:[0,1]
  v_pk_add_f32 v[230:231], v[212:213], v[94:95] neg_lo:[0,1] neg_hi:[0,1]
  v_pk_add_f32 v[232:233], v[214:215], v[94:95] neg_lo:[0,1] neg_hi:[0,1]
  v_pk_add_f32 v[234:235], v[216:217], v[94:95] neg_lo:[0,1] neg_hi:[0,1]
  v_cvt_pk_bf16_f32 v86, v218, v219
  v_lshlrev_b32 v218, 16, v86
  v_and_b32 v219, s40, v86
  v_cvt_pk_bf16_f32 v87, v220, v221
  v_lshlrev_b32 v220, 16, v87
  v_and_b32 v221, s40, v87
  v_cvt_pk_bf16_f32 v88, v222, v223
  v_lshlrev_b32 v222, 16, v88
  v_and_b32 v223, s40, v88
  v_cvt_pk_bf16_f32 v89, v224, v225
  v_lshlrev_b32 v224, 16, v89
  v_and_b32 v225, s40, v89
  v_cvt_pk_bf16_f32 v86, v226, v227
  v_lshlrev_b32 v226, 16, v86
  v_and_b32 v227, s40, v86
  v_cvt_pk_bf16_f32 v87, v228, v229
  v_lshlrev_b32 v228, 16, v87
  v_and_b32 v229, s40, v87
  v_cvt_pk_bf16_f32 v88, v230, v231
  v_lshlrev_b32 v230, 16, v88
  v_and_b32 v231, s40, v88
  v_cvt_pk_bf16_f32 v89, v232, v233
  v_lshlrev_b32 v232, 16, v89
  v_and_b32 v233, s40, v89
  v_cvt_pk_bf16_f32 v86, v234, v235
  v_lshlrev_b32 v234, 16, v86
  v_and_b32 v235, s40, v86
  v_pk_mul_f32 v[86:87], v[218:219], v[92:93]
  v_pk_fma_f32 v[96:97], v[86:87], v[90:91], v[218:219] neg_lo:[1,0,0] neg_hi:[1,0,0]
  v_pk_fma_f32 v[218:219], v[96:97], v[92:93], v[86:87]
  v_pk_mul_f32 v[88:89], v[220:221], v[92:93]
  v_pk_fma_f32 v[96:97], v[88:89], v[90:91], v[220:221] neg_lo:[1,0,0] neg_hi:[1,0,0]
  v_pk_fma_f32 v[220:221], v[96:97], v[92:93], v[88:89]
  v_pk_mul_f32 v[86:87], v[222:223], v[92:93]
  v_pk_fma_f32 v[96:97], v[86:87], v[90:91], v[222:223] neg_lo:[1,0,0] neg_hi:[1,0,0]
  v_pk_fma_f32 v[222:223], v[96:97], v[92:93], v[86:87]
  v_pk_mul_f32 v[88:89], v[224:225], v[92:93]
  v_pk_fma_f32 v[96:97], v[88:89], v[90:91], v[224:225] neg_lo:[1,0,0] neg_hi:[1,0,0]
  v_pk_fma_f32 v[224:225], v[96:97], v[92:93], v[88:89]
  v_pk_mul_f32 v[86:87], v[226:227], v[92:93]
  v_pk_fma_f32 v[96:97], v[86:87], v[90:91], v[226:227] neg_lo:[1,0,0] neg_hi:[1,0,0]
  v_pk_fma_f32 v[226:227], v[96:97], v[92:93], v[86:87]
  v_pk_mul_f32 v[88:89], v[228:229], v[92:93]
  v_pk_fma_f32 v[96:97], v[88:89], v[90:91], v[228:229] neg_lo:[1,0,0] neg_hi:[1,0,0]
  v_pk_fma_f32 v[228:229], v[96:97], v[92:93], v[88:89]
  v_pk_mul_f32 v[86:87], v[230:231], v[92:93]
  v_pk_fma_f32 v[96:97], v[86:87], v[90:91], v[230:231] neg_lo:[1,0,0] neg_hi:[1,0,0]
  v_pk_fma_f32 v[230:231], v[96:97], v[92:93], v[86:87]
  v_pk_mul_f32 v[88:89], v[232:233], v[92:93]
  v_pk_fma_f32 v[96:97], v[88:89], v[90:91], v[232:233] neg_lo:[1,0,0] neg_hi:[1,0,0]
  v_pk_fma_f32 v[232:233], v[96:97], v[92:93], v[88:89]
  v_pk_mul_f32 v[86:87], v[234:235], v[92:93]
  v_pk_fma_f32 v[96:97], v[86:87], v[90:91], v[234:235] neg_lo:[1,0,0] neg_hi:[1,0,0]
  v_pk_fma_f32 v[234:235], v[96:97], v[92:93], v[86:87]
  v_cvt_pk_bf16_f32 v86, v218, v219
  v_lshlrev_b32 v218, 16, v86
  v_and_b32 v219, s40, v86
  v_cvt_pk_bf16_f32 v87, v220, v221
  v_lshlrev_b32 v220, 16, v87
  v_and_b32 v221, s40, v87
  v_cvt_pk_bf16_f32 v88, v222, v223
  v_lshlrev_b32 v222, 16, v88
  v_and_b32 v223, s40, v88
  v_cvt_pk_bf16_f32 v89, v224, v225
  v_lshlrev_b32 v224, 16, v89
  v_and_b32 v225, s40, v89
  v_cvt_pk_bf16_f32 v86, v226, v227
  v_lshlrev_b32 v226, 16, v86
  v_and_b32 v227, s40, v86
  v_cvt_pk_bf16_f32 v87, v228, v229
  v_lshlrev_b32 v228, 16, v87
  v_and_b32 v229, s40, v87
  v_cvt_pk_bf16_f32 v88, v230, v231
  v_lshlrev_b32 v230, 16, v88
  v_and_b32 v231, s40, v88
  v_cvt_pk_bf16_f32 v89, v232, v233
  v_lshlrev_b32 v232, 16, v89
  v_and_b32 v233, s40, v89
  v_cvt_pk_bf16_f32 v86, v234, v235
  v_lshlrev_b32 v234, 16, v86
  v_and_b32 v235, s40, v86
  s_add_u32 m0, s60, 5120
  s_nop 0
  buffer_load_dwordx4 v9, s[24:27], s61 offen lds
  s_add_u32 s61, s61, s65
  s_add_u32 m0, s60, 6144
  s_nop 0
  buffer_load_dwordx4 v8, s[24:27], s61 offen lds
  s_add_u32 m0, s60, 7168
  s_nop 0
  buffer_load_dwordx4 v9, s[24:27], s61 offen lds
  s_add_u32 m0, s55, s43
  s_nop 0
  buffer_load_dwordx4 v10, s[24:27], s54 offen lds
  s_add_u32 s54, s54, s66
  s_add_u32 s55, s55, 36864
  s_cmp_ge_u32 s55, 147456
  s_cselect_b32 s55, 0, s55
  v_lshlrev_b32 v86, 16, v102
  v_pk_mul_f32 v[218:219], v[218:219], v[86:87] op_sel_hi:[1,0]
  v_lshlrev_b32 v88, 16, v106
  v_pk_mul_f32 v[220:221], v[220:221], v[88:89] op_sel_hi:[1,0]
  v_lshlrev_b32 v86, 16, v110
  v_pk_mul_f32 v[222:223], v[222:223], v[86:87] op_sel_hi:[1,0]
  v_lshlrev_b32 v88, 16, v114
  v_pk_mul_f32 v[224:225], v[224:225], v[88:89] op_sel_hi:[1,0]
  v_lshlrev_b32 v86, 16, v118
  v_pk_mul_f32 v[226:227], v[226:227], v[86:87] op_sel_hi:[1,0]
  v_lshlrev_b32 v88, 16, v122
  v_pk_mul_f32 v[228:229], v[228:229], v[88:89] op_sel_hi:[1,0]
  v_lshlrev_b32 v86, 16, v126
  v_pk_mul_f32 v[230:231], v[230:231], v[86:87] op_sel_hi:[1,0]
  v_lshlrev_b32 v88, 16, v130
  v_pk_mul_f32 v[232:233], v[232:233], v[88:89] op_sel_hi:[1,0]
  v_lshlrev_b32 v86, 16, v134
  v_pk_mul_f32 v[234:235], v[234:235], v[86:87] op_sel_hi:[1,0]
  v_cvt_pk_bf16_f32 v86, v218, v219
  v_lshlrev_b32 v218, 16, v86
  v_and_b32 v219, s40, v86
  v_cvt_pk_bf16_f32 v87, v220, v221
  v_lshlrev_b32 v220, 16, v87
  v_and_b32 v221, s40, v87
  v_cvt_pk_bf16_f32 v88, v222, v223
  v_lshlrev_b32 v222, 16, v88
  v_and_b32 v223, s40, v88
  v_cvt_pk_bf16_f32 v89, v224, v225
  v_lshlrev_b32 v224, 16, v89
  v_and_b32 v225, s40, v89
  v_cvt_pk_bf16_f32 v86, v226, v227
  v_lshlrev_b32 v226, 16, v86
  v_and_b32 v227, s40, v86
  v_cvt_pk_bf16_f32 v87, v228, v229
  v_lshlrev_b32 v228, 16, v87
  v_and_b32 v229, s40, v87
  v_cvt_pk_bf16_f32 v88, v230, v231
  v_lshlrev_b32 v230, 16, v88
  v_and_b32 v231, s40, v88
  v_cvt_pk_bf16_f32 v89, v232, v233
  v_lshlrev_b32 v232, 16, v89
  v_and_b32 v233, s40, v89
  v_cvt_pk_bf16_f32 v86, v234, v235
  v_lshlrev_b32 v234, 16, v86
  v_and_b32 v235, s40, v86
  v_and_b32 v86, s40, v101
  v_pk_add_f32 v[218:219], v[218:219], v[86:87] op_sel_hi:[1,0]
  v_cvt_pk_bf16_f32 v218, v218, v219
  ds_write_b16 v143, v218 offset:0
  ds_write_b16_d16_hi v143, v218 offset:16
  v_and_b32 v88, s40, v105
  v_pk_add_f32 v[220:221], v[220:221], v[88:89] op_sel_hi:[1,0]
  v_cvt_pk_bf16_f32 v220, v220, v221
  ds_write_b16 v143, v220 offset:1024
  ds_write_b16_d16_hi v143, v220 offset:1040
  v_and_b32 v86, s40, v109
  v_pk_add_f32 v[222:223], v[222:223], v[86:87] op_sel_hi:[1,0]
  v_cvt_pk_bf16_f32 v222, v222, v223
  ds_write_b16 v143, v222 offset:2048
  ds_write_b16_d16_hi v143, v222 offset:2064
  v_and_b32 v88, s40, v113
  v_pk_add_f32 v[224:225], v[224:225], v[88:89] op_sel_hi:[1,0]
  v_cvt_pk_bf16_f32 v224, v224, v225
  ds_write_b16 v143, v224 offset:3072
  ds_write_b16_d16_hi v143, v224 offset:3088
  v_and_b32 v86, s40, v117
  v_pk_add_f32 v[226:227], v[226:227], v[86:87] op_sel_hi:[1,0]
  v_cvt_pk_bf16_f32 v226, v226, v227
  ds_write_b16 v143, v226 offset:4096
  ds_write_b16_d16_hi v143, v226 offset:4112
  v_and_b32 v88, s40, v121
  v_pk_add_f32 v[228:229], v[228:229], v[88:89] op_sel_hi:[1,0]
  v_cvt_pk_bf16_f32 v228, v228, v229
  ds_write_b16 v143, v228 offset:5120
  ds_write_b16_d16_hi v143, v228 offset:5136
  v_and_b32 v86, s40, v125
  v_pk_add_f32 v[230:231], v[230:231], v[86:87] op_sel_hi:[1,0]
  v_cvt_pk_bf16_f32 v230, v230, v231
  ds_write_b16 v143, v230 offset:6144
  ds_write_b16_d16_hi v143, v230 offset:6160
  v_and_b32 v88, s40, v129
  v_pk_add_f32 v[232:233], v[232:233], v[88:89] op_sel_hi:[1,0]
  v_cvt_pk_bf16_f32 v232, v232, v233
  ds_write_b16 v143, v232 offset:7168
  ds_write_b16_d16_hi v143, v232 offset:7184
  v_and_b32 v86, s40, v133
  v_pk_add_f32 v[234:235], v[234:235], v[86:87] op_sel_hi:[1,0]
  v_cvt_pk_bf16_f32 v234, v234, v235
  ds_write_b16 v143, v234 offset:8192
  ds_write_b16_d16_hi v143, v234 offset:8208
  v_lshlrev_b32 v142, 4, v0
  v_add_u32 v142, 119808, v142
  v_lshrrev_b32 v143, 3, v0
  v_lshlrev_b32 v143, 8, v143
  v_and_b32 v144, 7, v0
  v_lshl_add_u32 v143, v144, 4, v143
  s_lshr_b32 s36, s2, 1
  s_mul_i32 s36, s36, 18432
  s_and_b32 s37, s2, 1
  s_lshl_b32 s37, s37, 7
  s_add_u32 s36, s36, s37
  s_add_u32 s37, s36, 8192
  s_add_u32 s38, s36, 16384
  s_waitcnt lgkmcnt(0)
  s_barrier
  ds_read_b128 v[32:35], v142
  ds_read_b128 v[36:39], v142 offset:4096
  s_cmp_lg_u32 s18, 0
  s_cbranch_scc1 mega_kernel_no3rd44
  ds_read_b128 v[40:43], v142 offset:8192
  s_waitcnt lgkmcnt(0)
  buffer_store_dwordx4 v[40:43], v143, s[32:35], s38 offen sc1
mega_kernel_no3rd44:
  s_waitcnt lgkmcnt(0)
  buffer_store_dwordx4 v[32:35], v143, s[32:35], s36 offen sc1
  buffer_store_dwordx4 v[36:39], v143, s[32:35], s37 offen sc1
  s_lshl_b32 s37, s2, 2
  s_add_u32 s37, s37, 3072
  s_waitcnt vmcnt(0) lgkmcnt(0)
  s_barrier
  s_cmp_lg_u32 s18, 0
  s_cbranch_scc1 mega_kernel_pubskip45
  s_mov_b64 exec, 4294967295
  v_mul_u32_u24 v2, 8960, v1
  v_add_u32 v2, s37, v2
  v_mov_b32 v3, s3
  global_store_dword v2, v3, s[12:13] sc1
  s_mov_b64 exec, -1
mega_kernel_pubskip45:
  buffer_store_short_d16_hi v200, v236, s[28:31], s68 offen offset:0 sc1
  buffer_store_short_d16_hi v202, v236, s[28:31], s68 offen offset:128 sc1
  buffer_store_short_d16_hi v204, v236, s[28:31], s68 offen offset:256 sc1
  buffer_store_short_d16_hi v206, v236, s[28:31], s68 offen offset:384 sc1
  buffer_store_short_d16_hi v208, v236, s[28:31], s68 offen offset:512 sc1
  buffer_store_short_d16_hi v210, v236, s[28:31], s68 offen offset:640 sc1
  buffer_store_short_d16_hi v212, v236, s[28:31], s68 offen offset:768 sc1
  buffer_store_short_d16_hi v214, v236, s[28:31], s68 offen offset:896 sc1
  buffer_store_short_d16_hi v216, v236, s[28:31], s68 offen offset:1024 sc1
  buffer_store_short_d16_hi v201, v236, s[28:31], s68 offen offset:1152 sc1
  buffer_store_short_d16_hi v203, v236, s[28:31], s68 offen offset:1280 sc1
  buffer_store_short_d16_hi v205, v236, s[28:31], s68 offen offset:1408 sc1
  buffer_store_short_d16_hi v207, v236, s[28:31], s68 offen offset:1536 sc1
  buffer_store_short_d16_hi v209, v236, s[28:31], s68 offen offset:1664 sc1
  buffer_store_short_d16_hi v211, v236, s[28:31], s68 offen offset:1792 sc1
  buffer_store_short_d16_hi v213, v236, s[28:31], s68 offen offset:1920 sc1
  buffer_store_short_d16_hi v215, v236, s[28:31], s68 offen offset:2048 sc1
  buffer_store_short_d16_hi v217, v236, s[28:31], s68 offen offset:2176 sc1
  s_mul_i32 s38, s62, 18
  s_add_u32 s38, s38, s19
  s_mul_i32 s38, s38, 73728
  s_mul_i32 s37, s20, 36864
  s_add_u32 s38, s38, s37
  s_lshl_b32 s37, s53, 8
  s_add_u32 s39, s38, s37
  s_lshl_b32 s37, s53, 5
  s_add_u32 s41, s38, s37
  s_add_u32 s41, s41, 1024
  s_movk_i32 s37, 1152
  v_lshrrev_b32 v22, 4, v1
  v_and_b32 v23, 15, v1
  v_mul_lo_u32 v24, v22, s37
  v_add_u32 v24, s39, v24
  v_lshlrev_b32 v25, 1, v22
  v_xor_b32 v25, v23, v25
  v_lshl_add_u32 v32, v25, 4, v24
  v_xor_b32 v25, 8, v25
  v_lshl_add_u32 v33, v25, 4, v24
  v_add_u32 v33, 4608, v33
  v_lshrrev_b32 v22, 1, v1
  v_mul_lo_u32 v24, v22, s37
  v_and_b32 v23, 1, v1
  v_lshl_add_u32 v24, v23, 4, v24
  v_add_u32 v34, s41, v24
  v_mov_b32 v25, v32
  v_mov_b32 v26, v33
  v_mov_b32 v27, v34
  s_mul_i32 s36, s52, 18
  s_lshl_b32 s37, s53, 2
  s_add_u32 s38, s36, s37
  s_lshl_b32 s38, s38, 10
  s_lshr_b32 s37, s53, 1
  s_add_u32 s39, s36, s37
  s_add_u32 s39, s39, 16
  s_lshl_b32 s39, s39, 10
  s_mul_i32 s36, s23, 147456
  s_add_u32 s38, s38, s36
  s_add_u32 s39, s39, s36
  v_and_b32 v32, 15, v1
  v_lshl_add_u32 v22, v32, 7, s38
  v_add_u32 v23, 2048, v22
  v_and_b32 v32, 3, v1
  v_lshl_add_u32 v32, v32, 7, s39
  v_add_u32 v33, 512, v32
  v_lshrrev_b32 v24, 2, v1
  v_cmp_eq_u32 vcc, 4, v24
  s_mov_b32 s47, 0
  s_nop 0
  v_cndmask_b32 v22, v22, v32, vcc
  v_cndmask_b32 v23, v23, v33, vcc
  s_lshl_b32 s36, s17, 2
  s_add_u32 s36, s36, s18
  s_mul_i32 s36, s36, 1408
  v_min_u32 v24, 10, v1
  v_lshl_add_u32 v24, v24, 7, s36
  s_mov_b32 s67, 0
  s_mul_i32 s36, s62, 1327104
  s_add_u32 s56, s8, s36
  s_addc_u32 s57, s9, 0
  s_mov_b32 s58, 1327104
  s_mov_b32 s59, 0x00020000
  s_add_u32 s28, s10, 10485760
  s_addc_u32 s29, s11, 0
  s_mov_b32 s30, 2359296
  s_mov_b32 s31, 0x00020000
  s_add_u32 s32, s10, 13631488
  s_addc_u32 s33, s11, 0
  s_mov_b32 s34, 18874368
  s_mov_b32 s35, 0x00020000
  v_mov_b32 v32, 0
  v_mov_b32 v33, 0
  v_mov_b32 v34, 0
  v_mov_b32 v35, 0
  v_mov_b32 v36, 0
  v_mov_b32 v37, 0
  v_mov_b32 v38, 0
  v_mov_b32 v39, 0
  v_mov_b32 v40, 0
  v_mov_b32 v41, 0
  v_mov_b32 v42, 0
  v_mov_b32 v43, 0
  v_mov_b32 v44, 0
  v_mov_b32 v45, 0
  v_mov_b32 v46, 0
  v_mov_b32 v47, 0
  v_mov_b32 v48, 0
  v_mov_b32 v49, 0
  v_mov_b32 v50, 0
  v_mov_b32 v51, 0
  v_mov_b32 v52, 0
  v_mov_b32 v53, 0
  v_mov_b32 v54, 0
  v_mov_b32 v55, 0
  v_mov_b32 v56, 0
  v_mov_b32 v57, 0
  v_mov_b32 v58, 0
  v_mov_b32 v59, 0
  v_mov_b32 v60, 0
  v_mov_b32 v61, 0
  v_mov_b32 v62, 0
  v_mov_b32 v63, 0
  v_mov_b32 v64, 0
  v_mov_b32 v65, 0
  v_mov_b32 v66, 0
  v_mov_b32 v67, 0
  v_mov_b32 v68, 0
  v_mov_b32 v69, 0
  v_mov_b32 v70, 0
  v_mov_b32 v71, 0
  v_mov_b32 v72, 0
  v_mov_b32 v73, 0
  v_mov_b32 v74, 0
  v_mov_b32 v75, 0
  v_mov_b32 v76, 0
  v_mov_b32 v77, 0
  v_mov_b32 v78, 0
  v_mov_b32 v79, 0
  v_mov_b32 v80, 0
  v_mov_b32 v81, 0
  v_mov_b32 v82, 0
  v_mov_b32 v83, 0
  v_mov_b32 v84, 0
  v_mov_b32 v85, 0
  v_mov_b32 v86, 0
  v_mov_b32 v87, 0
  v_mov_b32 v88, 0
  v_mov_b32 v89, 0
  v_mov_b32 v90, 0
  v_mov_b32 v91, 0
  v_mov_b32 v92, 0
  v_mov_b32 v93, 0
  v_mov_b32 v94, 0
  v_mov_b32 v95, 0
  v_mov_b32 v96, 0
  v_mov_b32 v97, 0
  v_mov_b32 v98, 0
  v_mov_b32 v99, 0
  v_mov_b32 v100, 0
  v_mov_b32 v101, 0
  v_mov_b32 v102, 0
  v_mov_b32 v103, 0
  v_mov_b32 v104, 0
  v_mov_b32 v105, 0
  v_mov_b32 v106, 0
  v_mov_b32 v107, 0
  v_mov_b32 v108, 0
  v_mov_b32 v109, 0
  v_mov_b32 v110, 0
  v_mov_b32 v111, 0
  v_mov_b32 v112, 0
  v_mov_b32 v113, 0
  v_mov_b32 v114, 0
  v_mov_b32 v115, 0
  v_mov_b32 v116, 0
  v_mov_b32 v117, 0
  v_mov_b32 v118, 0
  v_mov_b32 v119, 0
  v_mov_b32 v120, 0
  v_mov_b32 v121, 0
  v_mov_b32 v122, 0
  v_mov_b32 v123, 0
  v_mov_b32 v124, 0
  v_mov_b32 v125, 0
  v_mov_b32 v126, 0
  v_mov_b32 v127, 0
  v_mov_b32 v128, 0
  v_mov_b32 v129, 0
  v_mov_b32 v130, 0
  v_mov_b32 v131, 0
  v_mov_b32 v132, 0
  v_mov_b32 v133, 0
  v_mov_b32 v134, 0
  v_mov_b32 v135, 0
  v_mov_b32 v136, 0
  v_mov_b32 v137, 0
  v_mov_b32 v138, 0
  v_mov_b32 v139, 0
  v_mov_b32 v140, 0
  v_mov_b32 v141, 0
  v_mov_b32 v142, 0
  v_mov_b32 v143, 0
  v_mov_b32 v144, 0
  v_mov_b32 v145, 0
  v_mov_b32 v146, 0
  v_mov_b32 v147, 0
  v_mov_b32 v148, 0
  v_mov_b32 v149, 0
  v_mov_b32 v150, 0
  v_mov_b32 v151, 0
  v_mov_b32 v152, 0
  v_mov_b32 v153, 0
  v_mov_b32 v154, 0
  v_mov_b32 v155, 0
  v_mov_b32 v156, 0
  v_mov_b32 v157, 0
  v_mov_b32 v158, 0
  v_mov_b32 v159, 0
  v_mov_b32 v160, 0
  v_mov_b32 v161, 0
  v_mov_b32 v162, 0
  v_mov_b32 v163, 0
  v_mov_b32 v164, 0
  v_mov_b32 v165, 0
  v_mov_b32 v166, 0
  v_mov_b32 v167, 0
  v_mov_b32 v168, 0
  v_mov_b32 v169, 0
  v_mov_b32 v170, 0
  v_mov_b32 v171, 0
  v_mov_b32 v172, 0
  v_mov_b32 v173, 0
  v_mov_b32 v174, 0
  v_mov_b32 v175, 0
  v_mov_b32 v176, 0
  v_mov_b32 v177, 0
  v_mov_b32 v178, 0
  v_mov_b32 v179, 0
  v_mov_b32 v180, 0
  v_mov_b32 v181, 0
  v_mov_b32 v182, 0
  v_mov_b32 v183, 0
  v_mov_b32 v184, 0
  v_mov_b32 v185, 0
  v_mov_b32 v186, 0
  v_mov_b32 v187, 0
  v_mov_b32 v188, 0
  v_mov_b32 v189, 0
  v_mov_b32 v190, 0
  v_mov_b32 v191, 0
  v_mov_b32 v192, 0
  v_mov_b32 v193, 0
  v_mov_b32 v194, 0
  v_mov_b32 v195, 0
  v_mov_b32 v196, 0
  v_mov_b32 v197, 0
  v_mov_b32 v198, 0
  v_mov_b32 v199, 0
  v_mov_b32 v200, 0
  v_mov_b32 v201, 0
  v_mov_b32 v202, 0
  v_mov_b32 v203, 0
  v_mov_b32 v204, 0
  v_mov_b32 v205, 0
  v_mov_b32 v206, 0
  v_mov_b32 v207, 0
  v_mov_b32 v208, 0
  v_mov_b32 v209, 0
  v_mov_b32 v210, 0
  v_mov_b32 v211, 0
  v_mov_b32 v212, 0
  v_mov_b32 v213, 0
  v_mov_b32 v214, 0
  v_mov_b32 v215, 0
  v_mov_b32 v216, 0
  v_mov_b32 v217, 0
  v_mov_b32 v218, 0
  v_mov_b32 v219, 0
  v_mov_b32 v220, 0
  v_mov_b32 v221, 0
  v_mov_b32 v222, 0
  v_mov_b32 v223, 0
  v_mov_b32 v224, 0
  v_mov_b32 v225, 0
  v_mov_b32 v226, 0
  v_mov_b32 v227, 0
  v_mov_b32 v228, 0
  v_mov_b32 v229, 0
  v_mov_b32 v230, 0
  v_mov_b32 v231, 0
  v_mov_b32 v232, 0
  v_mov_b32 v233, 0
  v_mov_b32 v234, 0
  v_mov_b32 v235, 0
  v_mov_b32 v236, 0
  v_mov_b32 v237, 0
  v_mov_b32 v238, 0
  v_mov_b32 v239, 0
  v_mov_b32 v240, 0
  v_mov_b32 v241, 0
  v_mov_b32 v242, 0
  v_mov_b32 v243, 0
  v_mov_b32 v244, 0
  v_mov_b32 v245, 0
  v_mov_b32 v246, 0
  v_mov_b32 v247, 0
  v_mov_b32 v248, 0
  v_mov_b32 v249, 0
  v_mov_b32 v250, 0
  v_mov_b32 v251, 0
  v_mov_b32 v252, 0
  v_mov_b32 v253, 0
  v_mov_b32 v254, 0
  v_mov_b32 v255, 0
  v_accvgpr_write_b32 a0, 0
  v_accvgpr_write_b32 a1, 0
  v_accvgpr_write_b32 a2, 0
  v_accvgpr_write_b32 a3, 0
  v_accvgpr_write_b32 a4, 0
  v_accvgpr_write_b32 a5, 0
  v_accvgpr_write_b32 a6, 0
  v_accvgpr_write_b32 a7, 0
  v_accvgpr_write_b32 a8, 0
  v_accvgpr_write_b32 a9, 0
  v_accvgpr_write_b32 a10, 0
  v_accvgpr_write_b32 a11, 0
  v_accvgpr_write_b32 a12, 0
  v_accvgpr_write_b32 a13, 0
  v_accvgpr_write_b32 a14, 0
  v_accvgpr_write_b32 a15, 0
  v_accvgpr_write_b32 a16, 0
  v_accvgpr_write_b32 a17, 0
  v_accvgpr_write_b32 a18, 0
  v_accvgpr_write_b32 a19, 0
  v_accvgpr_write_b32 a20, 0
  v_accvgpr_write_b32 a21, 0
  v_accvgpr_write_b32 a22, 0
  v_accvgpr_write_b32 a23, 0
  v_accvgpr_write_b32 a24, 0
  v_accvgpr_write_b32 a25, 0
  v_accvgpr_write_b32 a26, 0
  v_accvgpr_write_b32 a27, 0
  v_accvgpr_write_b32 a28, 0
  v_accvgpr_write_b32 a29, 0
  v_accvgpr_write_b32 a30, 0
  v_accvgpr_write_b32 a31, 0
  v_accvgpr_write_b32 a32, 0
  v_accvgpr_write_b32 a33, 0
  v_accvgpr_write_b32 a34, 0
  v_accvgpr_write_b32 a35, 0
  v_accvgpr_write_b32 a36, 0
  v_accvgpr_write_b32 a37, 0
  v_accvgpr_write_b32 a38, 0
  v_accvgpr_write_b32 a39, 0
  v_accvgpr_write_b32 a40, 0
  v_accvgpr_write_b32 a41, 0
  v_accvgpr_write_b32 a42, 0
  v_accvgpr_write_b32 a43, 0
  v_accvgpr_write_b32 a44, 0
  v_accvgpr_write_b32 a45, 0
  v_accvgpr_write_b32 a46, 0
  v_accvgpr_write_b32 a47, 0
  v_accvgpr_write_b32 a48, 0
  v_accvgpr_write_b32 a49, 0
  v_accvgpr_write_b32 a50, 0
  v_accvgpr_write_b32 a51, 0
  v_accvgpr_write_b32 a52, 0
  v_accvgpr_write_b32 a53, 0
  v_accvgpr_write_b32 a54, 0
  v_accvgpr_write_b32 a55, 0
  v_accvgpr_write_b32 a56, 0
  v_accvgpr_write_b32 a57, 0
  v_accvgpr_write_b32 a58, 0
  v_accvgpr_write_b32 a59, 0
  v_accvgpr_write_b32 a60, 0
  v_accvgpr_write_b32 a61, 0
  v_accvgpr_write_b32 a62, 0
  v_accvgpr_write_b32 a63, 0
  s_mov_b32 s48, 0
  s_mov_b32 s50, 36864
  s_mov_b32 s51, 0
  s_lshl_b32 s37, s22, 7
  s_add_u32 s37, s37, 3072
  s_cmp_lg_u32 s18, 0
  s_cbranch_scc1 mega_kernel_wskip46
  v_min_u32 v2, 7, v1
  v_lshlrev_b32 v2, 4, v2
  v_add_u32 v2, s37, v2
  s_and_b32 s36, s2, 31
  s_mul_i32 s36, s36, 8960
  v_add_u32 v2, s36, v2
  s_mov_b32 s36, 0
mega_kernel_poll47:
  global_load_dwordx4 v[28:31], v2, s[12:13] sc1
  s_add_u32 s36, s36, 1
  s_waitcnt vmcnt(0)
  v_xor_b32 v28, s3, v28
  v_xor_b32 v29, s3, v29
  v_xor_b32 v30, s3, v30
  v_xor_b32 v31, s3, v31
  v_or3_b32 v28, v28, v29, v30
  v_or_b32 v28, v28, v31
  v_cmp_ne_u32 vcc, 0, v28
  s_cmp_ge_u32 s36, 1048576
  s_cbranch_scc1 mega_kernel_pdone48
  s_cbranch_vccz mega_kernel_pdone48
  s_sleep 2
  s_branch mega_kernel_poll47
mega_kernel_pdone48:
mega_kernel_wskip46:
  s_barrier
  buffer_load_dwordx4 a[64:67], v4, s[28:31], s46 offen offset:0 sc1
  buffer_load_dwordx4 a[68:71], v5, s[28:31], s46 offen offset:0 sc1
  buffer_load_dwordx4 a[72:75], v6, s[28:31], s46 offen offset:0 sc1
  buffer_load_dwordx4 a[76:79], v7, s[28:31], s46 offen offset:0 sc1
  buffer_load_dwordx4 a[80:83], v4, s[28:31], s46 offen offset:1024 sc1
  buffer_load_dwordx4 a[84:87], v5, s[28:31], s46 offen offset:1024 sc1
  buffer_load_dwordx4 a[88:91], v6, s[28:31], s46 offen offset:1024 sc1
  buffer_load_dwordx4 a[92:95], v7, s[28:31], s46 offen offset:1024 sc1
  s_add_u32 s46, s46, 2048
  buffer_load_dwordx4 a[96:99], v4, s[28:31], s46 offen offset:0 sc1
  buffer_load_dwordx4 a[100:103], v5, s[28:31], s46 offen offset:0 sc1
  buffer_load_dwordx4 a[104:107], v6, s[28:31], s46 offen offset:0 sc1
  buffer_load_dwordx4 a[108:111], v7, s[28:31], s46 offen offset:0 sc1
  buffer_load_dwordx4 a[112:115], v4, s[28:31], s46 offen offset:1024 sc1
  buffer_load_dwordx4 a[116:119], v5, s[28:31], s46 offen offset:1024 sc1
  buffer_load_dwordx4 a[120:123], v6, s[28:31], s46 offen offset:1024 sc1
  buffer_load_dwordx4 a[124:127], v7, s[28:31], s46 offen offset:1024 sc1
  s_add_u32 s46, s46, 2048
  buffer_load_dwordx4 a[128:131], v4, s[28:31], s46 offen offset:0 sc1
  buffer_load_dwordx4 a[132:135], v5, s[28:31], s46 offen offset:0 sc1
  buffer_load_dwordx4 a[136:139], v6, s[28:31], s46 offen offset:0 sc1
  buffer_load_dwordx4 a[140:143], v7, s[28:31], s46 offen offset:0 sc1
  buffer_load_dwordx4 a[144:147], v4, s[28:31], s46 offen offset:1024 sc1
  buffer_load_dwordx4 a[148:151], v5, s[28:31], s46 offen offset:1024 sc1
  buffer_load_dwordx4 a[152:155], v6, s[28:31], s46 offen offset:1024 sc1
  buffer_load_dwordx4 a[156:159], v7, s[28:31], s46 offen offset:1024 sc1
  s_add_u32 s46, s46, 2048
  ds_read_b64_tr_b16 a[192:193], v12 offset:0
  ds_read_b64_tr_b16 a[194:195], v12 offset:4096
  ds_read_b64_tr_b16 a[196:197], v13 offset:0
  ds_read_b64_tr_b16 a[198:199], v13 offset:4096
  ds_read_b64_tr_b16 a[200:201], v14 offset:0
  ds_read_b64_tr_b16 a[202:203], v14 offset:4096
  ds_read_b64_tr_b16 a[204:205], v15 offset:0
  ds_read_b64_tr_b16 a[206:207], v15 offset:4096
  s_waitcnt vmcnt(16)
mega_kernel_loop49:
  s_add_u32 s48, s48, 36864
  s_cmp_ge_u32 s48, 147456
  s_cselect_b32 s49, 0xfffe5000, s50
  s_cselect_b32 s48, 0, s48
  s_waitcnt lgkmcnt(6)
  v_mfma_f32_16x16x32_bf16 v[32:35], a[192:195], a[64:67], v[32:35]
  ds_read_b64_tr_b16 a[208:209], v16 offset:0
  v_mfma_f32_16x16x32_bf16 v[36:39], a[192:195], a[68:71], v[36:39]
  ds_read_b64_tr_b16 a[210:211], v16 offset:4096
  v_mfma_f32_16x16x32_bf16 v[40:43], a[192:195], a[72:75], v[40:43]
  s_add_u32 s60, s55, s42
  s_mov_b32 s61, s54
  s_add_u32 m0, s60, 0
  s_nop 0
  buffer_load_dwordx4 v8, s[24:27], s61 offen lds
  v_mfma_f32_16x16x32_bf16 v[44:47], a[192:195], a[76:79], v[44:47]
  s_waitcnt lgkmcnt(6)
  v_mfma_f32_16x16x32_bf16 v[48:51], a[196:199], a[64:67], v[48:51]
  ds_read_b64_tr_b16 a[212:213], v17 offset:0
  v_mfma_f32_16x16x32_bf16 v[52:55], a[196:199], a[68:71], v[52:55]
  ds_read_b64_tr_b16 a[214:215], v17 offset:4096
  v_mfma_f32_16x16x32_bf16 v[56:59], a[196:199], a[72:75], v[56:59]
  s_add_u32 m0, s60, 1024
  s_nop 0
  buffer_load_dwordx4 v9, s[24:27], s61 offen lds
  s_add_u32 s61, s61, s65
  v_mfma_f32_16x16x32_bf16 v[60:63], a[196:199], a[76:79], v[60:63]
  s_waitcnt lgkmcnt(6)
  v_mfma_f32_16x16x32_bf16 v[64:67], a[200:203], a[64:67], v[64:67]
  ds_read_b64_tr_b16 a[216:217], v18 offset:0
  v_mfma_f32_16x16x32_bf16 v[68:71], a[200:203], a[68:71], v[68:71]
  ds_read_b64_tr_b16 a[218:219], v18 offset:4096
  v_mfma_f32_16x16x32_bf16 v[72:75], a[200:203], a[72:75], v[72:75]
  v_mfma_f32_16x16x32_bf16 v[76:79], a[200:203], a[76:79], v[76:79]
  s_waitcnt lgkmcnt(6)
  v_mfma_f32_16x16x32_bf16 v[80:83], a[204:207], a[64:67], v[80:83]
  ds_read_b64_tr_b16 a[220:221], v19 offset:0
  v_mfma_f32_16x16x32_bf16 v[84:87], a[204:207], a[68:71], v[84:87]
  ds_read_b64_tr_b16 a[222:223], v19 offset:4096
  v_mfma_f32_16x16x32_bf16 v[88:91], a[204:207], a[72:75], v[88:91]
  s_add_u32 m0, s60, 2048
  s_nop 0
  buffer_load_dwordx4 v8, s[24:27], s61 offen lds
  v_mfma_f32_16x16x32_bf16 v[92:95], a[204:207], a[76:79], v[92:95]
  s_waitcnt lgkmcnt(6)
  v_mfma_f32_16x16x32_bf16 v[96:99], a[208:211], a[64:67], v[96:99]
  ds_read_b64_tr_b16 a[224:225], v20 offset:0
  v_mfma_f32_16x16x32_bf16 v[100:103], a[208:211], a[68:71], v[100:103]
  ds_read_b64_tr_b16 a[226:227], v20 offset:512
  v_mfma_f32_16x16x32_bf16 v[104:107], a[208:211], a[72:75], v[104:107]
  v_mfma_f32_16x16x32_bf16 v[108:111], a[208:211], a[76:79], v[108:111]
  s_waitcnt lgkmcnt(6)
  v_mfma_f32_16x16x32_bf16 v[112:115], a[212:215], a[64:67], v[112:115]
  ds_read_b64_tr_b16 a[192:193], v12 offset:18432
  v_mfma_f32_16x16x32_bf16 v[116:119], a[212:215], a[68:71], v[116:119]
  ds_read_b64_tr_b16 a[194:195], v12 offset:22528
  v_mfma_f32_16x16x32_bf16 v[120:123], a[212:215], a[72:75], v[120:123]
  s_add_u32 m0, s60, 3072
  s_nop 0
  buffer_load_dwordx4 v9, s[24:27], s61 offen lds
  s_add_u32 s61, s61, s65
  v_mfma_f32_16x16x32_bf16 v[124:127], a[212:215], a[76:79], v[124:127]
  s_waitcnt lgkmcnt(6)
  v_mfma_f32_16x16x32_bf16 v[128:131], a[216:219], a[64:67], v[128:131]
  ds_read_b64_tr_b16 a[196:197], v13 offset:18432
  v_mfma_f32_16x16x32_bf16 v[132:135], a[216:219], a[68:71], v[132:135]
  ds_read_b64_tr_b16 a[198:199], v13 offset:22528
  v_mfma_f32_16x16x32_bf16 v[136:139], a[216:219], a[72:75], v[136:139]
  v_mfma_f32_16x16x32_bf16 v[140:143], a[216:219], a[76:79], v[140:143]
  s_waitcnt lgkmcnt(6)
  v_mfma_f32_16x16x32_bf16 v[144:147], a[220:223], a[64:67], v[144:147]
  ds_read_b64_tr_b16 a[200:201], v14 offset:18432
  v_mfma_f32_16x16x32_bf16 v[148:151], a[220:223], a[68:71], v[148:151]
  ds_read_b64_tr_b16 a[202:203], v14 offset:22528
  v_mfma_f32_16x16x32_bf16 v[152:155], a[220:223], a[72:75], v[152:155]
  s_add_u32 m0, s60, 4096
  s_nop 0
  buffer_load_dwordx4 v8, s[24:27], s61 offen lds
  v_mfma_f32_16x16x32_bf16 v[156:159], a[220:223], a[76:79], v[156:159]
  s_waitcnt lgkmcnt(6)
  v_mfma_f32_16x16x32_bf16 v[160:163], a[224:227], a[64:67], v[160:163]
  ds_read_b64_tr_b16 a[204:205], v15 offset:18432
  v_mfma_f32_16x16x32_bf16 v[164:167], a[224:227], a[68:71], v[164:167]
  ds_read_b64_tr_b16 a[206:207], v15 offset:22528
  v_mfma_f32_16x16x32_bf16 v[168:171], a[224:227], a[72:75], v[168:171]
  s_add_u32 m0, s60, 5120
  s_nop 0
  buffer_load_dwordx4 v9, s[24:27], s61 offen lds
  s_add_u32 s61, s61, s65
  v_mfma_f32_16x16x32_bf16 v[172:175], a[224:227], a[76:79], v[172:175]
  s_waitcnt lgkmcnt(6)
  v_mfma_f32_16x16x32_bf16 v[176:179], a[192:195], a[64:67], v[176:179]
  ds_read_b64_tr_b16 a[208:209], v16 offset:18432
  v_mfma_f32_16x16x32_bf16 v[180:183], a[192:195], a[68:71], v[180:183]
  ds_read_b64_tr_b16 a[210:211], v16 offset:22528
  v_mfma_f32_16x16x32_bf16 v[184:187], a[192:195], a[72:75], v[184:187]
  v_mfma_f32_16x16x32_bf16 v[188:191], a[192:195], a[76:79], v[188:191]
  s_waitcnt lgkmcnt(6)
  v_mfma_f32_16x16x32_bf16 v[192:195], a[196:199], a[64:67], v[192:195]
  ds_read_b64_tr_b16 a[212:213], v17 offset:18432
  v_mfma_f32_16x16x32_bf16 v[196:199], a[196:199], a[68:71], v[196:199]
  ds_read_b64_tr_b16 a[214:215], v17 offset:22528
  v_mfma_f32_16x16x32_bf16 v[200:203], a[196:199], a[72:75], v[200:203]
  s_add_u32 m0, s60, 6144
  s_nop 0
  buffer_load_dwordx4 v8, s[24:27], s61 offen lds
  v_mfma_f32_16x16x32_bf16 v[204:207], a[196:199], a[76:79], v[204:207]
  s_waitcnt lgkmcnt(6)
  v_mfma_f32_16x16x32_bf16 v[208:211], a[200:203], a[64:67], v[208:211]
  ds_read_b64_tr_b16 a[216:217], v18 offset:18432
  v_mfma_f32_16x16x32_bf16 v[212:215], a[200:203], a[68:71], v[212:215]
  ds_read_b64_tr_b16 a[218:219], v18 offset:22528
  v_mfma_f32_16x16x32_bf16 v[216:219], a[200:203], a[72:75], v[216:219]
  v_mfma_f32_16x16x32_bf16 v[220:223], a[200:203], a[76:79], v[220:223]
  s_waitcnt lgkmcnt(6)
  v_mfma_f32_16x16x32_bf16 v[224:227], a[204:207], a[64:67], v[224:227]
  ds_read_b64_tr_b16 a[220:221], v19 offset:18432
  v_mfma_f32_16x16x32_bf16 v[228:231], a[204:207], a[68:71], v[228:231]
  ds_read_b64_tr_b16 a[222:223], v19 offset:22528
  v_mfma_f32_16x16x32_bf16 v[232:235], a[204:207], a[72:75], v[232:235]
  s_add_u32 m0, s60, 7168
  s_nop 0
  buffer_load_dwordx4 v9, s[24:27], s61 offen lds
  v_mfma_f32_16x16x32_bf16 v[236:239], a[204:207], a[76:79], v[236:239]
  s_waitcnt lgkmcnt(6)
  v_mfma_f32_16x16x32_bf16 v[240:243], a[208:211], a[64:67], v[240:243]
  ds_read_b64_tr_b16 a[224:225], v20 offset:18432
  v_mfma_f32_16x16x32_bf16 v[244:247], a[208:211], a[68:71], v[244:247]
  ds_read_b64_tr_b16 a[226:227], v20 offset:18944
  v_mfma_f32_16x16x32_bf16 v[248:251], a[208:211], a[72:75], v[248:251]
  v_mfma_f32_16x16x32_bf16 v[252:255], a[208:211], a[76:79], v[252:255]
  s_waitcnt lgkmcnt(6)
  v_mfma_f32_16x16x32_bf16 a[0:3], a[212:215], a[64:67], a[0:3]
  ds_read_b64_tr_b16 a[192:193], v12 offset:8192
  v_mfma_f32_16x16x32_bf16 a[4:7], a[212:215], a[68:71], a[4:7]
  ds_read_b64_tr_b16 a[194:195], v12 offset:12288
  v_mfma_f32_16x16x32_bf16 a[8:11], a[212:215], a[72:75], a[8:11]
  s_add_u32 m0, s55, s43
  s_nop 0
  buffer_load_dwordx4 v10, s[24:27], s54 offen lds
  s_add_u32 s54, s54, s66
  s_add_u32 s55, s55, 36864
  s_cmp_ge_u32 s55, 147456
  s_cselect_b32 s55, 0, s55
  v_mfma_f32_16x16x32_bf16 a[12:15], a[212:215], a[76:79], a[12:15]
  s_waitcnt lgkmcnt(6)
  v_mfma_f32_16x16x32_bf16 a[16:19], a[216:219], a[64:67], a[16:19]
  ds_read_b64_tr_b16 a[196:197], v13 offset:8192
  v_mfma_f32_16x16x32_bf16 a[20:23], a[216:219], a[68:71], a[20:23]
  ds_read_b64_tr_b16 a[198:199], v13 offset:12288
  v_mfma_f32_16x16x32_bf16 a[24:27], a[216:219], a[72:75], a[24:27]
  v_mfma_f32_16x16x32_bf16 a[28:31], a[216:219], a[76:79], a[28:31]
  s_waitcnt lgkmcnt(6)
  v_mfma_f32_16x16x32_bf16 a[32:35], a[220:223], a[64:67], a[32:35]
  ds_read_b64_tr_b16 a[200:201], v14 offset:8192
  v_mfma_f32_16x16x32_bf16 a[36:39], a[220:223], a[68:71], a[36:39]
  ds_read_b64_tr_b16 a[202:203], v14 offset:12288
  v_mfma_f32_16x16x32_bf16 a[40:43], a[220:223], a[72:75], a[40:43]
  buffer_load_dwordx4 a[160:163], v4, s[28:31], s46 offen offset:0 sc1
  v_mfma_f32_16x16x32_bf16 a[44:47], a[220:223], a[76:79], a[44:47]
  s_waitcnt lgkmcnt(6)
  v_mfma_f32_16x16x32_bf16 a[48:51], a[224:227], a[64:67], a[48:51]
  ds_read_b64_tr_b16 a[204:205], v15 offset:8192
  v_mfma_f32_16x16x32_bf16 a[52:55], a[224:227], a[68:71], a[52:55]
  ds_read_b64_tr_b16 a[206:207], v15 offset:12288
  v_mfma_f32_16x16x32_bf16 a[56:59], a[224:227], a[72:75], a[56:59]
  buffer_load_dwordx4 a[164:167], v5, s[28:31], s46 offen offset:0 sc1
  v_mfma_f32_16x16x32_bf16 a[60:63], a[224:227], a[76:79], a[60:63]
  s_waitcnt lgkmcnt(6)
  v_mfma_f32_16x16x32_bf16 v[32:35], a[192:195], a[80:83], v[32:35]
  ds_read_b64_tr_b16 a[208:209], v16 offset:8192
  v_mfma_f32_16x16x32_bf16 v[36:39], a[192:195], a[84:87], v[36:39]
  ds_read_b64_tr_b16 a[210:211], v16 offset:12288
  v_mfma_f32_16x16x32_bf16 v[40:43], a[192:195], a[88:91], v[40:43]
  v_mfma_f32_16x16x32_bf16 v[44:47], a[192:195], a[92:95], v[44:47]
  s_waitcnt lgkmcnt(6)
  v_mfma_f32_16x16x32_bf16 v[48:51], a[196:199], a[80:83], v[48:51]
  ds_read_b64_tr_b16 a[212:213], v17 offset:8192
  v_mfma_f32_16x16x32_bf16 v[52:55], a[196:199], a[84:87], v[52:55]
  ds_read_b64_tr_b16 a[214:215], v17 offset:12288
  v_mfma_f32_16x16x32_bf16 v[56:59], a[196:199], a[88:91], v[56:59]
  buffer_load_dwordx4 a[168:171], v6, s[28:31], s46 offen offset:0 sc1
  v_mfma_f32_16x16x32_bf16 v[60:63], a[196:199], a[92:95], v[60:63]
  s_waitcnt lgkmcnt(6)
  v_mfma_f32_16x16x32_bf16 v[64:67], a[200:203], a[80:83], v[64:67]
  ds_read_b64_tr_b16 a[216:217], v18 offset:8192
  v_mfma_f32_16x16x32_bf16 v[68:71], a[200:203], a[84:87], v[68:71]
  ds_read_b64_tr_b16 a[218:219], v18 offset:12288
  v_mfma_f32_16x16x32_bf16 v[72:75], a[200:203], a[88:91], v[72:75]
  v_mfma_f32_16x16x32_bf16 v[76:79], a[200:203], a[92:95], v[76:79]
  s_waitcnt lgkmcnt(6)
  v_mfma_f32_16x16x32_bf16 v[80:83], a[204:207], a[80:83], v[80:83]
  ds_read_b64_tr_b16 a[220:221], v19 offset:8192
  v_mfma_f32_16x16x32_bf16 v[84:87], a[204:207], a[84:87], v[84:87]
  ds_read_b64_tr_b16 a[222:223], v19 offset:12288
  v_mfma_f32_16x16x32_bf16 v[88:91], a[204:207], a[88:91], v[88:91]
  buffer_load_dwordx4 a[172:175], v7, s[28:31], s46 offen offset:0 sc1
  v_mfma_f32_16x16x32_bf16 v[92:95], a[204:207], a[92:95], v[92:95]
  s_waitcnt lgkmcnt(6)
  v_mfma_f32_16x16x32_bf16 v[96:99], a[208:211], a[80:83], v[96:99]
  ds_read_b64_tr_b16 a[224:225], v20 offset:1024
  v_mfma_f32_16x16x32_bf16 v[100:103], a[208:211], a[84:87], v[100:103]
  ds_read_b64_tr_b16 a[226:227], v20 offset:1536
  v_mfma_f32_16x16x32_bf16 v[104:107], a[208:211], a[88:91], v[104:107]
  v_mfma_f32_16x16x32_bf16 v[108:111], a[208:211], a[92:95], v[108:111]
  s_waitcnt lgkmcnt(6)
  v_mfma_f32_16x16x32_bf16 v[112:115], a[212:215], a[80:83], v[112:115]
  ds_read_b64_tr_b16 a[192:193], v12 offset:26624
  v_mfma_f32_16x16x32_bf16 v[116:119], a[212:215], a[84:87], v[116:119]
  ds_read_b64_tr_b16 a[194:195], v12 offset:30720
  v_add_u32 v12, s49, v12
  v_mfma_f32_16x16x32_bf16 v[120:123], a[212:215], a[88:91], v[120:123]
  buffer_load_dwordx4 a[176:179], v4, s[28:31], s46 offen offset:1024 sc1
  v_mfma_f32_16x16x32_bf16 v[124:127], a[212:215], a[92:95], v[124:127]
  s_waitcnt lgkmcnt(6)
  v_mfma_f32_16x16x32_bf16 v[128:131], a[216:219], a[80:83], v[128:131]
  ds_read_b64_tr_b16 a[196:197], v13 offset:26624
  v_mfma_f32_16x16x32_bf16 v[132:135], a[216:219], a[84:87], v[132:135]
  ds_read_b64_tr_b16 a[198:199], v13 offset:30720
  v_add_u32 v13, s49, v13
  v_mfma_f32_16x16x32_bf16 v[136:139], a[216:219], a[88:91], v[136:139]
  buffer_load_dwordx4 a[180:183], v5, s[28:31], s46 offen offset:1024 sc1
  v_mfma_f32_16x16x32_bf16 v[140:143], a[216:219], a[92:95], v[140:143]
  s_waitcnt lgkmcnt(6)
  v_mfma_f32_16x16x32_bf16 v[144:147], a[220:223], a[80:83], v[144:147]
  ds_read_b64_tr_b16 a[200:201], v14 offset:26624
  v_mfma_f32_16x16x32_bf16 v[148:151], a[220:223], a[84:87], v[148:151]
  ds_read_b64_tr_b16 a[202:203], v14 offset:30720
  v_add_u32 v14, s49, v14
  v_mfma_f32_16x16x32_bf16 v[152:155], a[220:223], a[88:91], v[152:155]
  v_mfma_f32_16x16x32_bf16 v[156:159], a[220:223], a[92:95], v[156:159]
  s_waitcnt lgkmcnt(6)
  v_mfma_f32_16x16x32_bf16 v[160:163], a[224:227], a[80:83], v[160:163]
  ds_read_b64_tr_b16 a[204:205], v15 offset:26624
  v_mfma_f32_16x16x32_bf16 v[164:167], a[224:227], a[84:87], v[164:167]
  ds_read_b64_tr_b16 a[206:207], v15 offset:30720
  v_add_u32 v15, s49, v15
  v_mfma_f32_16x16x32_bf16 v[168:171], a[224:227], a[88:91], v[168:171]
  buffer_load_dwordx4 a[184:187], v6, s[28:31], s46 offen offset:1024 sc1
  v_mfma_f32_16x16x32_bf16 v[172:175], a[224:227], a[92:95], v[172:175]
  s_waitcnt lgkmcnt(6)
  v_mfma_f32_16x16x32_bf16 v[176:179], a[192:195], a[80:83], v[176:179]
  ds_read_b64_tr_b16 a[208:209], v16 offset:26624
  v_mfma_f32_16x16x32_bf16 v[180:183], a[192:195], a[84:87], v[180:183]
  ds_read_b64_tr_b16 a[210:211], v16 offset:30720
  v_add_u32 v16, s49, v16
  v_mfma_f32_16x16x32_bf16 v[184:187], a[192:195], a[88:91], v[184:187]
  v_mfma_f32_16x16x32_bf16 v[188:191], a[192:195], a[92:95], v[188:191]
  s_waitcnt lgkmcnt(6)
  v_mfma_f32_16x16x32_bf16 v[192:195], a[196:199], a[80:83], v[192:195]
  ds_read_b64_tr_b16 a[212:213], v17 offset:26624
  v_mfma_f32_16x16x32_bf16 v[196:199], a[196:199], a[84:87], v[196:199]
  ds_read_b64_tr_b16 a[214:215], v17 offset:30720
  v_add_u32 v17, s49, v17
  v_mfma_f32_16x16x32_bf16 v[200:203], a[196:199], a[88:91], v[200:203]
  buffer_load_dwordx4 a[188:191], v7, s[28:31], s46 offen offset:1024 sc1
  s_add_u32 s46, s46, 2048
  v_mfma_f32_16x16x32_bf16 v[204:207], a[196:199], a[92:95], v[204:207]
  s_waitcnt lgkmcnt(6)
  v_mfma_f32_16x16x32_bf16 v[208:211], a[200:203], a[80:83], v[208:211]
  ds_read_b64_tr_b16 a[216:217], v18 offset:26624
  v_mfma_f32_16x16x32_bf16 v[212:215], a[200:203], a[84:87], v[212:215]
  ds_read_b64_tr_b16 a[218:219], v18 offset:30720
  v_add_u32 v18, s49, v18
  v_mfma_f32_16x16x32_bf16 v[216:219], a[200:203], a[88:91], v[216:219]
  v_mfma_f32_16x16x32_bf16 v[220:223], a[200:203], a[92:95], v[220:223]
  s_waitcnt lgkmcnt(6)
  v_mfma_f32_16x16x32_bf16 v[224:227], a[204:207], a[80:83], v[224:227]
  ds_read_b64_tr_b16 a[220:221], v19 offset:26624
  v_mfma_f32_16x16x32_bf16 v[228:231], a[204:207], a[84:87], v[228:231]
  ds_read_b64_tr_b16 a[222:223], v19 offset:30720
  v_add_u32 v19, s49, v19
  v_mfma_f32_16x16x32_bf16 v[232:235], a[204:207], a[88:91], v[232:235]
  buffer_load_dword a229, v24, s[56:59], s67 offen
  s_add_u32 s67, s67, 180224
  v_mfma_f32_16x16x32_bf16 v[236:239], a[204:207], a[92:95], v[236:239]
  s_waitcnt lgkmcnt(6)
  v_mfma_f32_16x16x32_bf16 v[240:243], a[208:211], a[80:83], v[240:243]
  ds_read_b64_tr_b16 a[224:225], v20 offset:19456
  v_mfma_f32_16x16x32_bf16 v[244:247], a[208:211], a[84:87], v[244:247]
  ds_read_b64_tr_b16 a[226:227], v20 offset:19968
  v_add_u32 v20, s49, v20
  v_mfma_f32_16x16x32_bf16 v[248:251], a[208:211], a[88:91], v[248:251]
  v_mfma_f32_16x16x32_bf16 v[252:255], a[208:211], a[92:95], v[252:255]
  s_waitcnt vmcnt(26)
  s_barrier
  s_waitcnt lgkmcnt(6)
  v_mfma_f32_16x16x32_bf16 a[0:3], a[212:215], a[80:83], a[0:3]
  ds_read_b64_tr_b16 a[192:193], v12 offset:0
  v_mfma_f32_16x16x32_bf16 a[4:7], a[212:215], a[84:87], a[4:7]
  ds_read_b64_tr_b16 a[194:195], v12 offset:4096
  v_mfma_f32_16x16x32_bf16 a[8:11], a[212:215], a[88:91], a[8:11]
  v_mfma_f32_16x16x32_bf16 a[12:15], a[212:215], a[92:95], a[12:15]
  s_waitcnt lgkmcnt(6)
  v_mfma_f32_16x16x32_bf16 a[16:19], a[216:219], a[80:83], a[16:19]
  ds_read_b64_tr_b16 a[196:197], v13 offset:0
  v_mfma_f32_16x16x32_bf16 a[20:23], a[216:219], a[84:87], a[20:23]
  ds_read_b64_tr_b16 a[198:199], v13 offset:4096
  v_mfma_f32_16x16x32_bf16 a[24:27], a[216:219], a[88:91], a[24:27]
  v_mfma_f32_16x16x32_bf16 a[28:31], a[216:219], a[92:95], a[28:31]
  s_waitcnt lgkmcnt(6)
  v_mfma_f32_16x16x32_bf16 a[32:35], a[220:223], a[80:83], a[32:35]
  ds_read_b64_tr_b16 a[200:201], v14 offset:0
  v_mfma_f32_16x16x32_bf16 a[36:39], a[220:223], a[84:87], a[36:39]
  ds_read_b64_tr_b16 a[202:203], v14 offset:4096
  v_mfma_f32_16x16x32_bf16 a[40:43], a[220:223], a[88:91], a[40:43]
  v_mfma_f32_16x16x32_bf16 a[44:47], a[220:223], a[92:95], a[44:47]
  s_waitcnt lgkmcnt(6)
  v_mfma_f32_16x16x32_bf16 a[48:51], a[224:227], a[80:83], a[48:51]
  ds_read_b64_tr_b16 a[204:205], v15 offset:0
  v_mfma_f32_16x16x32_bf16 a[52:55], a[224:227], a[84:87], a[52:55]
  ds_read_b64_tr_b16 a[206:207], v15 offset:4096
  v_mfma_f32_16x16x32_bf16 a[56:59], a[224:227], a[88:91], a[56:59]
  v_mfma_f32_16x16x32_bf16 a[60:63], a[224:227], a[92:95], a[60:63]
  s_add_u32 s48, s48, 36864
  s_cmp_ge_u32 s48, 147456
  s_cselect_b32 s49, 0xfffe5000, s50
  s_cselect_b32 s48, 0, s48
  s_waitcnt lgkmcnt(6)
  v_mfma_f32_16x16x32_bf16 v[32:35], a[192:195], a[96:99], v[32:35]
  ds_read_b64_tr_b16 a[208:209], v16 offset:0
  v_mfma_f32_16x16x32_bf16 v[36:39], a[192:195], a[100:103], v[36:39]
  ds_read_b64_tr_b16 a[210:211], v16 offset:4096
  v_mfma_f32_16x16x32_bf16 v[40:43], a[192:195], a[104:107], v[40:43]
  s_add_u32 s60, s55, s42
  s_mov_b32 s61, s54
  s_add_u32 m0, s60, 0
  s_nop 0
  buffer_load_dwordx4 v8, s[24:27], s61 offen lds
  v_mfma_f32_16x16x32_bf16 v[44:47], a[192:195], a[108:111], v[44:47]
  s_waitcnt lgkmcnt(6)
  v_mfma_f32_16x16x32_bf16 v[48:51], a[196:199], a[96:99], v[48:51]
  ds_read_b64_tr_b16 a[212:213], v17 offset:0
  v_mfma_f32_16x16x32_bf16 v[52:55], a[196:199], a[100:103], v[52:55]
  ds_read_b64_tr_b16 a[214:215], v17 offset:4096
  v_mfma_f32_16x16x32_bf16 v[56:59], a[196:199], a[104:107], v[56:59]
  s_add_u32 m0, s60, 1024
  s_nop 0
  buffer_load_dwordx4 v9, s[24:27], s61 offen lds
  s_add_u32 s61, s61, s65
  v_mfma_f32_16x16x32_bf16 v[60:63], a[196:199], a[108:111], v[60:63]
  s_waitcnt lgkmcnt(6)
  v_mfma_f32_16x16x32_bf16 v[64:67], a[200:203], a[96:99], v[64:67]
  ds_read_b64_tr_b16 a[216:217], v18 offset:0
  v_mfma_f32_16x16x32_bf16 v[68:71], a[200:203], a[100:103], v[68:71]
  ds_read_b64_tr_b16 a[218:219], v18 offset:4096
  v_mfma_f32_16x16x32_bf16 v[72:75], a[200:203], a[104:107], v[72:75]
  v_mfma_f32_16x16x32_bf16 v[76:79], a[200:203], a[108:111], v[76:79]
  s_waitcnt lgkmcnt(6)
  v_mfma_f32_16x16x32_bf16 v[80:83], a[204:207], a[96:99], v[80:83]
  ds_read_b64_tr_b16 a[220:221], v19 offset:0
  v_mfma_f32_16x16x32_bf16 v[84:87], a[204:207], a[100:103], v[84:87]
  ds_read_b64_tr_b16 a[222:223], v19 offset:4096
  v_mfma_f32_16x16x32_bf16 v[88:91], a[204:207], a[104:107], v[88:91]
  s_add_u32 m0, s60, 2048
  s_nop 0
  buffer_load_dwordx4 v8, s[24:27], s61 offen lds
  v_mfma_f32_16x16x32_bf16 v[92:95], a[204:207], a[108:111], v[92:95]
  s_waitcnt lgkmcnt(6)
  v_mfma_f32_16x16x32_bf16 v[96:99], a[208:211], a[96:99], v[96:99]
  ds_read_b64_tr_b16 a[224:225], v20 offset:0
  v_mfma_f32_16x16x32_bf16 v[100:103], a[208:211], a[100:103], v[100:103]
  ds_read_b64_tr_b16 a[226:227], v20 offset:512
  v_mfma_f32_16x16x32_bf16 v[104:107], a[208:211], a[104:107], v[104:107]
  v_mfma_f32_16x16x32_bf16 v[108:111], a[208:211], a[108:111], v[108:111]
  s_waitcnt lgkmcnt(6)
  v_mfma_f32_16x16x32_bf16 v[112:115], a[212:215], a[96:99], v[112:115]
  ds_read_b64_tr_b16 a[192:193], v12 offset:18432
  v_mfma_f32_16x16x32_bf16 v[116:119], a[212:215], a[100:103], v[116:119]
  ds_read_b64_tr_b16 a[194:195], v12 offset:22528
  v_mfma_f32_16x16x32_bf16 v[120:123], a[212:215], a[104:107], v[120:123]
  s_add_u32 m0, s60, 3072
  s_nop 0
  buffer_load_dwordx4 v9, s[24:27], s61 offen lds
  s_add_u32 s61, s61, s65
  v_mfma_f32_16x16x32_bf16 v[124:127], a[212:215], a[108:111], v[124:127]
  s_waitcnt lgkmcnt(6)
  v_mfma_f32_16x16x32_bf16 v[128:131], a[216:219], a[96:99], v[128:131]
  ds_read_b64_tr_b16 a[196:197], v13 offset:18432
  v_mfma_f32_16x16x32_bf16 v[132:135], a[216:219], a[100:103], v[132:135]
  ds_read_b64_tr_b16 a[198:199], v13 offset:22528
  v_mfma_f32_16x16x32_bf16 v[136:139], a[216:219], a[104:107], v[136:139]
  v_mfma_f32_16x16x32_bf16 v[140:143], a[216:219], a[108:111], v[140:143]
  s_waitcnt lgkmcnt(6)
  v_mfma_f32_16x16x32_bf16 v[144:147], a[220:223], a[96:99], v[144:147]
  ds_read_b64_tr_b16 a[200:201], v14 offset:18432
  v_mfma_f32_16x16x32_bf16 v[148:151], a[220:223], a[100:103], v[148:151]
  ds_read_b64_tr_b16 a[202:203], v14 offset:22528
  v_mfma_f32_16x16x32_bf16 v[152:155], a[220:223], a[104:107], v[152:155]
  s_add_u32 m0, s60, 4096
  s_nop 0
  buffer_load_dwordx4 v8, s[24:27], s61 offen lds
  v_mfma_f32_16x16x32_bf16 v[156:159], a[220:223], a[108:111], v[156:159]
  s_waitcnt lgkmcnt(6)
  v_mfma_f32_16x16x32_bf16 v[160:163], a[224:227], a[96:99], v[160:163]
  ds_read_b64_tr_b16 a[204:205], v15 offset:18432
  v_mfma_f32_16x16x32_bf16 v[164:167], a[224:227], a[100:103], v[164:167]
  ds_read_b64_tr_b16 a[206:207], v15 offset:22528
  v_mfma_f32_16x16x32_bf16 v[168:171], a[224:227], a[104:107], v[168:171]
  s_add_u32 m0, s60, 5120
  s_nop 0
  buffer_load_dwordx4 v9, s[24:27], s61 offen lds
  s_add_u32 s61, s61, s65
  v_mfma_f32_16x16x32_bf16 v[172:175], a[224:227], a[108:111], v[172:175]
  s_waitcnt lgkmcnt(6)
  v_mfma_f32_16x16x32_bf16 v[176:179], a[192:195], a[96:99], v[176:179]
  ds_read_b64_tr_b16 a[208:209], v16 offset:18432
  v_mfma_f32_16x16x32_bf16 v[180:183], a[192:195], a[100:103], v[180:183]
  ds_read_b64_tr_b16 a[210:211], v16 offset:22528
  v_mfma_f32_16x16x32_bf16 v[184:187], a[192:195], a[104:107], v[184:187]
  v_mfma_f32_16x16x32_bf16 v[188:191], a[192:195], a[108:111], v[188:191]
  s_waitcnt lgkmcnt(6)
  v_mfma_f32_16x16x32_bf16 v[192:195], a[196:199], a[96:99], v[192:195]
  ds_read_b64_tr_b16 a[212:213], v17 offset:18432
  v_mfma_f32_16x16x32_bf16 v[196:199], a[196:199], a[100:103], v[196:199]
  ds_read_b64_tr_b16 a[214:215], v17 offset:22528
  v_mfma_f32_16x16x32_bf16 v[200:203], a[196:199], a[104:107], v[200:203]
  s_add_u32 m0, s60, 6144
  s_nop 0
  buffer_load_dwordx4 v8, s[24:27], s61 offen lds
  v_mfma_f32_16x16x32_bf16 v[204:207], a[196:199], a[108:111], v[204:207]
  s_waitcnt lgkmcnt(6)
  v_mfma_f32_16x16x32_bf16 v[208:211], a[200:203], a[96:99], v[208:211]
  ds_read_b64_tr_b16 a[216:217], v18 offset:18432
  v_mfma_f32_16x16x32_bf16 v[212:215], a[200:203], a[100:103], v[212:215]
  ds_read_b64_tr_b16 a[218:219], v18 offset:22528
  v_mfma_f32_16x16x32_bf16 v[216:219], a[200:203], a[104:107], v[216:219]
  v_mfma_f32_16x16x32_bf16 v[220:223], a[200:203], a[108:111], v[220:223]
  s_waitcnt lgkmcnt(6)
  v_mfma_f32_16x16x32_bf16 v[224:227], a[204:207], a[96:99], v[224:227]
  ds_read_b64_tr_b16 a[220:221], v19 offset:18432
  v_mfma_f32_16x16x32_bf16 v[228:231], a[204:207], a[100:103], v[228:231]
  ds_read_b64_tr_b16 a[222:223], v19 offset:22528
  v_mfma_f32_16x16x32_bf16 v[232:235], a[204:207], a[104:107], v[232:235]
  s_add_u32 m0, s60, 7168
  s_nop 0
  buffer_load_dwordx4 v9, s[24:27], s61 offen lds
  v_mfma_f32_16x16x32_bf16 v[236:239], a[204:207], a[108:111], v[236:239]
  s_waitcnt lgkmcnt(6)
  v_mfma_f32_16x16x32_bf16 v[240:243], a[208:211], a[96:99], v[240:243]
  ds_read_b64_tr_b16 a[224:225], v20 offset:18432
  v_mfma_f32_16x16x32_bf16 v[244:247], a[208:211], a[100:103], v[244:247]
  ds_read_b64_tr_b16 a[226:227], v20 offset:18944
  v_mfma_f32_16x16x32_bf16 v[248:251], a[208:211], a[104:107], v[248:251]
  v_mfma_f32_16x16x32_bf16 v[252:255], a[208:211], a[108:111], v[252:255]
  s_waitcnt lgkmcnt(6)
  v_mfma_f32_16x16x32_bf16 a[0:3], a[212:215], a[96:99], a[0:3]
  ds_read_b64_tr_b16 a[192:193], v12 offset:8192
  v_mfma_f32_16x16x32_bf16 a[4:7], a[212:215], a[100:103], a[4:7]
  ds_read_b64_tr_b16 a[194:195], v12 offset:12288
  v_mfma_f32_16x16x32_bf16 a[8:11], a[212:215], a[104:107], a[8:11]
  s_add_u32 m0, s55, s43
  s_nop 0
  buffer_load_dwordx4 v10, s[24:27], s54 offen lds
  s_add_u32 s54, s54, s66
  s_add_u32 s55, s55, 36864
  s_cmp_ge_u32 s55, 147456
  s_cselect_b32 s55, 0, s55
  v_mfma_f32_16x16x32_bf16 a[12:15], a[212:215], a[108:111], a[12:15]
  s_waitcnt lgkmcnt(6)
  v_mfma_f32_16x16x32_bf16 a[16:19], a[216:219], a[96:99], a[16:19]
  ds_read_b64_tr_b16 a[196:197], v13 offset:8192
  v_mfma_f32_16x16x32_bf16 a[20:23], a[216:219], a[100:103], a[20:23]
  ds_read_b64_tr_b16 a[198:199], v13 offset:12288
  v_mfma_f32_16x16x32_bf16 a[24:27], a[216:219], a[104:107], a[24:27]
  v_mfma_f32_16x16x32_bf16 a[28:31], a[216:219], a[108:111], a[28:31]
  s_waitcnt lgkmcnt(6)
  v_mfma_f32_16x16x32_bf16 a[32:35], a[220:223], a[96:99], a[32:35]
  ds_read_b64_tr_b16 a[200:201], v14 offset:8192
  v_mfma_f32_16x16x32_bf16 a[36:39], a[220:223], a[100:103], a[36:39]
  ds_read_b64_tr_b16 a[202:203], v14 offset:12288
  v_mfma_f32_16x16x32_bf16 a[40:43], a[220:223], a[104:107], a[40:43]
  buffer_load_dwordx4 a[64:67], v4, s[28:31], s46 offen offset:0 sc1
  v_mfma_f32_16x16x32_bf16 a[44:47], a[220:223], a[108:111], a[44:47]
  s_waitcnt lgkmcnt(6)
  v_mfma_f32_16x16x32_bf16 a[48:51], a[224:227], a[96:99], a[48:51]
  ds_read_b64_tr_b16 a[204:205], v15 offset:8192
  v_mfma_f32_16x16x32_bf16 a[52:55], a[224:227], a[100:103], a[52:55]
  ds_read_b64_tr_b16 a[206:207], v15 offset:12288
  v_mfma_f32_16x16x32_bf16 a[56:59], a[224:227], a[104:107], a[56:59]
  buffer_load_dwordx4 a[68:71], v5, s[28:31], s46 offen offset:0 sc1
  v_mfma_f32_16x16x32_bf16 a[60:63], a[224:227], a[108:111], a[60:63]
  s_waitcnt lgkmcnt(6)
  v_mfma_f32_16x16x32_bf16 v[32:35], a[192:195], a[112:115], v[32:35]
  ds_read_b64_tr_b16 a[208:209], v16 offset:8192
  v_mfma_f32_16x16x32_bf16 v[36:39], a[192:195], a[116:119], v[36:39]
  ds_read_b64_tr_b16 a[210:211], v16 offset:12288
  v_mfma_f32_16x16x32_bf16 v[40:43], a[192:195], a[120:123], v[40:43]
  v_mfma_f32_16x16x32_bf16 v[44:47], a[192:195], a[124:127], v[44:47]
  s_waitcnt lgkmcnt(6)
  v_mfma_f32_16x16x32_bf16 v[48:51], a[196:199], a[112:115], v[48:51]
  ds_read_b64_tr_b16 a[212:213], v17 offset:8192
  v_mfma_f32_16x16x32_bf16 v[52:55], a[196:199], a[116:119], v[52:55]
  ds_read_b64_tr_b16 a[214:215], v17 offset:12288
  v_mfma_f32_16x16x32_bf16 v[56:59], a[196:199], a[120:123], v[56:59]
  buffer_load_dwordx4 a[72:75], v6, s[28:31], s46 offen offset:0 sc1
  v_mfma_f32_16x16x32_bf16 v[60:63], a[196:199], a[124:127], v[60:63]
  s_waitcnt lgkmcnt(6)
  v_mfma_f32_16x16x32_bf16 v[64:67], a[200:203], a[112:115], v[64:67]
  ds_read_b64_tr_b16 a[216:217], v18 offset:8192
  v_mfma_f32_16x16x32_bf16 v[68:71], a[200:203], a[116:119], v[68:71]
  ds_read_b64_tr_b16 a[218:219], v18 offset:12288
  v_mfma_f32_16x16x32_bf16 v[72:75], a[200:203], a[120:123], v[72:75]
  v_mfma_f32_16x16x32_bf16 v[76:79], a[200:203], a[124:127], v[76:79]
  s_waitcnt lgkmcnt(6)
  v_mfma_f32_16x16x32_bf16 v[80:83], a[204:207], a[112:115], v[80:83]
  ds_read_b64_tr_b16 a[220:221], v19 offset:8192
  v_mfma_f32_16x16x32_bf16 v[84:87], a[204:207], a[116:119], v[84:87]
  ds_read_b64_tr_b16 a[222:223], v19 offset:12288
  v_mfma_f32_16x16x32_bf16 v[88:91], a[204:207], a[120:123], v[88:91]
  buffer_load_dwordx4 a[76:79], v7, s[28:31], s46 offen offset:0 sc1
  v_mfma_f32_16x16x32_bf16 v[92:95], a[204:207], a[124:127], v[92:95]
  s_waitcnt lgkmcnt(6)
  v_mfma_f32_16x16x32_bf16 v[96:99], a[208:211], a[112:115], v[96:99]
  ds_read_b64_tr_b16 a[224:225], v20 offset:1024
  v_mfma_f32_16x16x32_bf16 v[100:103], a[208:211], a[116:119], v[100:103]
  ds_read_b64_tr_b16 a[226:227], v20 offset:1536
  v_mfma_f32_16x16x32_bf16 v[104:107], a[208:211], a[120:123], v[104:107]
  v_mfma_f32_16x16x32_bf16 v[108:111], a[208:211], a[124:127], v[108:111]
  s_waitcnt lgkmcnt(6)
  v_mfma_f32_16x16x32_bf16 v[112:115], a[212:215], a[112:115], v[112:115]
  ds_read_b64_tr_b16 a[192:193], v12 offset:26624
  v_mfma_f32_16x16x32_bf16 v[116:119], a[212:215], a[116:119], v[116:119]
  ds_read_b64_tr_b16 a[194:195], v12 offset:30720
  v_add_u32 v12, s49, v12
  v_mfma_f32_16x16x32_bf16 v[120:123], a[212:215], a[120:123], v[120:123]
  buffer_load_dwordx4 a[80:83], v4, s[28:31], s46 offen offset:1024 sc1
  v_mfma_f32_16x16x32_bf16 v[124:127], a[212:215], a[124:127], v[124:127]
  s_waitcnt lgkmcnt(6)
  v_mfma_f32_16x16x32_bf16 v[128:131], a[216:219], a[112:115], v[128:131]
  ds_read_b64_tr_b16 a[196:197], v13 offset:26624
  v_mfma_f32_16x16x32_bf16 v[132:135], a[216:219], a[116:119], v[132:135]
  ds_read_b64_tr_b16 a[198:199], v13 offset:30720
  v_add_u32 v13, s49, v13
  v_mfma_f32_16x16x32_bf16 v[136:139], a[216:219], a[120:123], v[136:139]
  buffer_load_dwordx4 a[84:87], v5, s[28:31], s46 offen offset:1024 sc1
  v_mfma_f32_16x16x32_bf16 v[140:143], a[216:219], a[124:127], v[140:143]
  s_waitcnt lgkmcnt(6)
  v_mfma_f32_16x16x32_bf16 v[144:147], a[220:223], a[112:115], v[144:147]
  ds_read_b64_tr_b16 a[200:201], v14 offset:26624
  v_mfma_f32_16x16x32_bf16 v[148:151], a[220:223], a[116:119], v[148:151]
  ds_read_b64_tr_b16 a[202:203], v14 offset:30720
  v_add_u32 v14, s49, v14
  v_mfma_f32_16x16x32_bf16 v[152:155], a[220:223], a[120:123], v[152:155]
  v_mfma_f32_16x16x32_bf16 v[156:159], a[220:223], a[124:127], v[156:159]
  s_waitcnt lgkmcnt(6)
  v_mfma_f32_16x16x32_bf16 v[160:163], a[224:227], a[112:115], v[160:163]
  ds_read_b64_tr_b16 a[204:205], v15 offset:26624
  v_mfma_f32_16x16x32_bf16 v[164:167], a[224:227], a[116:119], v[164:167]
  ds_read_b64_tr_b16 a[206:207], v15 offset:30720
  v_add_u32 v15, s49, v15
  v_mfma_f32_16x16x32_bf16 v[168:171], a[224:227], a[120:123], v[168:171]
  buffer_load_dwordx4 a[88:91], v6, s[28:31], s46 offen offset:1024 sc1
  v_mfma_f32_16x16x32_bf16 v[172:175], a[224:227], a[124:127], v[172:175]
  s_waitcnt lgkmcnt(6)
  v_mfma_f32_16x16x32_bf16 v[176:179], a[192:195], a[112:115], v[176:179]
  ds_read_b64_tr_b16 a[208:209], v16 offset:26624
  v_mfma_f32_16x16x32_bf16 v[180:183], a[192:195], a[116:119], v[180:183]
  ds_read_b64_tr_b16 a[210:211], v16 offset:30720
  v_add_u32 v16, s49, v16
  v_mfma_f32_16x16x32_bf16 v[184:187], a[192:195], a[120:123], v[184:187]
  v_mfma_f32_16x16x32_bf16 v[188:191], a[192:195], a[124:127], v[188:191]
  s_waitcnt lgkmcnt(6)
  v_mfma_f32_16x16x32_bf16 v[192:195], a[196:199], a[112:115], v[192:195]
  ds_read_b64_tr_b16 a[212:213], v17 offset:26624
  v_mfma_f32_16x16x32_bf16 v[196:199], a[196:199], a[116:119], v[196:199]
  ds_read_b64_tr_b16 a[214:215], v17 offset:30720
  v_add_u32 v17, s49, v17
  v_mfma_f32_16x16x32_bf16 v[200:203], a[196:199], a[120:123], v[200:203]
  buffer_load_dwordx4 a[92:95], v7, s[28:31], s46 offen offset:1024 sc1
  s_add_u32 s46, s46, 2048
  v_mfma_f32_16x16x32_bf16 v[204:207], a[196:199], a[124:127], v[204:207]
  s_waitcnt lgkmcnt(6)
  v_mfma_f32_16x16x32_bf16 v[208:211], a[200:203], a[112:115], v[208:211]
  ds_read_b64_tr_b16 a[216:217], v18 offset:26624
  v_mfma_f32_16x16x32_bf16 v[212:215], a[200:203], a[116:119], v[212:215]
  ds_read_b64_tr_b16 a[218:219], v18 offset:30720
  v_add_u32 v18, s49, v18
  v_mfma_f32_16x16x32_bf16 v[216:219], a[200:203], a[120:123], v[216:219]
  v_mfma_f32_16x16x32_bf16 v[220:223], a[200:203], a[124:127], v[220:223]
  s_waitcnt lgkmcnt(6)
  v_mfma_f32_16x16x32_bf16 v[224:227], a[204:207], a[112:115], v[224:227]
  ds_read_b64_tr_b16 a[220:221], v19 offset:26624
  v_mfma_f32_16x16x32_bf16 v[228:231], a[204:207], a[116:119], v[228:231]
  ds_read_b64_tr_b16 a[222:223], v19 offset:30720
  v_add_u32 v19, s49, v19
  v_mfma_f32_16x16x32_bf16 v[232:235], a[204:207], a[120:123], v[232:235]
  buffer_load_dword a229, v24, s[56:59], s67 offen
  s_add_u32 s67, s67, 180224
  v_mfma_f32_16x16x32_bf16 v[236:239], a[204:207], a[124:127], v[236:239]
  s_waitcnt lgkmcnt(6)
  v_mfma_f32_16x16x32_bf16 v[240:243], a[208:211], a[112:115], v[240:243]
  ds_read_b64_tr_b16 a[224:225], v20 offset:19456
  v_mfma_f32_16x16x32_bf16 v[244:247], a[208:211], a[116:119], v[244:247]
  ds_read_b64_tr_b16 a[226:227], v20 offset:19968
  v_add_u32 v20, s49, v20
  v_mfma_f32_16x16x32_bf16 v[248:251], a[208:211], a[120:123], v[248:251]
  v_mfma_f32_16x16x32_bf16 v[252:255], a[208:211], a[124:127], v[252:255]
  s_waitcnt vmcnt(26)
  s_barrier
  s_waitcnt lgkmcnt(6)
  v_mfma_f32_16x16x32_bf16 a[0:3], a[212:215], a[112:115], a[0:3]
  ds_read_b64_tr_b16 a[192:193], v12 offset:0
  v_mfma_f32_16x16x32_bf16 a[4:7], a[212:215], a[116:119], a[4:7]
  ds_read_b64_tr_b16 a[194:195], v12 offset:4096
  v_mfma_f32_16x16x32_bf16 a[8:11], a[212:215], a[120:123], a[8:11]
  v_mfma_f32_16x16x32_bf16 a[12:15], a[212:215], a[124:127], a[12:15]
  s_waitcnt lgkmcnt(6)
  v_mfma_f32_16x16x32_bf16 a[16:19], a[216:219], a[112:115], a[16:19]
  ds_read_b64_tr_b16 a[196:197], v13 offset:0
  v_mfma_f32_16x16x32_bf16 a[20:23], a[216:219], a[116:119], a[20:23]
  ds_read_b64_tr_b16 a[198:199], v13 offset:4096
  v_mfma_f32_16x16x32_bf16 a[24:27], a[216:219], a[120:123], a[24:27]
  v_mfma_f32_16x16x32_bf16 a[28:31], a[216:219], a[124:127], a[28:31]
  s_waitcnt lgkmcnt(6)
  v_mfma_f32_16x16x32_bf16 a[32:35], a[220:223], a[112:115], a[32:35]
  ds_read_b64_tr_b16 a[200:201], v14 offset:0
  v_mfma_f32_16x16x32_bf16 a[36:39], a[220:223], a[116:119], a[36:39]
  ds_read_b64_tr_b16 a[202:203], v14 offset:4096
  v_mfma_f32_16x16x32_bf16 a[40:43], a[220:223], a[120:123], a[40:43]
  v_mfma_f32_16x16x32_bf16 a[44:47], a[220:223], a[124:127], a[44:47]
  s_waitcnt lgkmcnt(6)
  v_mfma_f32_16x16x32_bf16 a[48:51], a[224:227], a[112:115], a[48:51]
  ds_read_b64_tr_b16 a[204:205], v15 offset:0
  v_mfma_f32_16x16x32_bf16 a[52:55], a[224:227], a[116:119], a[52:55]
  ds_read_b64_tr_b16 a[206:207], v15 offset:4096
  v_mfma_f32_16x16x32_bf16 a[56:59], a[224:227], a[120:123], a[56:59]
  v_mfma_f32_16x16x32_bf16 a[60:63], a[224:227], a[124:127], a[60:63]
  s_cmp_eq_u32 s51, 1
  s_cselect_b32 s30, 0, s30
  s_add_u32 s48, s48, 36864
  s_cmp_ge_u32 s48, 147456
  s_cselect_b32 s49, 0xfffe5000, s50
  s_cselect_b32 s48, 0, s48
  s_waitcnt lgkmcnt(6)
  v_mfma_f32_16x16x32_bf16 v[32:35], a[192:195], a[128:131], v[32:35]
  ds_read_b64_tr_b16 a[208:209], v16 offset:0
  v_mfma_f32_16x16x32_bf16 v[36:39], a[192:195], a[132:135], v[36:39]
  ds_read_b64_tr_b16 a[210:211], v16 offset:4096
  v_mfma_f32_16x16x32_bf16 v[40:43], a[192:195], a[136:139], v[40:43]
  s_add_u32 s60, s55, s42
  s_mov_b32 s61, s54
  s_add_u32 m0, s60, 0
  s_nop 0
  buffer_load_dwordx4 v8, s[24:27], s61 offen lds
  v_mfma_f32_16x16x32_bf16 v[44:47], a[192:195], a[140:143], v[44:47]
  s_waitcnt lgkmcnt(6)
  v_mfma_f32_16x16x32_bf16 v[48:51], a[196:199], a[128:131], v[48:51]
  ds_read_b64_tr_b16 a[212:213], v17 offset:0
  v_mfma_f32_16x16x32_bf16 v[52:55], a[196:199], a[132:135], v[52:55]
  ds_read_b64_tr_b16 a[214:215], v17 offset:4096
  v_mfma_f32_16x16x32_bf16 v[56:59], a[196:199], a[136:139], v[56:59]
  s_add_u32 m0, s60, 1024
  s_nop 0
  buffer_load_dwordx4 v9, s[24:27], s61 offen lds
  s_add_u32 s61, s61, s65
  v_mfma_f32_16x16x32_bf16 v[60:63], a[196:199], a[140:143], v[60:63]
  s_waitcnt lgkmcnt(6)
  v_mfma_f32_16x16x32_bf16 v[64:67], a[200:203], a[128:131], v[64:67]
  ds_read_b64_tr_b16 a[216:217], v18 offset:0
  v_mfma_f32_16x16x32_bf16 v[68:71], a[200:203], a[132:135], v[68:71]
  ds_read_b64_tr_b16 a[218:219], v18 offset:4096
  v_mfma_f32_16x16x32_bf16 v[72:75], a[200:203], a[136:139], v[72:75]
  v_mfma_f32_16x16x32_bf16 v[76:79], a[200:203], a[140:143], v[76:79]
  s_waitcnt lgkmcnt(6)
  v_mfma_f32_16x16x32_bf16 v[80:83], a[204:207], a[128:131], v[80:83]
  ds_read_b64_tr_b16 a[220:221], v19 offset:0
  v_mfma_f32_16x16x32_bf16 v[84:87], a[204:207], a[132:135], v[84:87]
  ds_read_b64_tr_b16 a[222:223], v19 offset:4096
  v_mfma_f32_16x16x32_bf16 v[88:91], a[204:207], a[136:139], v[88:91]
  s_add_u32 m0, s60, 2048
  s_nop 0
  buffer_load_dwordx4 v8, s[24:27], s61 offen lds
  v_mfma_f32_16x16x32_bf16 v[92:95], a[204:207], a[140:143], v[92:95]
  s_waitcnt lgkmcnt(6)
  v_mfma_f32_16x16x32_bf16 v[96:99], a[208:211], a[128:131], v[96:99]
  ds_read_b64_tr_b16 a[224:225], v20 offset:0
  v_mfma_f32_16x16x32_bf16 v[100:103], a[208:211], a[132:135], v[100:103]
  ds_read_b64_tr_b16 a[226:227], v20 offset:512
  v_mfma_f32_16x16x32_bf16 v[104:107], a[208:211], a[136:139], v[104:107]
  v_mfma_f32_16x16x32_bf16 v[108:111], a[208:211], a[140:143], v[108:111]
  s_waitcnt lgkmcnt(6)
  v_mfma_f32_16x16x32_bf16 v[112:115], a[212:215], a[128:131], v[112:115]
  ds_read_b64_tr_b16 a[192:193], v12 offset:18432
  v_mfma_f32_16x16x32_bf16 v[116:119], a[212:215], a[132:135], v[116:119]
  ds_read_b64_tr_b16 a[194:195], v12 offset:22528
  v_mfma_f32_16x16x32_bf16 v[120:123], a[212:215], a[136:139], v[120:123]
  s_add_u32 m0, s60, 3072
  s_nop 0
  buffer_load_dwordx4 v9, s[24:27], s61 offen lds
  s_add_u32 s61, s61, s65
  v_mfma_f32_16x16x32_bf16 v[124:127], a[212:215], a[140:143], v[124:127]
  s_waitcnt lgkmcnt(6)
  v_mfma_f32_16x16x32_bf16 v[128:131], a[216:219], a[128:131], v[128:131]
  ds_read_b64_tr_b16 a[196:197], v13 offset:18432
  v_mfma_f32_16x16x32_bf16 v[132:135], a[216:219], a[132:135], v[132:135]
  ds_read_b64_tr_b16 a[198:199], v13 offset:22528
  v_mfma_f32_16x16x32_bf16 v[136:139], a[216:219], a[136:139], v[136:139]
  v_mfma_f32_16x16x32_bf16 v[140:143], a[216:219], a[140:143], v[140:143]
  s_waitcnt lgkmcnt(6)
  v_mfma_f32_16x16x32_bf16 v[144:147], a[220:223], a[128:131], v[144:147]
  ds_read_b64_tr_b16 a[200:201], v14 offset:18432
  v_mfma_f32_16x16x32_bf16 v[148:151], a[220:223], a[132:135], v[148:151]
  ds_read_b64_tr_b16 a[202:203], v14 offset:22528
  v_mfma_f32_16x16x32_bf16 v[152:155], a[220:223], a[136:139], v[152:155]
  s_add_u32 m0, s60, 4096
  s_nop 0
  buffer_load_dwordx4 v8, s[24:27], s61 offen lds
  v_mfma_f32_16x16x32_bf16 v[156:159], a[220:223], a[140:143], v[156:159]
  s_waitcnt lgkmcnt(6)
  v_mfma_f32_16x16x32_bf16 v[160:163], a[224:227], a[128:131], v[160:163]
  ds_read_b64_tr_b16 a[204:205], v15 offset:18432
  v_mfma_f32_16x16x32_bf16 v[164:167], a[224:227], a[132:135], v[164:167]
  ds_read_b64_tr_b16 a[206:207], v15 offset:22528
  v_mfma_f32_16x16x32_bf16 v[168:171], a[224:227], a[136:139], v[168:171]
  s_add_u32 m0, s60, 5120
  s_nop 0
  buffer_load_dwordx4 v9, s[24:27], s61 offen lds
  s_add_u32 s61, s61, s65
  v_mfma_f32_16x16x32_bf16 v[172:175], a[224:227], a[140:143], v[172:175]
  s_waitcnt lgkmcnt(6)
  v_mfma_f32_16x16x32_bf16 v[176:179], a[192:195], a[128:131], v[176:179]
  ds_read_b64_tr_b16 a[208:209], v16 offset:18432
  v_mfma_f32_16x16x32_bf16 v[180:183], a[192:195], a[132:135], v[180:183]
  ds_read_b64_tr_b16 a[210:211], v16 offset:22528
  v_mfma_f32_16x16x32_bf16 v[184:187], a[192:195], a[136:139], v[184:187]
  v_mfma_f32_16x16x32_bf16 v[188:191], a[192:195], a[140:143], v[188:191]
  s_waitcnt lgkmcnt(6)
  v_mfma_f32_16x16x32_bf16 v[192:195], a[196:199], a[128:131], v[192:195]
  ds_read_b64_tr_b16 a[212:213], v17 offset:18432
  v_mfma_f32_16x16x32_bf16 v[196:199], a[196:199], a[132:135], v[196:199]
  ds_read_b64_tr_b16 a[214:215], v17 offset:22528
  v_mfma_f32_16x16x32_bf16 v[200:203], a[196:199], a[136:139], v[200:203]
  s_add_u32 m0, s60, 6144
  s_nop 0
  buffer_load_dwordx4 v8, s[24:27], s61 offen lds
  v_mfma_f32_16x16x32_bf16 v[204:207], a[196:199], a[140:143], v[204:207]
  s_waitcnt lgkmcnt(6)
  v_mfma_f32_16x16x32_bf16 v[208:211], a[200:203], a[128:131], v[208:211]
  ds_read_b64_tr_b16 a[216:217], v18 offset:18432
  v_mfma_f32_16x16x32_bf16 v[212:215], a[200:203], a[132:135], v[212:215]
  ds_read_b64_tr_b16 a[218:219], v18 offset:22528
  v_mfma_f32_16x16x32_bf16 v[216:219], a[200:203], a[136:139], v[216:219]
  v_mfma_f32_16x16x32_bf16 v[220:223], a[200:203], a[140:143], v[220:223]
  s_waitcnt lgkmcnt(6)
  v_mfma_f32_16x16x32_bf16 v[224:227], a[204:207], a[128:131], v[224:227]
  ds_read_b64_tr_b16 a[220:221], v19 offset:18432
  v_mfma_f32_16x16x32_bf16 v[228:231], a[204:207], a[132:135], v[228:231]
  ds_read_b64_tr_b16 a[222:223], v19 offset:22528
  v_mfma_f32_16x16x32_bf16 v[232:235], a[204:207], a[136:139], v[232:235]
  s_add_u32 m0, s60, 7168
  s_nop 0
  buffer_load_dwordx4 v9, s[24:27], s61 offen lds
  v_mfma_f32_16x16x32_bf16 v[236:239], a[204:207], a[140:143], v[236:239]
  s_waitcnt lgkmcnt(6)
  v_mfma_f32_16x16x32_bf16 v[240:243], a[208:211], a[128:131], v[240:243]
  ds_read_b64_tr_b16 a[224:225], v20 offset:18432
  v_mfma_f32_16x16x32_bf16 v[244:247], a[208:211], a[132:135], v[244:247]
  ds_read_b64_tr_b16 a[226:227], v20 offset:18944
  v_mfma_f32_16x16x32_bf16 v[248:251], a[208:211], a[136:139], v[248:251]
  v_mfma_f32_16x16x32_bf16 v[252:255], a[208:211], a[140:143], v[252:255]
  s_waitcnt lgkmcnt(6)
  v_mfma_f32_16x16x32_bf16 a[0:3], a[212:215], a[128:131], a[0:3]
  ds_read_b64_tr_b16 a[192:193], v12 offset:8192
  v_mfma_f32_16x16x32_bf16 a[4:7], a[212:215], a[132:135], a[4:7]
  ds_read_b64_tr_b16 a[194:195], v12 offset:12288
  v_mfma_f32_16x16x32_bf16 a[8:11], a[212:215], a[136:139], a[8:11]
  s_add_u32 m0, s55, s43
  s_nop 0
  buffer_load_dwordx4 v10, s[24:27], s54 offen lds
  s_add_u32 s54, s54, s66
  s_add_u32 s55, s55, 36864
  s_cmp_ge_u32 s55, 147456
  s_cselect_b32 s55, 0, s55
  v_mfma_f32_16x16x32_bf16 a[12:15], a[212:215], a[140:143], a[12:15]
  s_waitcnt lgkmcnt(6)
  v_mfma_f32_16x16x32_bf16 a[16:19], a[216:219], a[128:131], a[16:19]
  ds_read_b64_tr_b16 a[196:197], v13 offset:8192
  v_mfma_f32_16x16x32_bf16 a[20:23], a[216:219], a[132:135], a[20:23]
  ds_read_b64_tr_b16 a[198:199], v13 offset:12288
  v_mfma_f32_16x16x32_bf16 a[24:27], a[216:219], a[136:139], a[24:27]
  v_mfma_f32_16x16x32_bf16 a[28:31], a[216:219], a[140:143], a[28:31]
  s_waitcnt lgkmcnt(6)
  v_mfma_f32_16x16x32_bf16 a[32:35], a[220:223], a[128:131], a[32:35]
  ds_read_b64_tr_b16 a[200:201], v14 offset:8192
  v_mfma_f32_16x16x32_bf16 a[36:39], a[220:223], a[132:135], a[36:39]
  ds_read_b64_tr_b16 a[202:203], v14 offset:12288
  v_mfma_f32_16x16x32_bf16 a[40:43], a[220:223], a[136:139], a[40:43]
  buffer_load_dwordx4 a[96:99], v4, s[28:31], s46 offen offset:0 sc1
  v_mfma_f32_16x16x32_bf16 a[44:47], a[220:223], a[140:143], a[44:47]
  s_waitcnt lgkmcnt(6)
  v_mfma_f32_16x16x32_bf16 a[48:51], a[224:227], a[128:131], a[48:51]
  ds_read_b64_tr_b16 a[204:205], v15 offset:8192
  v_mfma_f32_16x16x32_bf16 a[52:55], a[224:227], a[132:135], a[52:55]
  ds_read_b64_tr_b16 a[206:207], v15 offset:12288
  v_mfma_f32_16x16x32_bf16 a[56:59], a[224:227], a[136:139], a[56:59]
  buffer_load_dwordx4 a[100:103], v5, s[28:31], s46 offen offset:0 sc1
  v_mfma_f32_16x16x32_bf16 a[60:63], a[224:227], a[140:143], a[60:63]
  s_waitcnt lgkmcnt(6)
  v_mfma_f32_16x16x32_bf16 v[32:35], a[192:195], a[144:147], v[32:35]
  ds_read_b64_tr_b16 a[208:209], v16 offset:8192
  v_mfma_f32_16x16x32_bf16 v[36:39], a[192:195], a[148:151], v[36:39]
  ds_read_b64_tr_b16 a[210:211], v16 offset:12288
  v_mfma_f32_16x16x32_bf16 v[40:43], a[192:195], a[152:155], v[40:43]
  v_mfma_f32_16x16x32_bf16 v[44:47], a[192:195], a[156:159], v[44:47]
  s_waitcnt lgkmcnt(6)
  v_mfma_f32_16x16x32_bf16 v[48:51], a[196:199], a[144:147], v[48:51]
  ds_read_b64_tr_b16 a[212:213], v17 offset:8192
  v_mfma_f32_16x16x32_bf16 v[52:55], a[196:199], a[148:151], v[52:55]
  ds_read_b64_tr_b16 a[214:215], v17 offset:12288
  v_mfma_f32_16x16x32_bf16 v[56:59], a[196:199], a[152:155], v[56:59]
  buffer_load_dwordx4 a[104:107], v6, s[28:31], s46 offen offset:0 sc1
  v_mfma_f32_16x16x32_bf16 v[60:63], a[196:199], a[156:159], v[60:63]
  s_waitcnt lgkmcnt(6)
  v_mfma_f32_16x16x32_bf16 v[64:67], a[200:203], a[144:147], v[64:67]
  ds_read_b64_tr_b16 a[216:217], v18 offset:8192
  v_mfma_f32_16x16x32_bf16 v[68:71], a[200:203], a[148:151], v[68:71]
  ds_read_b64_tr_b16 a[218:219], v18 offset:12288
  v_mfma_f32_16x16x32_bf16 v[72:75], a[200:203], a[152:155], v[72:75]
  v_mfma_f32_16x16x32_bf16 v[76:79], a[200:203], a[156:159], v[76:79]
  s_waitcnt lgkmcnt(6)
  v_mfma_f32_16x16x32_bf16 v[80:83], a[204:207], a[144:147], v[80:83]
  ds_read_b64_tr_b16 a[220:221], v19 offset:8192
  v_mfma_f32_16x16x32_bf16 v[84:87], a[204:207], a[148:151], v[84:87]
  ds_read_b64_tr_b16 a[222:223], v19 offset:12288
  v_mfma_f32_16x16x32_bf16 v[88:91], a[204:207], a[152:155], v[88:91]
  buffer_load_dwordx4 a[108:111], v7, s[28:31], s46 offen offset:0 sc1
  v_mfma_f32_16x16x32_bf16 v[92:95], a[204:207], a[156:159], v[92:95]
  s_waitcnt lgkmcnt(6)
  v_mfma_f32_16x16x32_bf16 v[96:99], a[208:211], a[144:147], v[96:99]
  ds_read_b64_tr_b16 a[224:225], v20 offset:1024
  v_mfma_f32_16x16x32_bf16 v[100:103], a[208:211], a[148:151], v[100:103]
  ds_read_b64_tr_b16 a[226:227], v20 offset:1536
  v_mfma_f32_16x16x32_bf16 v[104:107], a[208:211], a[152:155], v[104:107]
  v_mfma_f32_16x16x32_bf16 v[108:111], a[208:211], a[156:159], v[108:111]
  s_waitcnt lgkmcnt(6)
  v_mfma_f32_16x16x32_bf16 v[112:115], a[212:215], a[144:147], v[112:115]
  ds_read_b64_tr_b16 a[192:193], v12 offset:26624
  v_mfma_f32_16x16x32_bf16 v[116:119], a[212:215], a[148:151], v[116:119]
  ds_read_b64_tr_b16 a[194:195], v12 offset:30720
  v_add_u32 v12, s49, v12
  v_mfma_f32_16x16x32_bf16 v[120:123], a[212:215], a[152:155], v[120:123]
  buffer_load_dwordx4 a[112:115], v4, s[28:31], s46 offen offset:1024 sc1
  v_mfma_f32_16x16x32_bf16 v[124:127], a[212:215], a[156:159], v[124:127]
  s_waitcnt lgkmcnt(6)
  v_mfma_f32_16x16x32_bf16 v[128:131], a[216:219], a[144:147], v[128:131]
  ds_read_b64_tr_b16 a[196:197], v13 offset:26624
  v_mfma_f32_16x16x32_bf16 v[132:135], a[216:219], a[148:151], v[132:135]
  ds_read_b64_tr_b16 a[198:199], v13 offset:30720
  v_add_u32 v13, s49, v13
  v_mfma_f32_16x16x32_bf16 v[136:139], a[216:219], a[152:155], v[136:139]
  buffer_load_dwordx4 a[116:119], v5, s[28:31], s46 offen offset:1024 sc1
  v_mfma_f32_16x16x32_bf16 v[140:143], a[216:219], a[156:159], v[140:143]
  s_waitcnt lgkmcnt(6)
  v_mfma_f32_16x16x32_bf16 v[144:147], a[220:223], a[144:147], v[144:147]
  ds_read_b64_tr_b16 a[200:201], v14 offset:26624
  v_mfma_f32_16x16x32_bf16 v[148:151], a[220:223], a[148:151], v[148:151]
  ds_read_b64_tr_b16 a[202:203], v14 offset:30720
  v_add_u32 v14, s49, v14
  v_mfma_f32_16x16x32_bf16 v[152:155], a[220:223], a[152:155], v[152:155]
  v_mfma_f32_16x16x32_bf16 v[156:159], a[220:223], a[156:159], v[156:159]
  s_waitcnt lgkmcnt(6)
  v_mfma_f32_16x16x32_bf16 v[160:163], a[224:227], a[144:147], v[160:163]
  ds_read_b64_tr_b16 a[204:205], v15 offset:26624
  v_mfma_f32_16x16x32_bf16 v[164:167], a[224:227], a[148:151], v[164:167]
  ds_read_b64_tr_b16 a[206:207], v15 offset:30720
  v_add_u32 v15, s49, v15
  v_mfma_f32_16x16x32_bf16 v[168:171], a[224:227], a[152:155], v[168:171]
  buffer_load_dwordx4 a[120:123], v6, s[28:31], s46 offen offset:1024 sc1
  v_mfma_f32_16x16x32_bf16 v[172:175], a[224:227], a[156:159], v[172:175]
  s_waitcnt lgkmcnt(6)
  v_mfma_f32_16x16x32_bf16 v[176:179], a[192:195], a[144:147], v[176:179]
  ds_read_b64_tr_b16 a[208:209], v16 offset:26624
  v_mfma_f32_16x16x32_bf16 v[180:183], a[192:195], a[148:151], v[180:183]
  ds_read_b64_tr_b16 a[210:211], v16 offset:30720
  v_add_u32 v16, s49, v16
  v_mfma_f32_16x16x32_bf16 v[184:187], a[192:195], a[152:155], v[184:187]
  v_mfma_f32_16x16x32_bf16 v[188:191], a[192:195], a[156:159], v[188:191]
  s_waitcnt lgkmcnt(6)
  v_mfma_f32_16x16x32_bf16 v[192:195], a[196:199], a[144:147], v[192:195]
  ds_read_b64_tr_b16 a[212:213], v17 offset:26624
  v_mfma_f32_16x16x32_bf16 v[196:199], a[196:199], a[148:151], v[196:199]
  ds_read_b64_tr_b16 a[214:215], v17 offset:30720
  v_add_u32 v17, s49, v17
  v_mfma_f32_16x16x32_bf16 v[200:203], a[196:199], a[152:155], v[200:203]
  buffer_load_dwordx4 a[124:127], v7, s[28:31], s46 offen offset:1024 sc1
  s_add_u32 s46, s46, 2048
  v_mfma_f32_16x16x32_bf16 v[204:207], a[196:199], a[156:159], v[204:207]
  s_waitcnt lgkmcnt(6)
  v_mfma_f32_16x16x32_bf16 v[208:211], a[200:203], a[144:147], v[208:211]
  ds_read_b64_tr_b16 a[216:217], v18 offset:26624
  v_mfma_f32_16x16x32_bf16 v[212:215], a[200:203], a[148:151], v[212:215]
  ds_read_b64_tr_b16 a[218:219], v18 offset:30720
  v_add_u32 v18, s49, v18
  v_mfma_f32_16x16x32_bf16 v[216:219], a[200:203], a[152:155], v[216:219]
  v_mfma_f32_16x16x32_bf16 v[220:223], a[200:203], a[156:159], v[220:223]
  s_waitcnt lgkmcnt(6)
  v_mfma_f32_16x16x32_bf16 v[224:227], a[204:207], a[144:147], v[224:227]
  ds_read_b64_tr_b16 a[220:221], v19 offset:26624
  v_mfma_f32_16x16x32_bf16 v[228:231], a[204:207], a[148:151], v[228:231]
  ds_read_b64_tr_b16 a[222:223], v19 offset:30720
  v_add_u32 v19, s49, v19
  v_mfma_f32_16x16x32_bf16 v[232:235], a[204:207], a[152:155], v[232:235]
  buffer_load_dword a229, v24, s[56:59], s67 offen
  s_add_u32 s67, s67, 180224
  v_mfma_f32_16x16x32_bf16 v[236:239], a[204:207], a[156:159], v[236:239]
  s_waitcnt lgkmcnt(6)
  v_mfma_f32_16x16x32_bf16 v[240:243], a[208:211], a[144:147], v[240:243]
  ds_read_b64_tr_b16 a[224:225], v20 offset:19456
  v_mfma_f32_16x16x32_bf16 v[244:247], a[208:211], a[148:151], v[244:247]
  ds_read_b64_tr_b16 a[226:227], v20 offset:19968
  v_add_u32 v20, s49, v20
  v_mfma_f32_16x16x32_bf16 v[248:251], a[208:211], a[152:155], v[248:251]
  v_mfma_f32_16x16x32_bf16 v[252:255], a[208:211], a[156:159], v[252:255]
  s_waitcnt vmcnt(26)
  s_barrier
  s_waitcnt lgkmcnt(6)
  v_mfma_f32_16x16x32_bf16 a[0:3], a[212:215], a[144:147], a[0:3]
  ds_read_b64_tr_b16 a[192:193], v12 offset:0
  v_mfma_f32_16x16x32_bf16 a[4:7], a[212:215], a[148:151], a[4:7]
  ds_read_b64_tr_b16 a[194:195], v12 offset:4096
  v_mfma_f32_16x16x32_bf16 a[8:11], a[212:215], a[152:155], a[8:11]
  v_mfma_f32_16x16x32_bf16 a[12:15], a[212:215], a[156:159], a[12:15]
  s_waitcnt lgkmcnt(6)
  v_mfma_f32_16x16x32_bf16 a[16:19], a[216:219], a[144:147], a[16:19]
  ds_read_b64_tr_b16 a[196:197], v13 offset:0
  v_mfma_f32_16x16x32_bf16 a[20:23], a[216:219], a[148:151], a[20:23]
  ds_read_b64_tr_b16 a[198:199], v13 offset:4096
  v_mfma_f32_16x16x32_bf16 a[24:27], a[216:219], a[152:155], a[24:27]
  v_mfma_f32_16x16x32_bf16 a[28:31], a[216:219], a[156:159], a[28:31]
  s_waitcnt lgkmcnt(6)
  v_mfma_f32_16x16x32_bf16 a[32:35], a[220:223], a[144:147], a[32:35]
  ds_read_b64_tr_b16 a[200:201], v14 offset:0
  v_mfma_f32_16x16x32_bf16 a[36:39], a[220:223], a[148:151], a[36:39]
  ds_read_b64_tr_b16 a[202:203], v14 offset:4096
  v_mfma_f32_16x16x32_bf16 a[40:43], a[220:223], a[152:155], a[40:43]
  v_mfma_f32_16x16x32_bf16 a[44:47], a[220:223], a[156:159], a[44:47]
  s_waitcnt lgkmcnt(6)
  v_mfma_f32_16x16x32_bf16 a[48:51], a[224:227], a[144:147], a[48:51]
  ds_read_b64_tr_b16 a[204:205], v15 offset:0
  v_mfma_f32_16x16x32_bf16 a[52:55], a[224:227], a[148:151], a[52:55]
  ds_read_b64_tr_b16 a[206:207], v15 offset:4096
  v_mfma_f32_16x16x32_bf16 a[56:59], a[224:227], a[152:155], a[56:59]
  v_mfma_f32_16x16x32_bf16 a[60:63], a[224:227], a[156:159], a[60:63]
  s_cmp_eq_u32 s51, 1
  s_cbranch_scc1 mega_kernel_super150
  s_add_u32 s48, s48, 36864
  s_cmp_ge_u32 s48, 147456
  s_cselect_b32 s49, 0xfffe5000, s50
  s_cselect_b32 s48, 0, s48
  s_waitcnt lgkmcnt(6)
  v_mfma_f32_16x16x32_bf16 v[32:35], a[192:195], a[160:163], v[32:35]
  ds_read_b64_tr_b16 a[208:209], v16 offset:0
  v_mfma_f32_16x16x32_bf16 v[36:39], a[192:195], a[164:167], v[36:39]
  ds_read_b64_tr_b16 a[210:211], v16 offset:4096
  v_mfma_f32_16x16x32_bf16 v[40:43], a[192:195], a[168:171], v[40:43]
  s_add_u32 s60, s55, s42
  s_mov_b32 s61, s54
  s_add_u32 m0, s60, 0
  s_nop 0
  buffer_load_dwordx4 v8, s[24:27], s61 offen lds
  v_mfma_f32_16x16x32_bf16 v[44:47], a[192:195], a[172:175], v[44:47]
  s_waitcnt lgkmcnt(6)
  v_mfma_f32_16x16x32_bf16 v[48:51], a[196:199], a[160:163], v[48:51]
  ds_read_b64_tr_b16 a[212:213], v17 offset:0
  v_mfma_f32_16x16x32_bf16 v[52:55], a[196:199], a[164:167], v[52:55]
  ds_read_b64_tr_b16 a[214:215], v17 offset:4096
  v_mfma_f32_16x16x32_bf16 v[56:59], a[196:199], a[168:171], v[56:59]
  s_add_u32 m0, s60, 1024
  s_nop 0
  buffer_load_dwordx4 v9, s[24:27], s61 offen lds
  s_add_u32 s61, s61, s65
  v_mfma_f32_16x16x32_bf16 v[60:63], a[196:199], a[172:175], v[60:63]
  s_waitcnt lgkmcnt(6)
  v_mfma_f32_16x16x32_bf16 v[64:67], a[200:203], a[160:163], v[64:67]
  ds_read_b64_tr_b16 a[216:217], v18 offset:0
  v_mfma_f32_16x16x32_bf16 v[68:71], a[200:203], a[164:167], v[68:71]
  ds_read_b64_tr_b16 a[218:219], v18 offset:4096
  v_mfma_f32_16x16x32_bf16 v[72:75], a[200:203], a[168:171], v[72:75]
  v_mfma_f32_16x16x32_bf16 v[76:79], a[200:203], a[172:175], v[76:79]
  s_waitcnt lgkmcnt(6)
  v_mfma_f32_16x16x32_bf16 v[80:83], a[204:207], a[160:163], v[80:83]
  ds_read_b64_tr_b16 a[220:221], v19 offset:0
  v_mfma_f32_16x16x32_bf16 v[84:87], a[204:207], a[164:167], v[84:87]
  ds_read_b64_tr_b16 a[222:223], v19 offset:4096
  v_mfma_f32_16x16x32_bf16 v[88:91], a[204:207], a[168:171], v[88:91]
  s_add_u32 m0, s60, 2048
  s_nop 0
  buffer_load_dwordx4 v8, s[24:27], s61 offen lds
  v_mfma_f32_16x16x32_bf16 v[92:95], a[204:207], a[172:175], v[92:95]
  s_waitcnt lgkmcnt(6)
  v_mfma_f32_16x16x32_bf16 v[96:99], a[208:211], a[160:163], v[96:99]
  ds_read_b64_tr_b16 a[224:225], v20 offset:0
  v_mfma_f32_16x16x32_bf16 v[100:103], a[208:211], a[164:167], v[100:103]
  ds_read_b64_tr_b16 a[226:227], v20 offset:512
  v_mfma_f32_16x16x32_bf16 v[104:107], a[208:211], a[168:171], v[104:107]
  v_mfma_f32_16x16x32_bf16 v[108:111], a[208:211], a[172:175], v[108:111]
  s_waitcnt lgkmcnt(6)
  v_mfma_f32_16x16x32_bf16 v[112:115], a[212:215], a[160:163], v[112:115]
  ds_read_b64_tr_b16 a[192:193], v12 offset:18432
  v_mfma_f32_16x16x32_bf16 v[116:119], a[212:215], a[164:167], v[116:119]
  ds_read_b64_tr_b16 a[194:195], v12 offset:22528
  v_mfma_f32_16x16x32_bf16 v[120:123], a[212:215], a[168:171], v[120:123]
  s_add_u32 m0, s60, 3072
  s_nop 0
  buffer_load_dwordx4 v9, s[24:27], s61 offen lds
  s_add_u32 s61, s61, s65
  v_mfma_f32_16x16x32_bf16 v[124:127], a[212:215], a[172:175], v[124:127]
  s_waitcnt lgkmcnt(6)
  v_mfma_f32_16x16x32_bf16 v[128:131], a[216:219], a[160:163], v[128:131]
  ds_read_b64_tr_b16 a[196:197], v13 offset:18432
  v_mfma_f32_16x16x32_bf16 v[132:135], a[216:219], a[164:167], v[132:135]
  ds_read_b64_tr_b16 a[198:199], v13 offset:22528
  v_mfma_f32_16x16x32_bf16 v[136:139], a[216:219], a[168:171], v[136:139]
  v_mfma_f32_16x16x32_bf16 v[140:143], a[216:219], a[172:175], v[140:143]
  s_waitcnt lgkmcnt(6)
  v_mfma_f32_16x16x32_bf16 v[144:147], a[220:223], a[160:163], v[144:147]
  ds_read_b64_tr_b16 a[200:201], v14 offset:18432
  v_mfma_f32_16x16x32_bf16 v[148:151], a[220:223], a[164:167], v[148:151]
  ds_read_b64_tr_b16 a[202:203], v14 offset:22528
  v_mfma_f32_16x16x32_bf16 v[152:155], a[220:223], a[168:171], v[152:155]
  s_add_u32 m0, s60, 4096
  s_nop 0
  buffer_load_dwordx4 v8, s[24:27], s61 offen lds
  v_mfma_f32_16x16x32_bf16 v[156:159], a[220:223], a[172:175], v[156:159]
  s_waitcnt lgkmcnt(6)
  v_mfma_f32_16x16x32_bf16 v[160:163], a[224:227], a[160:163], v[160:163]
  ds_read_b64_tr_b16 a[204:205], v15 offset:18432
  v_mfma_f32_16x16x32_bf16 v[164:167], a[224:227], a[164:167], v[164:167]
  ds_read_b64_tr_b16 a[206:207], v15 offset:22528
  v_mfma_f32_16x16x32_bf16 v[168:171], a[224:227], a[168:171], v[168:171]
  s_add_u32 m0, s60, 5120
  s_nop 0
  buffer_load_dwordx4 v9, s[24:27], s61 offen lds
  s_add_u32 s61, s61, s65
  v_mfma_f32_16x16x32_bf16 v[172:175], a[224:227], a[172:175], v[172:175]
  s_waitcnt lgkmcnt(6)
  v_mfma_f32_16x16x32_bf16 v[176:179], a[192:195], a[160:163], v[176:179]
  ds_read_b64_tr_b16 a[208:209], v16 offset:18432
  v_mfma_f32_16x16x32_bf16 v[180:183], a[192:195], a[164:167], v[180:183]
  ds_read_b64_tr_b16 a[210:211], v16 offset:22528
  v_mfma_f32_16x16x32_bf16 v[184:187], a[192:195], a[168:171], v[184:187]
  v_mfma_f32_16x16x32_bf16 v[188:191], a[192:195], a[172:175], v[188:191]
  s_waitcnt lgkmcnt(6)
  v_mfma_f32_16x16x32_bf16 v[192:195], a[196:199], a[160:163], v[192:195]
  ds_read_b64_tr_b16 a[212:213], v17 offset:18432
  v_mfma_f32_16x16x32_bf16 v[196:199], a[196:199], a[164:167], v[196:199]
  ds_read_b64_tr_b16 a[214:215], v17 offset:22528
  v_mfma_f32_16x16x32_bf16 v[200:203], a[196:199], a[168:171], v[200:203]
  s_add_u32 m0, s60, 6144
  s_nop 0
  buffer_load_dwordx4 v8, s[24:27], s61 offen lds
  v_mfma_f32_16x16x32_bf16 v[204:207], a[196:199], a[172:175], v[204:207]
  s_waitcnt lgkmcnt(6)
  v_mfma_f32_16x16x32_bf16 v[208:211], a[200:203], a[160:163], v[208:211]
  ds_read_b64_tr_b16 a[216:217], v18 offset:18432
  v_mfma_f32_16x16x32_bf16 v[212:215], a[200:203], a[164:167], v[212:215]
  ds_read_b64_tr_b16 a[218:219], v18 offset:22528
  v_mfma_f32_16x16x32_bf16 v[216:219], a[200:203], a[168:171], v[216:219]
  v_mfma_f32_16x16x32_bf16 v[220:223], a[200:203], a[172:175], v[220:223]
  s_waitcnt lgkmcnt(6)
  v_mfma_f32_16x16x32_bf16 v[224:227], a[204:207], a[160:163], v[224:227]
  ds_read_b64_tr_b16 a[220:221], v19 offset:18432
  v_mfma_f32_16x16x32_bf16 v[228:231], a[204:207], a[164:167], v[228:231]
  ds_read_b64_tr_b16 a[222:223], v19 offset:22528
  v_mfma_f32_16x16x32_bf16 v[232:235], a[204:207], a[168:171], v[232:235]
  s_add_u32 m0, s60, 7168
  s_nop 0
  buffer_load_dwordx4 v9, s[24:27], s61 offen lds
  v_mfma_f32_16x16x32_bf16 v[236:239], a[204:207], a[172:175], v[236:239]
  s_waitcnt lgkmcnt(6)
  v_mfma_f32_16x16x32_bf16 v[240:243], a[208:211], a[160:163], v[240:243]
  ds_read_b64_tr_b16 a[224:225], v20 offset:18432
  v_mfma_f32_16x16x32_bf16 v[244:247], a[208:211], a[164:167], v[244:247]
  ds_read_b64_tr_b16 a[226:227], v20 offset:18944
  v_mfma_f32_16x16x32_bf16 v[248:251], a[208:211], a[168:171], v[248:251]
  v_mfma_f32_16x16x32_bf16 v[252:255], a[208:211], a[172:175], v[252:255]
  s_waitcnt lgkmcnt(6)
  v_mfma_f32_16x16x32_bf16 a[0:3], a[212:215], a[160:163], a[0:3]
  ds_read_b64_tr_b16 a[192:193], v12 offset:8192
  v_mfma_f32_16x16x32_bf16 a[4:7], a[212:215], a[164:167], a[4:7]
  ds_read_b64_tr_b16 a[194:195], v12 offset:12288
  v_mfma_f32_16x16x32_bf16 a[8:11], a[212:215], a[168:171], a[8:11]
  s_add_u32 m0, s55, s43
  s_nop 0
  buffer_load_dwordx4 v10, s[24:27], s54 offen lds
  s_add_u32 s54, s54, s66
  s_add_u32 s55, s55, 36864
  s_cmp_ge_u32 s55, 147456
  s_cselect_b32 s55, 0, s55
  v_mfma_f32_16x16x32_bf16 a[12:15], a[212:215], a[172:175], a[12:15]
  s_waitcnt lgkmcnt(6)
  v_mfma_f32_16x16x32_bf16 a[16:19], a[216:219], a[160:163], a[16:19]
  ds_read_b64_tr_b16 a[196:197], v13 offset:8192
  v_mfma_f32_16x16x32_bf16 a[20:23], a[216:219], a[164:167], a[20:23]
  ds_read_b64_tr_b16 a[198:199], v13 offset:12288
  v_mfma_f32_16x16x32_bf16 a[24:27], a[216:219], a[168:171], a[24:27]
  v_mfma_f32_16x16x32_bf16 a[28:31], a[216:219], a[172:175], a[28:31]
  s_waitcnt lgkmcnt(6)
  v_mfma_f32_16x16x32_bf16 a[32:35], a[220:223], a[160:163], a[32:35]
  ds_read_b64_tr_b16 a[200:201], v14 offset:8192
  v_mfma_f32_16x16x32_bf16 a[36:39], a[220:223], a[164:167], a[36:39]
  ds_read_b64_tr_b16 a[202:203], v14 offset:12288
  v_mfma_f32_16x16x32_bf16 a[40:43], a[220:223], a[168:171], a[40:43]
  buffer_load_dwordx4 a[128:131], v4, s[28:31], s46 offen offset:0 sc1
  v_mfma_f32_16x16x32_bf16 a[44:47], a[220:223], a[172:175], a[44:47]
  s_waitcnt lgkmcnt(6)
  v_mfma_f32_16x16x32_bf16 a[48:51], a[224:227], a[160:163], a[48:51]
  ds_read_b64_tr_b16 a[204:205], v15 offset:8192
  v_mfma_f32_16x16x32_bf16 a[52:55], a[224:227], a[164:167], a[52:55]
  ds_read_b64_tr_b16 a[206:207], v15 offset:12288
  v_mfma_f32_16x16x32_bf16 a[56:59], a[224:227], a[168:171], a[56:59]
  buffer_load_dwordx4 a[132:135], v5, s[28:31], s46 offen offset:0 sc1
  v_mfma_f32_16x16x32_bf16 a[60:63], a[224:227], a[172:175], a[60:63]
  s_waitcnt lgkmcnt(6)
  v_mfma_f32_16x16x32_bf16 v[32:35], a[192:195], a[176:179], v[32:35]
  ds_read_b64_tr_b16 a[208:209], v16 offset:8192
  v_mfma_f32_16x16x32_bf16 v[36:39], a[192:195], a[180:183], v[36:39]
  ds_read_b64_tr_b16 a[210:211], v16 offset:12288
  v_mfma_f32_16x16x32_bf16 v[40:43], a[192:195], a[184:187], v[40:43]
  v_mfma_f32_16x16x32_bf16 v[44:47], a[192:195], a[188:191], v[44:47]
  s_waitcnt lgkmcnt(6)
  v_mfma_f32_16x16x32_bf16 v[48:51], a[196:199], a[176:179], v[48:51]
  ds_read_b64_tr_b16 a[212:213], v17 offset:8192
  v_mfma_f32_16x16x32_bf16 v[52:55], a[196:199], a[180:183], v[52:55]
  ds_read_b64_tr_b16 a[214:215], v17 offset:12288
  v_mfma_f32_16x16x32_bf16 v[56:59], a[196:199], a[184:187], v[56:59]
  buffer_load_dwordx4 a[136:139], v6, s[28:31], s46 offen offset:0 sc1
  v_mfma_f32_16x16x32_bf16 v[60:63], a[196:199], a[188:191], v[60:63]
  s_waitcnt lgkmcnt(6)
  v_mfma_f32_16x16x32_bf16 v[64:67], a[200:203], a[176:179], v[64:67]
  ds_read_b64_tr_b16 a[216:217], v18 offset:8192
  v_mfma_f32_16x16x32_bf16 v[68:71], a[200:203], a[180:183], v[68:71]
  ds_read_b64_tr_b16 a[218:219], v18 offset:12288
  v_mfma_f32_16x16x32_bf16 v[72:75], a[200:203], a[184:187], v[72:75]
  v_mfma_f32_16x16x32_bf16 v[76:79], a[200:203], a[188:191], v[76:79]
  s_waitcnt lgkmcnt(6)
  v_mfma_f32_16x16x32_bf16 v[80:83], a[204:207], a[176:179], v[80:83]
  ds_read_b64_tr_b16 a[220:221], v19 offset:8192
  v_mfma_f32_16x16x32_bf16 v[84:87], a[204:207], a[180:183], v[84:87]
  ds_read_b64_tr_b16 a[222:223], v19 offset:12288
  v_mfma_f32_16x16x32_bf16 v[88:91], a[204:207], a[184:187], v[88:91]
  buffer_load_dwordx4 a[140:143], v7, s[28:31], s46 offen offset:0 sc1
  v_mfma_f32_16x16x32_bf16 v[92:95], a[204:207], a[188:191], v[92:95]
  s_waitcnt lgkmcnt(6)
  v_mfma_f32_16x16x32_bf16 v[96:99], a[208:211], a[176:179], v[96:99]
  ds_read_b64_tr_b16 a[224:225], v20 offset:1024
  v_mfma_f32_16x16x32_bf16 v[100:103], a[208:211], a[180:183], v[100:103]
  ds_read_b64_tr_b16 a[226:227], v20 offset:1536
  v_mfma_f32_16x16x32_bf16 v[104:107], a[208:211], a[184:187], v[104:107]
  v_mfma_f32_16x16x32_bf16 v[108:111], a[208:211], a[188:191], v[108:111]
  s_waitcnt lgkmcnt(6)
  v_mfma_f32_16x16x32_bf16 v[112:115], a[212:215], a[176:179], v[112:115]
  ds_read_b64_tr_b16 a[192:193], v12 offset:26624
  v_mfma_f32_16x16x32_bf16 v[116:119], a[212:215], a[180:183], v[116:119]
  ds_read_b64_tr_b16 a[194:195], v12 offset:30720
  v_add_u32 v12, s49, v12
  v_mfma_f32_16x16x32_bf16 v[120:123], a[212:215], a[184:187], v[120:123]
  buffer_load_dwordx4 a[144:147], v4, s[28:31], s46 offen offset:1024 sc1
  v_mfma_f32_16x16x32_bf16 v[124:127], a[212:215], a[188:191], v[124:127]
  s_waitcnt lgkmcnt(6)
  v_mfma_f32_16x16x32_bf16 v[128:131], a[216:219], a[176:179], v[128:131]
  ds_read_b64_tr_b16 a[196:197], v13 offset:26624
  v_mfma_f32_16x16x32_bf16 v[132:135], a[216:219], a[180:183], v[132:135]
  ds_read_b64_tr_b16 a[198:199], v13 offset:30720
  v_add_u32 v13, s49, v13
  v_mfma_f32_16x16x32_bf16 v[136:139], a[216:219], a[184:187], v[136:139]
  buffer_load_dwordx4 a[148:151], v5, s[28:31], s46 offen offset:1024 sc1
  v_mfma_f32_16x16x32_bf16 v[140:143], a[216:219], a[188:191], v[140:143]
  s_waitcnt lgkmcnt(6)
  v_mfma_f32_16x16x32_bf16 v[144:147], a[220:223], a[176:179], v[144:147]
  ds_read_b64_tr_b16 a[200:201], v14 offset:26624
  v_mfma_f32_16x16x32_bf16 v[148:151], a[220:223], a[180:183], v[148:151]
  ds_read_b64_tr_b16 a[202:203], v14 offset:30720
  v_add_u32 v14, s49, v14
  v_mfma_f32_16x16x32_bf16 v[152:155], a[220:223], a[184:187], v[152:155]
  v_mfma_f32_16x16x32_bf16 v[156:159], a[220:223], a[188:191], v[156:159]
  s_waitcnt lgkmcnt(6)
  v_mfma_f32_16x16x32_bf16 v[160:163], a[224:227], a[176:179], v[160:163]
  ds_read_b64_tr_b16 a[204:205], v15 offset:26624
  v_mfma_f32_16x16x32_bf16 v[164:167], a[224:227], a[180:183], v[164:167]
  ds_read_b64_tr_b16 a[206:207], v15 offset:30720
  v_add_u32 v15, s49, v15
  v_mfma_f32_16x16x32_bf16 v[168:171], a[224:227], a[184:187], v[168:171]
  buffer_load_dwordx4 a[152:155], v6, s[28:31], s46 offen offset:1024 sc1
  v_mfma_f32_16x16x32_bf16 v[172:175], a[224:227], a[188:191], v[172:175]
  s_waitcnt lgkmcnt(6)
  v_mfma_f32_16x16x32_bf16 v[176:179], a[192:195], a[176:179], v[176:179]
  ds_read_b64_tr_b16 a[208:209], v16 offset:26624
  v_mfma_f32_16x16x32_bf16 v[180:183], a[192:195], a[180:183], v[180:183]
  ds_read_b64_tr_b16 a[210:211], v16 offset:30720
  v_add_u32 v16, s49, v16
  v_mfma_f32_16x16x32_bf16 v[184:187], a[192:195], a[184:187], v[184:187]
  v_mfma_f32_16x16x32_bf16 v[188:191], a[192:195], a[188:191], v[188:191]
  s_waitcnt lgkmcnt(6)
  v_mfma_f32_16x16x32_bf16 v[192:195], a[196:199], a[176:179], v[192:195]
  ds_read_b64_tr_b16 a[212:213], v17 offset:26624
  v_mfma_f32_16x16x32_bf16 v[196:199], a[196:199], a[180:183], v[196:199]
  ds_read_b64_tr_b16 a[214:215], v17 offset:30720
  v_add_u32 v17, s49, v17
  v_mfma_f32_16x16x32_bf16 v[200:203], a[196:199], a[184:187], v[200:203]
  buffer_load_dwordx4 a[156:159], v7, s[28:31], s46 offen offset:1024 sc1
  s_add_u32 s46, s46, 2048
  v_mfma_f32_16x16x32_bf16 v[204:207], a[196:199], a[188:191], v[204:207]
  s_waitcnt lgkmcnt(6)
  v_mfma_f32_16x16x32_bf16 v[208:211], a[200:203], a[176:179], v[208:211]
  ds_read_b64_tr_b16 a[216:217], v18 offset:26624
  v_mfma_f32_16x16x32_bf16 v[212:215], a[200:203], a[180:183], v[212:215]
  ds_read_b64_tr_b16 a[218:219], v18 offset:30720
  v_add_u32 v18, s49, v18
  v_mfma_f32_16x16x32_bf16 v[216:219], a[200:203], a[184:187], v[216:219]
  v_mfma_f32_16x16x32_bf16 v[220:223], a[200:203], a[188:191], v[220:223]
  s_waitcnt lgkmcnt(6)
  v_mfma_f32_16x16x32_bf16 v[224:227], a[204:207], a[176:179], v[224:227]
  ds_read_b64_tr_b16 a[220:221], v19 offset:26624
  v_mfma_f32_16x16x32_bf16 v[228:231], a[204:207], a[180:183], v[228:231]
  ds_read_b64_tr_b16 a[222:223], v19 offset:30720
  v_add_u32 v19, s49, v19
  v_mfma_f32_16x16x32_bf16 v[232:235], a[204:207], a[184:187], v[232:235]
  buffer_load_dword a229, v24, s[56:59], s67 offen
  s_add_u32 s67, s67, 180224
  v_mfma_f32_16x16x32_bf16 v[236:239], a[204:207], a[188:191], v[236:239]
  s_waitcnt lgkmcnt(6)
  v_mfma_f32_16x16x32_bf16 v[240:243], a[208:211], a[176:179], v[240:243]
  ds_read_b64_tr_b16 a[224:225], v20 offset:19456
  v_mfma_f32_16x16x32_bf16 v[244:247], a[208:211], a[180:183], v[244:247]
  ds_read_b64_tr_b16 a[226:227], v20 offset:19968
  v_add_u32 v20, s49, v20
  v_mfma_f32_16x16x32_bf16 v[248:251], a[208:211], a[184:187], v[248:251]
  v_mfma_f32_16x16x32_bf16 v[252:255], a[208:211], a[188:191], v[252:255]
  s_waitcnt vmcnt(26)
  s_barrier
  s_waitcnt lgkmcnt(6)
  v_mfma_f32_16x16x32_bf16 a[0:3], a[212:215], a[176:179], a[0:3]
  ds_read_b64_tr_b16 a[192:193], v12 offset:0
  v_mfma_f32_16x16x32_bf16 a[4:7], a[212:215], a[180:183], a[4:7]
  ds_read_b64_tr_b16 a[194:195], v12 offset:4096
  v_mfma_f32_16x16x32_bf16 a[8:11], a[212:215], a[184:187], a[8:11]
  v_mfma_f32_16x16x32_bf16 a[12:15], a[212:215], a[188:191], a[12:15]
  s_waitcnt lgkmcnt(6)
  v_mfma_f32_16x16x32_bf16 a[16:19], a[216:219], a[176:179], a[16:19]
  ds_read_b64_tr_b16 a[196:197], v13 offset:0
  v_mfma_f32_16x16x32_bf16 a[20:23], a[216:219], a[180:183], a[20:23]
  ds_read_b64_tr_b16 a[198:199], v13 offset:4096
  v_mfma_f32_16x16x32_bf16 a[24:27], a[216:219], a[184:187], a[24:27]
  v_mfma_f32_16x16x32_bf16 a[28:31], a[216:219], a[188:191], a[28:31]
  s_waitcnt lgkmcnt(6)
  v_mfma_f32_16x16x32_bf16 a[32:35], a[220:223], a[176:179], a[32:35]
  ds_read_b64_tr_b16 a[200:201], v14 offset:0
  v_mfma_f32_16x16x32_bf16 a[36:39], a[220:223], a[180:183], a[36:39]
  ds_read_b64_tr_b16 a[202:203], v14 offset:4096
  v_mfma_f32_16x16x32_bf16 a[40:43], a[220:223], a[184:187], a[40:43]
  v_mfma_f32_16x16x32_bf16 a[44:47], a[220:223], a[188:191], a[44:47]
  s_waitcnt lgkmcnt(6)
  v_mfma_f32_16x16x32_bf16 a[48:51], a[224:227], a[176:179], a[48:51]
  ds_read_b64_tr_b16 a[204:205], v15 offset:0
  v_mfma_f32_16x16x32_bf16 a[52:55], a[224:227], a[180:183], a[52:55]
  ds_read_b64_tr_b16 a[206:207], v15 offset:4096
  v_mfma_f32_16x16x32_bf16 a[56:59], a[224:227], a[184:187], a[56:59]
  v_mfma_f32_16x16x32_bf16 a[60:63], a[224:227], a[188:191], a[60:63]
  s_add_u32 s51, s51, 1
  s_branch mega_kernel_loop49
mega_kernel_super150:
  s_mov_b32 s24, s8
  s_mov_b32 s25, s9
  s_mov_b32 s54, 0
  s_mov_b32 s65, 9216
  s_mov_b32 s66, 147456
  v_mov_b32 v8, v25
  v_mov_b32 v9, v26
  v_mov_b32 v10, v27
  s_mul_i32 s36, s52, 18
  s_lshl_b32 s37, s53, 2
  s_add_u32 s38, s36, s37
  s_lshl_b32 s38, s38, 10
  s_lshr_b32 s37, s53, 1
  s_add_u32 s39, s36, s37
  s_add_u32 s39, s39, 16
  s_lshl_b32 s39, s39, 10
  s_and_b32 s37, s53, 1
  s_lshl_b32 s37, s37, 3
  s_add_u32 s39, s39, s37
  s_mul_i32 s36, s23, 147456
  v_lshl_add_u32 v4, v1, 4, s36
  v_add_u32 v5, 147456, v4
  v_add_u32 v6, 147456, v5
  v_add_u32 v7, 147456, v6
  s_waitcnt vmcnt(9) lgkmcnt(0)
  s_barrier
  buffer_load_dword a229, v24, s[56:59], s67 offen
  s_add_u32 s67, s67, 180224
  ds_read_b64_tr_b16 a[192:193], v20 offset:0
  ds_read_b64_tr_b16 a[194:195], v20 offset:512
  ds_read_b64_tr_b16 a[196:197], v20 offset:18432
  ds_read_b64_tr_b16 a[198:199], v20 offset:18944
  ds_read_b64_tr_b16 a[200:201], v20 offset:1024
  ds_read_b64_tr_b16 a[202:203], v20 offset:1536
  ds_read_b64_tr_b16 a[204:205], v20 offset:19456
  ds_read_b64_tr_b16 a[206:207], v20 offset:19968
  s_waitcnt lgkmcnt(6)
  v_mfma_f32_16x16x32_bf16 v[160:163], a[192:195], a[160:163], v[160:163]
  v_add_u32 v11, 0xfffe5000, v20
  ds_read_b64_tr_b16 a[208:209], v11 offset:0
  v_mfma_f32_16x16x32_bf16 v[164:167], a[192:195], a[164:167], v[164:167]
  ds_read_b64_tr_b16 a[210:211], v11 offset:512
  v_mfma_f32_16x16x32_bf16 v[168:171], a[192:195], a[168:171], v[168:171]
  v_mfma_f32_16x16x32_bf16 v[172:175], a[192:195], a[172:175], v[172:175]
  s_add_u32 s60, s55, s42
  s_mov_b32 s61, s54
  s_add_u32 m0, s60, 0
  s_nop 0
  buffer_load_dwordx4 v8, s[24:27], s61 offen lds
  s_waitcnt lgkmcnt(6)
  v_mfma_f32_16x16x32_bf16 a[48:51], a[196:199], a[160:163], a[48:51]
  ds_read_b64_tr_b16 a[212:213], v11 offset:18432
  v_mfma_f32_16x16x32_bf16 a[52:55], a[196:199], a[164:167], a[52:55]
  ds_read_b64_tr_b16 a[214:215], v11 offset:18944
  v_mfma_f32_16x16x32_bf16 a[56:59], a[196:199], a[168:171], a[56:59]
  v_mfma_f32_16x16x32_bf16 a[60:63], a[196:199], a[172:175], a[60:63]
  s_waitcnt lgkmcnt(6)
  v_mfma_f32_16x16x32_bf16 v[160:163], a[200:203], a[176:179], v[160:163]
  ds_read_b64_tr_b16 a[216:217], v11 offset:1024
  v_mfma_f32_16x16x32_bf16 v[164:167], a[200:203], a[180:183], v[164:167]
  ds_read_b64_tr_b16 a[218:219], v11 offset:1536
  v_mfma_f32_16x16x32_bf16 v[168:171], a[200:203], a[184:187], v[168:171]
  v_mfma_f32_16x16x32_bf16 v[172:175], a[200:203], a[188:191], v[172:175]
  s_add_u32 m0, s60, 1024
  s_nop 0
  buffer_load_dwordx4 v9, s[24:27], s61 offen lds
  s_add_u32 s61, s61, s65
  s_waitcnt lgkmcnt(6)
  v_mfma_f32_16x16x32_bf16 a[48:51], a[204:207], a[176:179], a[48:51]
  ds_read_b64_tr_b16 a[220:221], v11 offset:19456
  v_mfma_f32_16x16x32_bf16 a[52:55], a[204:207], a[180:183], a[52:55]
  ds_read_b64_tr_b16 a[222:223], v11 offset:19968
  v_mfma_f32_16x16x32_bf16 a[56:59], a[204:207], a[184:187], a[56:59]
  v_mfma_f32_16x16x32_bf16 a[60:63], a[204:207], a[188:191], a[60:63]
  s_waitcnt lgkmcnt(6)
  v_mfma_f32_16x16x32_bf16 v[160:163], a[208:211], a[64:67], v[160:163]
  ds_read_b64_tr_b16 a[224:225], v12 offset:0
  v_mfma_f32_16x16x32_bf16 v[164:167], a[208:211], a[68:71], v[164:167]
  ds_read_b64_tr_b16 a[226:227], v12 offset:4096
  v_mfma_f32_16x16x32_bf16 v[168:171], a[208:211], a[72:75], v[168:171]
  v_mfma_f32_16x16x32_bf16 v[172:175], a[208:211], a[76:79], v[172:175]
  s_add_u32 m0, s60, 2048
  s_nop 0
  buffer_load_dwordx4 v8, s[24:27], s61 offen lds
  s_waitcnt lgkmcnt(6)
  v_mfma_f32_16x16x32_bf16 a[48:51], a[212:215], a[64:67], a[48:51]
  ds_read_b64_tr_b16 a[192:193], v12 offset:18432
  v_mfma_f32_16x16x32_bf16 a[52:55], a[212:215], a[68:71], a[52:55]
  ds_read_b64_tr_b16 a[194:195], v12 offset:22528
  v_mfma_f32_16x16x32_bf16 a[56:59], a[212:215], a[72:75], a[56:59]
  v_mfma_f32_16x16x32_bf16 a[60:63], a[212:215], a[76:79], a[60:63]
  s_waitcnt lgkmcnt(6)
  v_mfma_f32_16x16x32_bf16 v[160:163], a[216:219], a[80:83], v[160:163]
  ds_read_b64_tr_b16 a[196:197], v12 offset:8192
  v_mfma_f32_16x16x32_bf16 v[164:167], a[216:219], a[84:87], v[164:167]
  ds_read_b64_tr_b16 a[198:199], v12 offset:12288
  v_mfma_f32_16x16x32_bf16 v[168:171], a[216:219], a[88:91], v[168:171]
  v_mfma_f32_16x16x32_bf16 v[172:175], a[216:219], a[92:95], v[172:175]
  s_add_u32 m0, s60, 3072
  s_nop 0
  buffer_load_dwordx4 v9, s[24:27], s61 offen lds
  s_add_u32 s61, s61, s65
  s_waitcnt lgkmcnt(6)
  v_mfma_f32_16x16x32_bf16 a[48:51], a[220:223], a[80:83], a[48:51]
  ds_read_b64_tr_b16 a[200:201], v12 offset:26624
  v_mfma_f32_16x16x32_bf16 a[52:55], a[220:223], a[84:87], a[52:55]
  ds_read_b64_tr_b16 a[202:203], v12 offset:30720
  v_mfma_f32_16x16x32_bf16 a[56:59], a[220:223], a[88:91], a[56:59]
  v_mfma_f32_16x16x32_bf16 a[60:63], a[220:223], a[92:95], a[60:63]
  s_waitcnt lgkmcnt(6)
  v_mfma_f32_16x16x32_bf16 v[32:35], a[224:227], a[160:163], v[32:35]
  v_add_u32 v11, 0xfffe5000, v12
  ds_read_b64_tr_b16 a[204:205], v11 offset:0
  v_mfma_f32_16x16x32_bf16 v[36:39], a[224:227], a[164:167], v[36:39]
  ds_read_b64_tr_b16 a[206:207], v11 offset:4096
  v_mfma_f32_16x16x32_bf16 v[40:43], a[224:227], a[168:171], v[40:43]
  v_mfma_f32_16x16x32_bf16 v[44:47], a[224:227], a[172:175], v[44:47]
  s_add_u32 m0, s60, 4096
  s_nop 0
  buffer_load_dwordx4 v8, s[24:27], s61 offen lds
  s_waitcnt lgkmcnt(6)
  v_mfma_f32_16x16x32_bf16 v[176:179], a[192:195], a[160:163], v[176:179]
  ds_read_b64_tr_b16 a[208:209], v11 offset:18432
  v_mfma_f32_16x16x32_bf16 v[180:183], a[192:195], a[164:167], v[180:183]
  ds_read_b64_tr_b16 a[210:211], v11 offset:22528
  v_mfma_f32_16x16x32_bf16 v[184:187], a[192:195], a[168:171], v[184:187]
  v_accvgpr_read_b32 v22, a48
  v_accvgpr_read_b32 v23, a49
  v_cvt_pk_bf16_f32 v30, v160, v161
  v_mfma_f32_16x16x32_bf16 v[188:191], a[192:195], a[172:175], v[188:191]
  v_cvt_pk_bf16_f32 v31, v22, v23
  v_pk_max_i16 v30, v30, 0
  v_lshlrev_b32 v2, 16, v31
  s_waitcnt lgkmcnt(6)
  v_mfma_f32_16x16x32_bf16 v[32:35], a[196:199], a[176:179], v[32:35]
  ds_read_b64_tr_b16 a[212:213], v11 offset:8192
  v_and_b32 v3, s40, v31
  v_lshlrev_b32 v26, 16, v30
  v_and_b32 v27, s40, v30
  v_mfma_f32_16x16x32_bf16 v[36:39], a[196:199], a[180:183], v[36:39]
  ds_read_b64_tr_b16 a[214:215], v11 offset:12288
  v_mul_f32 v26, v26, v2
  v_mul_f32 v27, v27, v3
  v_accvgpr_read_b32 v22, a50
  v_mfma_f32_16x16x32_bf16 v[40:43], a[196:199], a[184:187], v[40:43]
  v_accvgpr_read_b32 v23, a51
  v_cvt_pk_bf16_f32 v30, v162, v163
  v_cvt_pk_bf16_f32 v31, v22, v23
  v_mfma_f32_16x16x32_bf16 v[44:47], a[196:199], a[188:191], v[44:47]
  v_pk_max_i16 v30, v30, 0
  v_lshlrev_b32 v2, 16, v31
  v_and_b32 v3, s40, v31
  s_add_u32 m0, s60, 5120
  s_nop 0
  buffer_load_dwordx4 v9, s[24:27], s61 offen lds
  s_add_u32 s61, s61, s65
  s_waitcnt lgkmcnt(6)
  v_mfma_f32_16x16x32_bf16 v[176:179], a[200:203], a[176:179], v[176:179]
  ds_read_b64_tr_b16 a[216:217], v11 offset:26624
  v_lshlrev_b32 v28, 16, v30
  v_and_b32 v29, s40, v30
  v_mul_f32 v28, v28, v2
  v_mfma_f32_16x16x32_bf16 v[180:183], a[200:203], a[180:183], v[180:183]
  ds_read_b64_tr_b16 a[218:219], v11 offset:30720
  v_mul_f32 v29, v29, v3
  v_cvt_pk_bf16_f32 v160, v26, v27
  v_cvt_pk_bf16_f32 v161, v28, v29
  v_mfma_f32_16x16x32_bf16 v[184:187], a[200:203], a[184:187], v[184:187]
  buffer_store_dwordx2 v[160:161], v4, s[32:35], s39 offen sc1
  v_accvgpr_read_b32 v22, a52
  v_accvgpr_read_b32 v23, a53
  v_mfma_f32_16x16x32_bf16 v[188:191], a[200:203], a[188:191], v[188:191]
  v_cvt_pk_bf16_f32 v30, v164, v165
  v_cvt_pk_bf16_f32 v31, v22, v23
  v_pk_max_i16 v30, v30, 0
  s_waitcnt lgkmcnt(6)
  v_mfma_f32_16x16x32_bf16 v[32:35], a[204:207], a[64:67], v[32:35]
  ds_read_b64_tr_b16 a[220:221], v13 offset:0
  v_lshlrev_b32 v2, 16, v31
  v_and_b32 v3, s40, v31
  v_lshlrev_b32 v26, 16, v30
  v_mfma_f32_16x16x32_bf16 v[36:39], a[204:207], a[68:71], v[36:39]
  ds_read_b64_tr_b16 a[222:223], v13 offset:4096
  v_and_b32 v27, s40, v30
  v_mul_f32 v26, v26, v2
  v_mul_f32 v27, v27, v3
  v_mfma_f32_16x16x32_bf16 v[40:43], a[204:207], a[72:75], v[40:43]
  v_accvgpr_read_b32 v22, a54
  v_accvgpr_read_b32 v23, a55
  v_cvt_pk_bf16_f32 v30, v166, v167
  v_mfma_f32_16x16x32_bf16 v[44:47], a[204:207], a[76:79], v[44:47]
  v_cvt_pk_bf16_f32 v31, v22, v23
  v_pk_max_i16 v30, v30, 0
  v_lshlrev_b32 v2, 16, v31
  s_add_u32 m0, s60, 6144
  s_nop 0
  buffer_load_dwordx4 v8, s[24:27], s61 offen lds
  s_waitcnt lgkmcnt(6)
  v_mfma_f32_16x16x32_bf16 v[176:179], a[208:211], a[64:67], v[176:179]
  ds_read_b64_tr_b16 a[224:225], v13 offset:18432
  v_and_b32 v3, s40, v31
  v_lshlrev_b32 v28, 16, v30
  v_and_b32 v29, s40, v30
  v_mfma_f32_16x16x32_bf16 v[180:183], a[208:211], a[68:71], v[180:183]
  ds_read_b64_tr_b16 a[226:227], v13 offset:22528
  v_mul_f32 v28, v28, v2
  v_mul_f32 v29, v29, v3
  v_cvt_pk_bf16_f32 v164, v26, v27
  v_mfma_f32_16x16x32_bf16 v[184:187], a[208:211], a[72:75], v[184:187]
  v_cvt_pk_bf16_f32 v165, v28, v29
  buffer_store_dwordx2 v[164:165], v5, s[32:35], s39 offen sc1
  v_accvgpr_read_b32 v22, a56
  v_mfma_f32_16x16x32_bf16 v[188:191], a[208:211], a[76:79], v[188:191]
  v_accvgpr_read_b32 v23, a57
  v_cvt_pk_bf16_f32 v30, v168, v169
  v_cvt_pk_bf16_f32 v31, v22, v23
  s_waitcnt lgkmcnt(6)
  v_mfma_f32_16x16x32_bf16 v[32:35], a[212:215], a[80:83], v[32:35]
  ds_read_b64_tr_b16 a[192:193], v13 offset:8192
  v_pk_max_i16 v30, v30, 0
  v_lshlrev_b32 v2, 16, v31
  v_and_b32 v3, s40, v31
  v_mfma_f32_16x16x32_bf16 v[36:39], a[212:215], a[84:87], v[36:39]
  ds_read_b64_tr_b16 a[194:195], v13 offset:12288
  v_lshlrev_b32 v26, 16, v30
  v_and_b32 v27, s40, v30
  v_mul_f32 v26, v26, v2
  v_mfma_f32_16x16x32_bf16 v[40:43], a[212:215], a[88:91], v[40:43]
  v_mul_f32 v27, v27, v3
  v_accvgpr_read_b32 v22, a58
  v_accvgpr_read_b32 v23, a59
  v_mfma_f32_16x16x32_bf16 v[44:47], a[212:215], a[92:95], v[44:47]
  v_cvt_pk_bf16_f32 v30, v170, v171
  v_cvt_pk_bf16_f32 v31, v22, v23
  v_pk_max_i16 v30, v30, 0
  s_add_u32 m0, s60, 7168
  s_nop 0
  buffer_load_dwordx4 v9, s[24:27], s61 offen lds
  s_waitcnt lgkmcnt(6)
  v_mfma_f32_16x16x32_bf16 v[176:179], a[216:219], a[80:83], v[176:179]
  ds_read_b64_tr_b16 a[196:197], v13 offset:26624
  v_lshlrev_b32 v2, 16, v31
  v_and_b32 v3, s40, v31
  v_lshlrev_b32 v28, 16, v30
  v_mfma_f32_16x16x32_bf16 v[180:183], a[216:219], a[84:87], v[180:183]
  ds_read_b64_tr_b16 a[198:199], v13 offset:30720
  v_and_b32 v29, s40, v30
  v_mul_f32 v28, v28, v2
  v_mul_f32 v29, v29, v3
  v_mfma_f32_16x16x32_bf16 v[184:187], a[216:219], a[88:91], v[184:187]
  v_cvt_pk_bf16_f32 v168, v26, v27
  v_cvt_pk_bf16_f32 v169, v28, v29
  buffer_store_dwordx2 v[168:169], v6, s[32:35], s39 offen sc1
  v_mfma_f32_16x16x32_bf16 v[188:191], a[216:219], a[92:95], v[188:191]
  v_accvgpr_read_b32 v22, a60
  v_accvgpr_read_b32 v23, a61
  v_cvt_pk_bf16_f32 v30, v172, v173
  s_waitcnt lgkmcnt(6)
  v_mfma_f32_16x16x32_bf16 v[48:51], a[220:223], a[160:163], v[48:51]
  v_add_u32 v0, 0xfffe5000, v13
  ds_read_b64_tr_b16 a[200:201], v0 offset:0
  v_cvt_pk_bf16_f32 v31, v22, v23
  v_pk_max_i16 v30, v30, 0
  v_lshlrev_b32 v2, 16, v31
  v_mfma_f32_16x16x32_bf16 v[52:55], a[220:223], a[164:167], v[52:55]
  ds_read_b64_tr_b16 a[202:203], v0 offset:4096
  v_and_b32 v3, s40, v31
  v_lshlrev_b32 v26, 16, v30
  v_and_b32 v27, s40, v30
  v_mfma_f32_16x16x32_bf16 v[56:59], a[220:223], a[168:171], v[56:59]
  v_mul_f32 v26, v26, v2
  v_mul_f32 v27, v27, v3
  v_accvgpr_read_b32 v22, a62
  v_mfma_f32_16x16x32_bf16 v[60:63], a[220:223], a[172:175], v[60:63]
  v_accvgpr_read_b32 v23, a63
  v_cvt_pk_bf16_f32 v30, v174, v175
  v_cvt_pk_bf16_f32 v31, v22, v23
  s_add_u32 m0, s55, s43
  s_nop 0
  buffer_load_dwordx4 v10, s[24:27], s54 offen lds
  s_add_u32 s54, s54, s66
  s_add_u32 s55, s55, 36864
  s_cmp_ge_u32 s55, 147456
  s_cselect_b32 s55, 0, s55
  s_waitcnt lgkmcnt(6)
  v_mfma_f32_16x16x32_bf16 v[192:195], a[224:227], a[160:163], v[192:195]
  ds_read_b64_tr_b16 a[204:205], v0 offset:18432
  v_pk_max_i16 v30, v30, 0
  v_lshlrev_b32 v2, 16, v31
  v_and_b32 v3, s40, v31
  v_mfma_f32_16x16x32_bf16 v[196:199], a[224:227], a[164:167], v[196:199]
  ds_read_b64_tr_b16 a[206:207], v0 offset:22528
  v_lshlrev_b32 v28, 16, v30
  v_and_b32 v29, s40, v30
  v_mul_f32 v28, v28, v2
  v_mfma_f32_16x16x32_bf16 v[200:203], a[224:227], a[168:171], v[200:203]
  v_mul_f32 v29, v29, v3
  v_cvt_pk_bf16_f32 v172, v26, v27
  v_cvt_pk_bf16_f32 v173, v28, v29
  v_mfma_f32_16x16x32_bf16 v[204:207], a[224:227], a[172:175], v[204:207]
  buffer_store_dwordx2 v[172:173], v7, s[32:35], s39 offen sc1
  v_cvt_pk_bf16_f32 v30, v32, v33
  v_cvt_pk_bf16_f32 v31, v176, v177
  s_waitcnt lgkmcnt(6)
  v_mfma_f32_16x16x32_bf16 v[48:51], a[192:195], a[176:179], v[48:51]
  ds_read_b64_tr_b16 a[208:209], v0 offset:8192
  v_pk_max_i16 v30, v30, 0
  v_lshlrev_b32 v2, 16, v31
  v_and_b32 v3, s40, v31
  v_mfma_f32_16x16x32_bf16 v[52:55], a[192:195], a[180:183], v[52:55]
  ds_read_b64_tr_b16 a[210:211], v0 offset:12288
  v_lshlrev_b32 v26, 16, v30
  v_and_b32 v27, s40, v30
  v_mul_f32 v26, v26, v2
  v_mfma_f32_16x16x32_bf16 v[56:59], a[192:195], a[184:187], v[56:59]
  v_mul_f32 v27, v27, v3
  v_cvt_pk_bf16_f32 v30, v34, v35
  v_cvt_pk_bf16_f32 v31, v178, v179
  v_mfma_f32_16x16x32_bf16 v[60:63], a[192:195], a[188:191], v[60:63]
  v_pk_max_i16 v30, v30, 0
  v_lshlrev_b32 v2, 16, v31
  v_and_b32 v3, s40, v31
  s_add_u32 s60, s55, s42
  s_mov_b32 s61, s54
  s_add_u32 m0, s60, 0
  s_nop 0
  buffer_load_dwordx4 v8, s[24:27], s61 offen lds
  s_waitcnt lgkmcnt(6)
  v_mfma_f32_16x16x32_bf16 v[192:195], a[196:199], a[176:179], v[192:195]
  ds_read_b64_tr_b16 a[212:213], v0 offset:26624
  v_lshlrev_b32 v28, 16, v30
  v_and_b32 v29, s40, v30
  v_mul_f32 v28, v28, v2
  v_mfma_f32_16x16x32_bf16 v[196:199], a[196:199], a[180:183], v[196:199]
  ds_read_b64_tr_b16 a[214:215], v0 offset:30720
  v_mul_f32 v29, v29, v3
  v_cvt_pk_bf16_f32 v32, v26, v27
  v_cvt_pk_bf16_f32 v33, v28, v29
  v_mfma_f32_16x16x32_bf16 v[200:203], a[196:199], a[184:187], v[200:203]
  v_cvt_pk_bf16_f32 v30, v36, v37
  v_cvt_pk_bf16_f32 v31, v180, v181
  v_pk_max_i16 v30, v30, 0
  v_mfma_f32_16x16x32_bf16 v[204:207], a[196:199], a[188:191], v[204:207]
  v_lshlrev_b32 v2, 16, v31
  v_and_b32 v3, s40, v31
  v_lshlrev_b32 v26, 16, v30
  s_waitcnt lgkmcnt(6)
  v_mfma_f32_16x16x32_bf16 v[48:51], a[200:203], a[64:67], v[48:51]
  ds_read_b64_tr_b16 a[216:217], v14 offset:0
  v_and_b32 v27, s40, v30
  v_mul_f32 v26, v26, v2
  v_mul_f32 v27, v27, v3
  v_mfma_f32_16x16x32_bf16 v[52:55], a[200:203], a[68:71], v[52:55]
  ds_read_b64_tr_b16 a[218:219], v14 offset:4096
  v_cvt_pk_bf16_f32 v30, v38, v39
  v_cvt_pk_bf16_f32 v31, v182, v183
  v_pk_max_i16 v30, v30, 0
  v_mfma_f32_16x16x32_bf16 v[56:59], a[200:203], a[72:75], v[56:59]
  v_lshlrev_b32 v2, 16, v31
  v_and_b32 v3, s40, v31
  v_lshlrev_b32 v28, 16, v30
  v_mfma_f32_16x16x32_bf16 v[60:63], a[200:203], a[76:79], v[60:63]
  v_and_b32 v29, s40, v30
  v_mul_f32 v28, v28, v2
  v_mul_f32 v29, v29, v3
  s_add_u32 m0, s60, 1024
  s_nop 0
  buffer_load_dwordx4 v9, s[24:27], s61 offen lds
  s_add_u32 s61, s61, s65
  s_waitcnt lgkmcnt(6)
  v_mfma_f32_16x16x32_bf16 v[192:195], a[204:207], a[64:67], v[192:195]
  ds_read_b64_tr_b16 a[220:221], v14 offset:18432
  v_cvt_pk_bf16_f32 v36, v26, v27
  v_cvt_pk_bf16_f32 v37, v28, v29
  v_cvt_pk_bf16_f32 v30, v40, v41
  v_mfma_f32_16x16x32_bf16 v[196:199], a[204:207], a[68:71], v[196:199]
  ds_read_b64_tr_b16 a[222:223], v14 offset:22528
  v_cvt_pk_bf16_f32 v31, v184, v185
  v_pk_max_i16 v30, v30, 0
  v_lshlrev_b32 v2, 16, v31
  v_mfma_f32_16x16x32_bf16 v[200:203], a[204:207], a[72:75], v[200:203]
  v_and_b32 v3, s40, v31
  v_lshlrev_b32 v26, 16, v30
  v_and_b32 v27, s40, v30
  v_mfma_f32_16x16x32_bf16 v[204:207], a[204:207], a[76:79], v[204:207]
  v_mul_f32 v26, v26, v2
  v_mul_f32 v27, v27, v3
  v_cvt_pk_bf16_f32 v30, v42, v43
  s_waitcnt lgkmcnt(6)
  v_mfma_f32_16x16x32_bf16 v[48:51], a[208:211], a[80:83], v[48:51]
  ds_read_b64_tr_b16 a[224:225], v14 offset:8192
  v_cvt_pk_bf16_f32 v31, v186, v187
  v_pk_max_i16 v30, v30, 0
  v_lshlrev_b32 v2, 16, v31
  v_mfma_f32_16x16x32_bf16 v[52:55], a[208:211], a[84:87], v[52:55]
  ds_read_b64_tr_b16 a[226:227], v14 offset:12288
  v_and_b32 v3, s40, v31
  v_lshlrev_b32 v28, 16, v30
  v_and_b32 v29, s40, v30
  v_mfma_f32_16x16x32_bf16 v[56:59], a[208:211], a[88:91], v[56:59]
  v_mul_f32 v28, v28, v2
  v_mul_f32 v29, v29, v3
  v_cvt_pk_bf16_f32 v40, v26, v27
  v_mfma_f32_16x16x32_bf16 v[60:63], a[208:211], a[92:95], v[60:63]
  v_cvt_pk_bf16_f32 v41, v28, v29
  v_cvt_pk_bf16_f32 v30, v44, v45
  v_cvt_pk_bf16_f32 v31, v188, v189
  s_add_u32 m0, s60, 2048
  s_nop 0
  buffer_load_dwordx4 v8, s[24:27], s61 offen lds
  s_waitcnt lgkmcnt(6)
  v_mfma_f32_16x16x32_bf16 v[192:195], a[212:215], a[80:83], v[192:195]
  ds_read_b64_tr_b16 a[192:193], v14 offset:26624
  v_pk_max_i16 v30, v30, 0
  v_lshlrev_b32 v2, 16, v31
  v_and_b32 v3, s40, v31
  v_mfma_f32_16x16x32_bf16 v[196:199], a[212:215], a[84:87], v[196:199]
  ds_read_b64_tr_b16 a[194:195], v14 offset:30720
  v_lshlrev_b32 v26, 16, v30
  v_and_b32 v27, s40, v30
  v_mul_f32 v26, v26, v2
  v_mfma_f32_16x16x32_bf16 v[200:203], a[212:215], a[88:91], v[200:203]
  v_mul_f32 v27, v27, v3
  v_cvt_pk_bf16_f32 v30, v46, v47
  v_cvt_pk_bf16_f32 v31, v190, v191
  v_mfma_f32_16x16x32_bf16 v[204:207], a[212:215], a[92:95], v[204:207]
  v_pk_max_i16 v30, v30, 0
  v_lshlrev_b32 v2, 16, v31
  v_and_b32 v3, s40, v31
  s_waitcnt lgkmcnt(6)
  v_mfma_f32_16x16x32_bf16 v[64:67], a[216:219], a[160:163], v[64:67]
  v_add_u32 v11, 0xfffe5000, v14
  ds_read_b64_tr_b16 a[196:197], v11 offset:0
  v_lshlrev_b32 v28, 16, v30
  v_and_b32 v29, s40, v30
  v_mul_f32 v28, v28, v2
  v_mfma_f32_16x16x32_bf16 v[68:71], a[216:219], a[164:167], v[68:71]
  ds_read_b64_tr_b16 a[198:199], v11 offset:4096
  v_mul_f32 v29, v29, v3
  v_cvt_pk_bf16_f32 v44, v26, v27
  v_cvt_pk_bf16_f32 v45, v28, v29
  v_mfma_f32_16x16x32_bf16 v[72:75], a[216:219], a[168:171], v[72:75]
  v_mfma_f32_16x16x32_bf16 v[76:79], a[216:219], a[172:175], v[76:79]
  s_add_u32 m0, s60, 3072
  s_nop 0
  buffer_load_dwordx4 v9, s[24:27], s61 offen lds
  s_add_u32 s61, s61, s65
  s_waitcnt lgkmcnt(6)
  v_mfma_f32_16x16x32_bf16 v[208:211], a[220:223], a[160:163], v[208:211]
  ds_read_b64_tr_b16 a[200:201], v11 offset:18432
  v_mfma_f32_16x16x32_bf16 v[212:215], a[220:223], a[164:167], v[212:215]
  ds_read_b64_tr_b16 a[202:203], v11 offset:22528
  v_mfma_f32_16x16x32_bf16 v[216:219], a[220:223], a[168:171], v[216:219]
  v_cvt_pk_bf16_f32 v30, v48, v49
  v_cvt_pk_bf16_f32 v31, v192, v193
  v_pk_max_i16 v30, v30, 0
  v_mfma_f32_16x16x32_bf16 v[220:223], a[220:223], a[172:175], v[220:223]
  v_lshlrev_b32 v2, 16, v31
  v_and_b32 v3, s40, v31
  v_lshlrev_b32 v26, 16, v30
  s_waitcnt lgkmcnt(6)
  v_mfma_f32_16x16x32_bf16 v[64:67], a[224:227], a[176:179], v[64:67]
  ds_read_b64_tr_b16 a[204:205], v11 offset:8192
  v_and_b32 v27, s40, v30
  v_mul_f32 v26, v26, v2
  v_mul_f32 v27, v27, v3
  v_mfma_f32_16x16x32_bf16 v[68:71], a[224:227], a[180:183], v[68:71]
  ds_read_b64_tr_b16 a[206:207], v11 offset:12288
  v_cvt_pk_bf16_f32 v30, v50, v51
  v_cvt_pk_bf16_f32 v31, v194, v195
  v_pk_max_i16 v30, v30, 0
  v_mfma_f32_16x16x32_bf16 v[72:75], a[224:227], a[184:187], v[72:75]
  v_lshlrev_b32 v2, 16, v31
  v_and_b32 v3, s40, v31
  v_lshlrev_b32 v28, 16, v30
  v_mfma_f32_16x16x32_bf16 v[76:79], a[224:227], a[188:191], v[76:79]
  v_and_b32 v29, s40, v30
  v_mul_f32 v28, v28, v2
  v_mul_f32 v29, v29, v3
  s_add_u32 m0, s60, 4096
  s_nop 0
  buffer_load_dwordx4 v8, s[24:27], s61 offen lds
  s_waitcnt lgkmcnt(6)
  v_mfma_f32_16x16x32_bf16 v[208:211], a[192:195], a[176:179], v[208:211]
  ds_read_b64_tr_b16 a[208:209], v11 offset:26624
  v_cvt_pk_bf16_f32 v34, v26, v27
  v_cvt_pk_bf16_f32 v35, v28, v29
  buffer_store_dwordx4 v[32:35], v4, s[32:35], s38 offen offset:0 sc1
  v_mfma_f32_16x16x32_bf16 v[212:215], a[192:195], a[180:183], v[212:215]
  ds_read_b64_tr_b16 a[210:211], v11 offset:30720
  v_cvt_pk_bf16_f32 v30, v52, v53
  v_cvt_pk_bf16_f32 v31, v196, v197
  v_pk_max_i16 v30, v30, 0
  v_mfma_f32_16x16x32_bf16 v[216:219], a[192:195], a[184:187], v[216:219]
  v_lshlrev_b32 v2, 16, v31
  v_and_b32 v3, s40, v31
  v_lshlrev_b32 v26, 16, v30
  v_mfma_f32_16x16x32_bf16 v[220:223], a[192:195], a[188:191], v[220:223]
  v_and_b32 v27, s40, v30
  v_mul_f32 v26, v26, v2
  v_mul_f32 v27, v27, v3
  s_waitcnt lgkmcnt(6)
  v_mfma_f32_16x16x32_bf16 v[64:67], a[196:199], a[64:67], v[64:67]
  ds_read_b64_tr_b16 a[212:213], v15 offset:0
  v_cvt_pk_bf16_f32 v30, v54, v55
  v_cvt_pk_bf16_f32 v31, v198, v199
  v_pk_max_i16 v30, v30, 0
  v_mfma_f32_16x16x32_bf16 v[68:71], a[196:199], a[68:71], v[68:71]
  ds_read_b64_tr_b16 a[214:215], v15 offset:4096
  v_lshlrev_b32 v2, 16, v31
  v_and_b32 v3, s40, v31
  v_lshlrev_b32 v28, 16, v30
  v_mfma_f32_16x16x32_bf16 v[72:75], a[196:199], a[72:75], v[72:75]
  v_and_b32 v29, s40, v30
  v_mul_f32 v28, v28, v2
  v_mul_f32 v29, v29, v3
  v_mfma_f32_16x16x32_bf16 v[76:79], a[196:199], a[76:79], v[76:79]
  v_cvt_pk_bf16_f32 v38, v26, v27
  v_cvt_pk_bf16_f32 v39, v28, v29
  buffer_store_dwordx4 v[36:39], v5, s[32:35], s38 offen offset:0 sc1
  s_add_u32 m0, s60, 5120
  s_nop 0
  buffer_load_dwordx4 v9, s[24:27], s61 offen lds
  s_add_u32 s61, s61, s65
  s_waitcnt lgkmcnt(6)
  v_mfma_f32_16x16x32_bf16 v[208:211], a[200:203], a[64:67], v[208:211]
  ds_read_b64_tr_b16 a[216:217], v15 offset:18432
  v_cvt_pk_bf16_f32 v30, v56, v57
  v_cvt_pk_bf16_f32 v31, v200, v201
  v_pk_max_i16 v30, v30, 0
  v_mfma_f32_16x16x32_bf16 v[212:215], a[200:203], a[68:71], v[212:215]
  ds_read_b64_tr_b16 a[218:219], v15 offset:22528
  v_lshlrev_b32 v2, 16, v31
  v_and_b32 v3, s40, v31
  v_lshlrev_b32 v26, 16, v30
  v_mfma_f32_16x16x32_bf16 v[216:219], a[200:203], a[72:75], v[216:219]
  v_and_b32 v27, s40, v30
  v_mul_f32 v26, v26, v2
  v_mul_f32 v27, v27, v3
  v_mfma_f32_16x16x32_bf16 v[220:223], a[200:203], a[76:79], v[220:223]
  v_cvt_pk_bf16_f32 v30, v58, v59
  v_cvt_pk_bf16_f32 v31, v202, v203
  v_pk_max_i16 v30, v30, 0
  s_waitcnt lgkmcnt(6)
  v_mfma_f32_16x16x32_bf16 v[64:67], a[204:207], a[80:83], v[64:67]
  ds_read_b64_tr_b16 a[220:221], v15 offset:8192
  v_lshlrev_b32 v2, 16, v31
  v_and_b32 v3, s40, v31
  v_lshlrev_b32 v28, 16, v30
  v_mfma_f32_16x16x32_bf16 v[68:71], a[204:207], a[84:87], v[68:71]
  ds_read_b64_tr_b16 a[222:223], v15 offset:12288
  v_and_b32 v29, s40, v30
  v_mul_f32 v28, v28, v2
  v_mul_f32 v29, v29, v3
  v_mfma_f32_16x16x32_bf16 v[72:75], a[204:207], a[88:91], v[72:75]
  v_cvt_pk_bf16_f32 v42, v26, v27
  v_cvt_pk_bf16_f32 v43, v28, v29
  buffer_store_dwordx4 v[40:43], v6, s[32:35], s38 offen offset:0 sc1
  v_mfma_f32_16x16x32_bf16 v[76:79], a[204:207], a[92:95], v[76:79]
  v_cvt_pk_bf16_f32 v30, v60, v61
  v_cvt_pk_bf16_f32 v31, v204, v205
  v_pk_max_i16 v30, v30, 0
  s_add_u32 m0, s60, 6144
  s_nop 0
  buffer_load_dwordx4 v8, s[24:27], s61 offen lds
  s_waitcnt lgkmcnt(6)
  v_mfma_f32_16x16x32_bf16 v[208:211], a[208:211], a[80:83], v[208:211]
  ds_read_b64_tr_b16 a[224:225], v15 offset:26624
  v_lshlrev_b32 v2, 16, v31
  v_and_b32 v3, s40, v31
  v_lshlrev_b32 v26, 16, v30
  v_mfma_f32_16x16x32_bf16 v[212:215], a[208:211], a[84:87], v[212:215]
  ds_read_b64_tr_b16 a[226:227], v15 offset:30720
  v_and_b32 v27, s40, v30
  v_mul_f32 v26, v26, v2
  v_mul_f32 v27, v27, v3
  v_mfma_f32_16x16x32_bf16 v[216:219], a[208:211], a[88:91], v[216:219]
  v_cvt_pk_bf16_f32 v30, v62, v63
  v_cvt_pk_bf16_f32 v31, v206, v207
  v_pk_max_i16 v30, v30, 0
  v_mfma_f32_16x16x32_bf16 v[220:223], a[208:211], a[92:95], v[220:223]
  v_lshlrev_b32 v2, 16, v31
  v_and_b32 v3, s40, v31
  v_lshlrev_b32 v28, 16, v30
  s_waitcnt lgkmcnt(6)
  v_mfma_f32_16x16x32_bf16 v[80:83], a[212:215], a[160:163], v[80:83]
  v_add_u32 v0, 0xfffe5000, v15
  ds_read_b64_tr_b16 a[192:193], v0 offset:0
  v_and_b32 v29, s40, v30
  v_mul_f32 v28, v28, v2
  v_mul_f32 v29, v29, v3
  v_mfma_f32_16x16x32_bf16 v[84:87], a[212:215], a[164:167], v[84:87]
  ds_read_b64_tr_b16 a[194:195], v0 offset:4096
  v_cvt_pk_bf16_f32 v46, v26, v27
  v_cvt_pk_bf16_f32 v47, v28, v29
  buffer_store_dwordx4 v[44:47], v7, s[32:35], s38 offen offset:0 sc1
  v_mfma_f32_16x16x32_bf16 v[88:91], a[212:215], a[168:171], v[88:91]
  v_mfma_f32_16x16x32_bf16 v[92:95], a[212:215], a[172:175], v[92:95]
  s_add_u32 m0, s60, 7168
  s_nop 0
  buffer_load_dwordx4 v9, s[24:27], s61 offen lds
  s_waitcnt lgkmcnt(6)
  v_mfma_f32_16x16x32_bf16 v[224:227], a[216:219], a[160:163], v[224:227]
  ds_read_b64_tr_b16 a[196:197], v0 offset:18432
  v_mfma_f32_16x16x32_bf16 v[228:231], a[216:219], a[164:167], v[228:231]
  ds_read_b64_tr_b16 a[198:199], v0 offset:22528
  v_mfma_f32_16x16x32_bf16 v[232:235], a[216:219], a[168:171], v[232:235]
  v_cvt_pk_bf16_f32 v30, v64, v65
  v_cvt_pk_bf16_f32 v31, v208, v209
  v_pk_max_i16 v30, v30, 0
  v_mfma_f32_16x16x32_bf16 v[236:239], a[216:219], a[172:175], v[236:239]
  v_lshlrev_b32 v2, 16, v31
  v_and_b32 v3, s40, v31
  v_lshlrev_b32 v26, 16, v30
  s_waitcnt lgkmcnt(6)
  v_mfma_f32_16x16x32_bf16 v[80:83], a[220:223], a[176:179], v[80:83]
  ds_read_b64_tr_b16 a[200:201], v0 offset:8192
  v_and_b32 v27, s40, v30
  v_mul_f32 v26, v26, v2
  v_mul_f32 v27, v27, v3
  v_mfma_f32_16x16x32_bf16 v[84:87], a[220:223], a[180:183], v[84:87]
  ds_read_b64_tr_b16 a[202:203], v0 offset:12288
  v_cvt_pk_bf16_f32 v30, v66, v67
  v_cvt_pk_bf16_f32 v31, v210, v211
  v_pk_max_i16 v30, v30, 0
  v_mfma_f32_16x16x32_bf16 v[88:91], a[220:223], a[184:187], v[88:91]
  v_lshlrev_b32 v2, 16, v31
  v_and_b32 v3, s40, v31
  v_lshlrev_b32 v28, 16, v30
  v_mfma_f32_16x16x32_bf16 v[92:95], a[220:223], a[188:191], v[92:95]
  v_and_b32 v29, s40, v30
  v_mul_f32 v28, v28, v2
  v_mul_f32 v29, v29, v3
  s_add_u32 m0, s55, s43
  s_nop 0
  buffer_load_dwordx4 v10, s[24:27], s54 offen lds
  s_add_u32 s54, s54, s66
  s_add_u32 s55, s55, 36864
  s_cmp_ge_u32 s55, 147456
  s_cselect_b32 s55, 0, s55
  s_waitcnt lgkmcnt(6)
  v_mfma_f32_16x16x32_bf16 v[224:227], a[224:227], a[176:179], v[224:227]
  ds_read_b64_tr_b16 a[204:205], v0 offset:26624
  v_cvt_pk_bf16_f32 v64, v26, v27
  v_cvt_pk_bf16_f32 v65, v28, v29
  v_cvt_pk_bf16_f32 v30, v68, v69
  v_mfma_f32_16x16x32_bf16 v[228:231], a[224:227], a[180:183], v[228:231]
  ds_read_b64_tr_b16 a[206:207], v0 offset:30720
  v_cvt_pk_bf16_f32 v31, v212, v213
  v_pk_max_i16 v30, v30, 0
  v_lshlrev_b32 v2, 16, v31
  v_mfma_f32_16x16x32_bf16 v[232:235], a[224:227], a[184:187], v[232:235]
  v_and_b32 v3, s40, v31
  v_lshlrev_b32 v26, 16, v30
  v_and_b32 v27, s40, v30
  v_mfma_f32_16x16x32_bf16 v[236:239], a[224:227], a[188:191], v[236:239]
  v_mul_f32 v26, v26, v2
  v_mul_f32 v27, v27, v3
  v_cvt_pk_bf16_f32 v30, v70, v71
  s_waitcnt lgkmcnt(6)
  v_mfma_f32_16x16x32_bf16 v[80:83], a[192:195], a[64:67], v[80:83]
  ds_read_b64_tr_b16 a[208:209], v16 offset:0
  v_cvt_pk_bf16_f32 v31, v214, v215
  v_pk_max_i16 v30, v30, 0
  v_lshlrev_b32 v2, 16, v31
  v_mfma_f32_16x16x32_bf16 v[84:87], a[192:195], a[68:71], v[84:87]
  ds_read_b64_tr_b16 a[210:211], v16 offset:4096
  v_and_b32 v3, s40, v31
  v_lshlrev_b32 v28, 16, v30
  v_and_b32 v29, s40, v30
  v_mfma_f32_16x16x32_bf16 v[88:91], a[192:195], a[72:75], v[88:91]
  v_mul_f32 v28, v28, v2
  v_mul_f32 v29, v29, v3
  v_cvt_pk_bf16_f32 v68, v26, v27
  v_mfma_f32_16x16x32_bf16 v[92:95], a[192:195], a[76:79], v[92:95]
  v_cvt_pk_bf16_f32 v69, v28, v29
  v_cvt_pk_bf16_f32 v30, v72, v73
  v_cvt_pk_bf16_f32 v31, v216, v217
  s_waitcnt lgkmcnt(6)
  v_mfma_f32_16x16x32_bf16 v[224:227], a[196:199], a[64:67], v[224:227]
  ds_read_b64_tr_b16 a[212:213], v16 offset:18432
  v_pk_max_i16 v30, v30, 0
  v_lshlrev_b32 v2, 16, v31
  v_and_b32 v3, s40, v31
  v_mfma_f32_16x16x32_bf16 v[228:231], a[196:199], a[68:71], v[228:231]
  ds_read_b64_tr_b16 a[214:215], v16 offset:22528
  v_lshlrev_b32 v26, 16, v30
  v_and_b32 v27, s40, v30
  v_mul_f32 v26, v26, v2
  v_mfma_f32_16x16x32_bf16 v[232:235], a[196:199], a[72:75], v[232:235]
  v_mul_f32 v27, v27, v3
  v_cvt_pk_bf16_f32 v30, v74, v75
  v_cvt_pk_bf16_f32 v31, v218, v219
  v_mfma_f32_16x16x32_bf16 v[236:239], a[196:199], a[76:79], v[236:239]
  v_pk_max_i16 v30, v30, 0
  v_lshlrev_b32 v2, 16, v31
  v_and_b32 v3, s40, v31
  s_waitcnt lgkmcnt(6)
  v_mfma_f32_16x16x32_bf16 v[80:83], a[200:203], a[80:83], v[80:83]
  ds_read_b64_tr_b16 a[216:217], v16 offset:8192
  v_lshlrev_b32 v28, 16, v30
  v_and_b32 v29, s40, v30
  v_mul_f32 v28, v28, v2
  v_mfma_f32_16x16x32_bf16 v[84:87], a[200:203], a[84:87], v[84:87]
  ds_read_b64_tr_b16 a[218:219], v16 offset:12288
  v_mul_f32 v29, v29, v3
  v_cvt_pk_bf16_f32 v72, v26, v27
  v_cvt_pk_bf16_f32 v73, v28, v29
  v_mfma_f32_16x16x32_bf16 v[88:91], a[200:203], a[88:91], v[88:91]
  v_cvt_pk_bf16_f32 v30, v76, v77
  v_cvt_pk_bf16_f32 v31, v220, v221
  v_pk_max_i16 v30, v30, 0
  v_mfma_f32_16x16x32_bf16 v[92:95], a[200:203], a[92:95], v[92:95]
  v_lshlrev_b32 v2, 16, v31
  v_and_b32 v3, s40, v31
  v_lshlrev_b32 v26, 16, v30
  s_waitcnt lgkmcnt(6)
  v_mfma_f32_16x16x32_bf16 v[224:227], a[204:207], a[80:83], v[224:227]
  ds_read_b64_tr_b16 a[220:221], v16 offset:26624
  v_and_b32 v27, s40, v30
  v_mul_f32 v26, v26, v2
  v_mul_f32 v27, v27, v3
  v_mfma_f32_16x16x32_bf16 v[228:231], a[204:207], a[84:87], v[228:231]
  ds_read_b64_tr_b16 a[222:223], v16 offset:30720
  v_cvt_pk_bf16_f32 v30, v78, v79
  v_cvt_pk_bf16_f32 v31, v222, v223
  v_pk_max_i16 v30, v30, 0
  v_mfma_f32_16x16x32_bf16 v[232:235], a[204:207], a[88:91], v[232:235]
  v_lshlrev_b32 v2, 16, v31
  v_and_b32 v3, s40, v31
  v_lshlrev_b32 v28, 16, v30
  v_mfma_f32_16x16x32_bf16 v[236:239], a[204:207], a[92:95], v[236:239]
  v_and_b32 v29, s40, v30
  v_mul_f32 v28, v28, v2
  v_mul_f32 v29, v29, v3
  s_waitcnt lgkmcnt(6)
  v_mfma_f32_16x16x32_bf16 v[96:99], a[208:211], a[160:163], v[96:99]
  v_add_u32 v11, 0xfffe5000, v16
  ds_read_b64_tr_b16 a[224:225], v11 offset:0
  v_cvt_pk_bf16_f32 v76, v26, v27
  v_cvt_pk_bf16_f32 v77, v28, v29
  v_mfma_f32_16x16x32_bf16 v[100:103], a[208:211], a[164:167], v[100:103]
  ds_read_b64_tr_b16 a[226:227], v11 offset:4096
  v_mfma_f32_16x16x32_bf16 v[104:107], a[208:211], a[168:171], v[104:107]
  v_mfma_f32_16x16x32_bf16 v[108:111], a[208:211], a[172:175], v[108:111]
  s_waitcnt lgkmcnt(6)
  v_mfma_f32_16x16x32_bf16 v[240:243], a[212:215], a[160:163], v[240:243]
  ds_read_b64_tr_b16 a[192:193], v11 offset:18432
  v_mfma_f32_16x16x32_bf16 v[244:247], a[212:215], a[164:167], v[244:247]
  ds_read_b64_tr_b16 a[194:195], v11 offset:22528
  v_mfma_f32_16x16x32_bf16 v[248:251], a[212:215], a[168:171], v[248:251]
  v_cvt_pk_bf16_f32 v30, v80, v81
  v_cvt_pk_bf16_f32 v31, v224, v225
  v_pk_max_i16 v30, v30, 0
  v_mfma_f32_16x16x32_bf16 v[252:255], a[212:215], a[172:175], v[252:255]
  v_lshlrev_b32 v2, 16, v31
  v_and_b32 v3, s40, v31
  v_lshlrev_b32 v26, 16, v30
  s_waitcnt lgkmcnt(6)
  v_mfma_f32_16x16x32_bf16 v[96:99], a[216:219], a[176:179], v[96:99]
  ds_read_b64_tr_b16 a[196:197], v11 offset:8192
  v_and_b32 v27, s40, v30
  v_mul_f32 v26, v26, v2
  v_mul_f32 v27, v27, v3
  v_mfma_f32_16x16x32_bf16 v[100:103], a[216:219], a[180:183], v[100:103]
  ds_read_b64_tr_b16 a[198:199], v11 offset:12288
  v_cvt_pk_bf16_f32 v30, v82, v83
  v_cvt_pk_bf16_f32 v31, v226, v227
  v_pk_max_i16 v30, v30, 0
  v_mfma_f32_16x16x32_bf16 v[104:107], a[216:219], a[184:187], v[104:107]
  v_lshlrev_b32 v2, 16, v31
  v_and_b32 v3, s40, v31
  v_lshlrev_b32 v28, 16, v30
  v_mfma_f32_16x16x32_bf16 v[108:111], a[216:219], a[188:191], v[108:111]
  v_and_b32 v29, s40, v30
  v_mul_f32 v28, v28, v2
  v_mul_f32 v29, v29, v3
  s_waitcnt lgkmcnt(6)
  v_mfma_f32_16x16x32_bf16 v[240:243], a[220:223], a[176:179], v[240:243]
  ds_read_b64_tr_b16 a[200:201], v11 offset:26624
  v_cvt_pk_bf16_f32 v66, v26, v27
  v_cvt_pk_bf16_f32 v67, v28, v29
  buffer_store_dwordx4 v[64:67], v4, s[32:35], s38 offen offset:1024 sc1
  v_mfma_f32_16x16x32_bf16 v[244:247], a[220:223], a[180:183], v[244:247]
  ds_read_b64_tr_b16 a[202:203], v11 offset:30720
  v_cvt_pk_bf16_f32 v30, v84, v85
  v_cvt_pk_bf16_f32 v31, v228, v229
  v_pk_max_i16 v30, v30, 0
  v_mfma_f32_16x16x32_bf16 v[248:251], a[220:223], a[184:187], v[248:251]
  v_lshlrev_b32 v2, 16, v31
  v_and_b32 v3, s40, v31
  v_lshlrev_b32 v26, 16, v30
  v_mfma_f32_16x16x32_bf16 v[252:255], a[220:223], a[188:191], v[252:255]
  v_and_b32 v27, s40, v30
  v_mul_f32 v26, v26, v2
  v_mul_f32 v27, v27, v3
  s_waitcnt lgkmcnt(6)
  v_mfma_f32_16x16x32_bf16 v[96:99], a[224:227], a[64:67], v[96:99]
  ds_read_b64_tr_b16 a[204:205], v17 offset:0
  v_cvt_pk_bf16_f32 v30, v86, v87
  v_cvt_pk_bf16_f32 v31, v230, v231
  v_pk_max_i16 v30, v30, 0
  v_mfma_f32_16x16x32_bf16 v[100:103], a[224:227], a[68:71], v[100:103]
  ds_read_b64_tr_b16 a[206:207], v17 offset:4096
  v_lshlrev_b32 v2, 16, v31
  v_and_b32 v3, s40, v31
  v_lshlrev_b32 v28, 16, v30
  v_mfma_f32_16x16x32_bf16 v[104:107], a[224:227], a[72:75], v[104:107]
  v_and_b32 v29, s40, v30
  v_mul_f32 v28, v28, v2
  v_mul_f32 v29, v29, v3
  v_mfma_f32_16x16x32_bf16 v[108:111], a[224:227], a[76:79], v[108:111]
  v_cvt_pk_bf16_f32 v70, v26, v27
  v_cvt_pk_bf16_f32 v71, v28, v29
  buffer_store_dwordx4 v[68:71], v5, s[32:35], s38 offen offset:1024 sc1
  s_waitcnt lgkmcnt(6)
  v_mfma_f32_16x16x32_bf16 v[240:243], a[192:195], a[64:67], v[240:243]
  ds_read_b64_tr_b16 a[208:209], v17 offset:18432
  v_cvt_pk_bf16_f32 v30, v88, v89
  v_cvt_pk_bf16_f32 v31, v232, v233
  v_pk_max_i16 v30, v30, 0
  v_mfma_f32_16x16x32_bf16 v[244:247], a[192:195], a[68:71], v[244:247]
  ds_read_b64_tr_b16 a[210:211], v17 offset:22528
  v_lshlrev_b32 v2, 16, v31
  v_and_b32 v3, s40, v31
  v_lshlrev_b32 v26, 16, v30
  v_mfma_f32_16x16x32_bf16 v[248:251], a[192:195], a[72:75], v[248:251]
  v_and_b32 v27, s40, v30
  v_mul_f32 v26, v26, v2
  v_mul_f32 v27, v27, v3
  v_mfma_f32_16x16x32_bf16 v[252:255], a[192:195], a[76:79], v[252:255]
  v_cvt_pk_bf16_f32 v30, v90, v91
  v_cvt_pk_bf16_f32 v31, v234, v235
  v_pk_max_i16 v30, v30, 0
  s_waitcnt lgkmcnt(6)
  v_mfma_f32_16x16x32_bf16 v[96:99], a[196:199], a[80:83], v[96:99]
  ds_read_b64_tr_b16 a[212:213], v17 offset:8192
  v_lshlrev_b32 v2, 16, v31
  v_and_b32 v3, s40, v31
  v_lshlrev_b32 v28, 16, v30
  v_mfma_f32_16x16x32_bf16 v[100:103], a[196:199], a[84:87], v[100:103]
  ds_read_b64_tr_b16 a[214:215], v17 offset:12288
  v_and_b32 v29, s40, v30
  v_mul_f32 v28, v28, v2
  v_mul_f32 v29, v29, v3
  v_mfma_f32_16x16x32_bf16 v[104:107], a[196:199], a[88:91], v[104:107]
  v_cvt_pk_bf16_f32 v74, v26, v27
  v_cvt_pk_bf16_f32 v75, v28, v29
  buffer_store_dwordx4 v[72:75], v6, s[32:35], s38 offen offset:1024 sc1
  v_mfma_f32_16x16x32_bf16 v[108:111], a[196:199], a[92:95], v[108:111]
  v_cvt_pk_bf16_f32 v30, v92, v93
  v_cvt_pk_bf16_f32 v31, v236, v237
  v_pk_max_i16 v30, v30, 0
  s_waitcnt lgkmcnt(6)
  v_mfma_f32_16x16x32_bf16 v[240:243], a[200:203], a[80:83], v[240:243]
  ds_read_b64_tr_b16 a[216:217], v17 offset:26624
  v_lshlrev_b32 v2, 16, v31
  v_and_b32 v3, s40, v31
  v_lshlrev_b32 v26, 16, v30
  v_mfma_f32_16x16x32_bf16 v[244:247], a[200:203], a[84:87], v[244:247]
  ds_read_b64_tr_b16 a[218:219], v17 offset:30720
  v_and_b32 v27, s40, v30
  v_mul_f32 v26, v26, v2
  v_mul_f32 v27, v27, v3
  v_mfma_f32_16x16x32_bf16 v[248:251], a[200:203], a[88:91], v[248:251]
  v_cvt_pk_bf16_f32 v30, v94, v95
  v_cvt_pk_bf16_f32 v31, v238, v239
  v_pk_max_i16 v30, v30, 0
  v_mfma_f32_16x16x32_bf16 v[252:255], a[200:203], a[92:95], v[252:255]
  v_lshlrev_b32 v2, 16, v31
  v_and_b32 v3, s40, v31
  v_lshlrev_b32 v28, 16, v30
  s_waitcnt lgkmcnt(6)
  v_mfma_f32_16x16x32_bf16 v[112:115], a[204:207], a[160:163], v[112:115]
  v_add_u32 v0, 0xfffe5000, v17
  ds_read_b64_tr_b16 a[220:221], v0 offset:0
  v_and_b32 v29, s40, v30
  v_mul_f32 v28, v28, v2
  v_mul_f32 v29, v29, v3
  v_mfma_f32_16x16x32_bf16 v[116:119], a[204:207], a[164:167], v[116:119]
  ds_read_b64_tr_b16 a[222:223], v0 offset:4096
  v_cvt_pk_bf16_f32 v78, v26, v27
  v_cvt_pk_bf16_f32 v79, v28, v29
  buffer_store_dwordx4 v[76:79], v7, s[32:35], s38 offen offset:1024 sc1
  v_mfma_f32_16x16x32_bf16 v[120:123], a[204:207], a[168:171], v[120:123]
  v_mfma_f32_16x16x32_bf16 v[124:127], a[204:207], a[172:175], v[124:127]
  s_waitcnt lgkmcnt(6)
  v_mfma_f32_16x16x32_bf16 a[0:3], a[208:211], a[160:163], a[0:3]
  ds_read_b64_tr_b16 a[224:225], v0 offset:18432
  v_mfma_f32_16x16x32_bf16 a[4:7], a[208:211], a[164:167], a[4:7]
  ds_read_b64_tr_b16 a[226:227], v0 offset:22528
  v_mfma_f32_16x16x32_bf16 a[8:11], a[208:211], a[168:171], a[8:11]
  v_cvt_pk_bf16_f32 v30, v96, v97
  v_cvt_pk_bf16_f32 v31, v240, v241
  v_pk_max_i16 v30, v30, 0
  v_mfma_f32_16x16x32_bf16 a[12:15], a[208:211], a[172:175], a[12:15]
  v_lshlrev_b32 v2, 16, v31
  v_and_b32 v3, s40, v31
  v_lshlrev_b32 v26, 16, v30
  s_waitcnt lgkmcnt(6)
  v_mfma_f32_16x16x32_bf16 v[112:115], a[212:215], a[176:179], v[112:115]
  ds_read_b64_tr_b16 a[192:193], v0 offset:8192
  v_and_b32 v27, s40, v30
  v_mul_f32 v26, v26, v2
  v_mul_f32 v27, v27, v3
  v_mfma_f32_16x16x32_bf16 v[116:119], a[212:215], a[180:183], v[116:119]
  ds_read_b64_tr_b16 a[194:195], v0 offset:12288
  v_cvt_pk_bf16_f32 v30, v98, v99
  v_cvt_pk_bf16_f32 v31, v242, v243
  v_pk_max_i16 v30, v30, 0
  v_mfma_f32_16x16x32_bf16 v[120:123], a[212:215], a[184:187], v[120:123]
  v_lshlrev_b32 v2, 16, v31
  v_and_b32 v3, s40, v31
  v_lshlrev_b32 v28, 16, v30
  v_mfma_f32_16x16x32_bf16 v[124:127], a[212:215], a[188:191], v[124:127]
  v_and_b32 v29, s40, v30
  v_mul_f32 v28, v28, v2
  v_mul_f32 v29, v29, v3
  s_waitcnt lgkmcnt(6)
  v_mfma_f32_16x16x32_bf16 a[0:3], a[216:219], a[176:179], a[0:3]
  ds_read_b64_tr_b16 a[196:197], v0 offset:26624
  v_cvt_pk_bf16_f32 v96, v26, v27
  v_cvt_pk_bf16_f32 v97, v28, v29
  v_cvt_pk_bf16_f32 v30, v100, v101
  v_mfma_f32_16x16x32_bf16 a[4:7], a[216:219], a[180:183], a[4:7]
  ds_read_b64_tr_b16 a[198:199], v0 offset:30720
  v_cvt_pk_bf16_f32 v31, v244, v245
  v_pk_max_i16 v30, v30, 0
  v_lshlrev_b32 v2, 16, v31
  v_mfma_f32_16x16x32_bf16 a[8:11], a[216:219], a[184:187], a[8:11]
  v_and_b32 v3, s40, v31
  v_lshlrev_b32 v26, 16, v30
  v_and_b32 v27, s40, v30
  v_mfma_f32_16x16x32_bf16 a[12:15], a[216:219], a[188:191], a[12:15]
  v_mul_f32 v26, v26, v2
  v_mul_f32 v27, v27, v3
  v_cvt_pk_bf16_f32 v30, v102, v103
  s_waitcnt lgkmcnt(6)
  v_mfma_f32_16x16x32_bf16 v[112:115], a[220:223], a[64:67], v[112:115]
  ds_read_b64_tr_b16 a[200:201], v18 offset:0
  v_cvt_pk_bf16_f32 v31, v246, v247
  v_pk_max_i16 v30, v30, 0
  v_lshlrev_b32 v2, 16, v31
  v_mfma_f32_16x16x32_bf16 v[116:119], a[220:223], a[68:71], v[116:119]
  ds_read_b64_tr_b16 a[202:203], v18 offset:4096
  v_and_b32 v3, s40, v31
  v_lshlrev_b32 v28, 16, v30
  v_and_b32 v29, s40, v30
  v_mfma_f32_16x16x32_bf16 v[120:123], a[220:223], a[72:75], v[120:123]
  v_mul_f32 v28, v28, v2
  v_mul_f32 v29, v29, v3
  v_cvt_pk_bf16_f32 v100, v26, v27
  v_mfma_f32_16x16x32_bf16 v[124:127], a[220:223], a[76:79], v[124:127]
  v_cvt_pk_bf16_f32 v101, v28, v29
  v_cvt_pk_bf16_f32 v30, v104, v105
  v_cvt_pk_bf16_f32 v31, v248, v249
  s_waitcnt lgkmcnt(6)
  v_mfma_f32_16x16x32_bf16 a[0:3], a[224:227], a[64:67], a[0:3]
  ds_read_b64_tr_b16 a[204:205], v18 offset:18432
  v_pk_max_i16 v30, v30, 0
  v_lshlrev_b32 v2, 16, v31
  v_and_b32 v3, s40, v31
  v_mfma_f32_16x16x32_bf16 a[4:7], a[224:227], a[68:71], a[4:7]
  ds_read_b64_tr_b16 a[206:207], v18 offset:22528
  v_lshlrev_b32 v26, 16, v30
  v_and_b32 v27, s40, v30
  v_mul_f32 v26, v26, v2
  v_mfma_f32_16x16x32_bf16 a[8:11], a[224:227], a[72:75], a[8:11]
  v_mul_f32 v27, v27, v3
  v_cvt_pk_bf16_f32 v30, v106, v107
  v_cvt_pk_bf16_f32 v31, v250, v251
  v_mfma_f32_16x16x32_bf16 a[12:15], a[224:227], a[76:79], a[12:15]
  v_pk_max_i16 v30, v30, 0
  v_lshlrev_b32 v2, 16, v31
  v_and_b32 v3, s40, v31
  s_waitcnt lgkmcnt(6)
  v_mfma_f32_16x16x32_bf16 v[112:115], a[192:195], a[80:83], v[112:115]
  ds_read_b64_tr_b16 a[208:209], v18 offset:8192
  v_lshlrev_b32 v28, 16, v30
  v_and_b32 v29, s40, v30
  v_mul_f32 v28, v28, v2
  v_mfma_f32_16x16x32_bf16 v[116:119], a[192:195], a[84:87], v[116:119]
  ds_read_b64_tr_b16 a[210:211], v18 offset:12288
  v_mul_f32 v29, v29, v3
  v_cvt_pk_bf16_f32 v104, v26, v27
  v_cvt_pk_bf16_f32 v105, v28, v29
  v_mfma_f32_16x16x32_bf16 v[120:123], a[192:195], a[88:91], v[120:123]
  v_cvt_pk_bf16_f32 v30, v108, v109
  v_cvt_pk_bf16_f32 v31, v252, v253
  v_pk_max_i16 v30, v30, 0
  v_mfma_f32_16x16x32_bf16 v[124:127], a[192:195], a[92:95], v[124:127]
  v_lshlrev_b32 v2, 16, v31
  v_and_b32 v3, s40, v31
  v_lshlrev_b32 v26, 16, v30
  s_waitcnt lgkmcnt(6)
  v_mfma_f32_16x16x32_bf16 a[0:3], a[196:199], a[80:83], a[0:3]
  ds_read_b64_tr_b16 a[212:213], v18 offset:26624
  v_and_b32 v27, s40, v30
  v_mul_f32 v26, v26, v2
  v_mul_f32 v27, v27, v3
  v_mfma_f32_16x16x32_bf16 a[4:7], a[196:199], a[84:87], a[4:7]
  ds_read_b64_tr_b16 a[214:215], v18 offset:30720
  v_cvt_pk_bf16_f32 v30, v110, v111
  v_cvt_pk_bf16_f32 v31, v254, v255
  v_pk_max_i16 v30, v30, 0
  v_mfma_f32_16x16x32_bf16 a[8:11], a[196:199], a[88:91], a[8:11]
  v_lshlrev_b32 v2, 16, v31
  v_and_b32 v3, s40, v31
  v_lshlrev_b32 v28, 16, v30
  v_mfma_f32_16x16x32_bf16 a[12:15], a[196:199], a[92:95], a[12:15]
  v_and_b32 v29, s40, v30
  v_mul_f32 v28, v28, v2
  v_mul_f32 v29, v29, v3
  s_waitcnt lgkmcnt(6)
  v_mfma_f32_16x16x32_bf16 v[128:131], a[200:203], a[160:163], v[128:131]
  v_add_u32 v11, 0xfffe5000, v18
  ds_read_b64_tr_b16 a[216:217], v11 offset:0
  v_cvt_pk_bf16_f32 v108, v26, v27
  v_cvt_pk_bf16_f32 v109, v28, v29
  v_mfma_f32_16x16x32_bf16 v[132:135], a[200:203], a[164:167], v[132:135]
  ds_read_b64_tr_b16 a[218:219], v11 offset:4096
  v_mfma_f32_16x16x32_bf16 v[136:139], a[200:203], a[168:171], v[136:139]
  v_mfma_f32_16x16x32_bf16 v[140:143], a[200:203], a[172:175], v[140:143]
  s_waitcnt lgkmcnt(6)
  v_mfma_f32_16x16x32_bf16 a[16:19], a[204:207], a[160:163], a[16:19]
  ds_read_b64_tr_b16 a[220:221], v11 offset:18432
  v_mfma_f32_16x16x32_bf16 a[20:23], a[204:207], a[164:167], a[20:23]
  ds_read_b64_tr_b16 a[222:223], v11 offset:22528
  v_mfma_f32_16x16x32_bf16 a[24:27], a[204:207], a[168:171], a[24:27]
  v_accvgpr_read_b32 v22, a0
  v_accvgpr_read_b32 v23, a1
  v_cvt_pk_bf16_f32 v30, v112, v113
  v_mfma_f32_16x16x32_bf16 a[28:31], a[204:207], a[172:175], a[28:31]
  v_cvt_pk_bf16_f32 v31, v22, v23
  v_pk_max_i16 v30, v30, 0
  v_lshlrev_b32 v2, 16, v31
  s_waitcnt lgkmcnt(6)
  v_mfma_f32_16x16x32_bf16 v[128:131], a[208:211], a[176:179], v[128:131]
  ds_read_b64_tr_b16 a[224:225], v11 offset:8192
  v_and_b32 v3, s40, v31
  v_lshlrev_b32 v26, 16, v30
  v_and_b32 v27, s40, v30
  v_mfma_f32_16x16x32_bf16 v[132:135], a[208:211], a[180:183], v[132:135]
  ds_read_b64_tr_b16 a[226:227], v11 offset:12288
  v_mul_f32 v26, v26, v2
  v_mul_f32 v27, v27, v3
  v_accvgpr_read_b32 v22, a2
  v_mfma_f32_16x16x32_bf16 v[136:139], a[208:211], a[184:187], v[136:139]
  v_accvgpr_read_b32 v23, a3
  v_cvt_pk_bf16_f32 v30, v114, v115
  v_cvt_pk_bf16_f32 v31, v22, v23
  v_mfma_f32_16x16x32_bf16 v[140:143], a[208:211], a[188:191], v[140:143]
  v_pk_max_i16 v30, v30, 0
  v_lshlrev_b32 v2, 16, v31
  v_and_b32 v3, s40, v31
  s_waitcnt lgkmcnt(6)
  v_mfma_f32_16x16x32_bf16 a[16:19], a[212:215], a[176:179], a[16:19]
  ds_read_b64_tr_b16 a[192:193], v11 offset:26624
  v_lshlrev_b32 v28, 16, v30
  v_and_b32 v29, s40, v30
  v_mul_f32 v28, v28, v2
  v_mfma_f32_16x16x32_bf16 a[20:23], a[212:215], a[180:183], a[20:23]
  ds_read_b64_tr_b16 a[194:195], v11 offset:30720
  v_mul_f32 v29, v29, v3
  v_cvt_pk_bf16_f32 v98, v26, v27
  v_cvt_pk_bf16_f32 v99, v28, v29
  v_mfma_f32_16x16x32_bf16 a[24:27], a[212:215], a[184:187], a[24:27]
  buffer_store_dwordx4 v[96:99], v4, s[32:35], s38 offen offset:2048 sc1
  v_accvgpr_read_b32 v22, a4
  v_accvgpr_read_b32 v23, a5
  v_mfma_f32_16x16x32_bf16 a[28:31], a[212:215], a[188:191], a[28:31]
  v_cvt_pk_bf16_f32 v30, v116, v117
  v_cvt_pk_bf16_f32 v31, v22, v23
  v_pk_max_i16 v30, v30, 0
  s_waitcnt lgkmcnt(6)
  v_mfma_f32_16x16x32_bf16 v[128:131], a[216:219], a[64:67], v[128:131]
  ds_read_b64_tr_b16 a[196:197], v19 offset:0
  v_lshlrev_b32 v2, 16, v31
  v_and_b32 v3, s40, v31
  v_lshlrev_b32 v26, 16, v30
  v_mfma_f32_16x16x32_bf16 v[132:135], a[216:219], a[68:71], v[132:135]
  ds_read_b64_tr_b16 a[198:199], v19 offset:4096
  v_and_b32 v27, s40, v30
  v_mul_f32 v26, v26, v2
  v_mul_f32 v27, v27, v3
  v_mfma_f32_16x16x32_bf16 v[136:139], a[216:219], a[72:75], v[136:139]
  v_accvgpr_read_b32 v22, a6
  v_accvgpr_read_b32 v23, a7
  v_cvt_pk_bf16_f32 v30, v118, v119
  v_mfma_f32_16x16x32_bf16 v[140:143], a[216:219], a[76:79], v[140:143]
  v_cvt_pk_bf16_f32 v31, v22, v23
  v_pk_max_i16 v30, v30, 0
  v_lshlrev_b32 v2, 16, v31
  s_waitcnt lgkmcnt(6)
  v_mfma_f32_16x16x32_bf16 a[16:19], a[220:223], a[64:67], a[16:19]
  ds_read_b64_tr_b16 a[200:201], v19 offset:18432
  v_and_b32 v3, s40, v31
  v_lshlrev_b32 v28, 16, v30
  v_and_b32 v29, s40, v30
  v_mfma_f32_16x16x32_bf16 a[20:23], a[220:223], a[68:71], a[20:23]
  ds_read_b64_tr_b16 a[202:203], v19 offset:22528
  v_mul_f32 v28, v28, v2
  v_mul_f32 v29, v29, v3
  v_cvt_pk_bf16_f32 v102, v26, v27
  v_mfma_f32_16x16x32_bf16 a[24:27], a[220:223], a[72:75], a[24:27]
  v_cvt_pk_bf16_f32 v103, v28, v29
  buffer_store_dwordx4 v[100:103], v5, s[32:35], s38 offen offset:2048 sc1
  v_accvgpr_read_b32 v22, a8
  v_mfma_f32_16x16x32_bf16 a[28:31], a[220:223], a[76:79], a[28:31]
  v_accvgpr_read_b32 v23, a9
  v_cvt_pk_bf16_f32 v30, v120, v121
  v_cvt_pk_bf16_f32 v31, v22, v23
  s_waitcnt lgkmcnt(6)
  v_mfma_f32_16x16x32_bf16 v[128:131], a[224:227], a[80:83], v[128:131]
  ds_read_b64_tr_b16 a[204:205], v19 offset:8192
  v_pk_max_i16 v30, v30, 0
  v_lshlrev_b32 v2, 16, v31
  v_and_b32 v3, s40, v31
  v_mfma_f32_16x16x32_bf16 v[132:135], a[224:227], a[84:87], v[132:135]
  ds_read_b64_tr_b16 a[206:207], v19 offset:12288
  v_lshlrev_b32 v26, 16, v30
  v_and_b32 v27, s40, v30
  v_mul_f32 v26, v26, v2
  v_mfma_f32_16x16x32_bf16 v[136:139], a[224:227], a[88:91], v[136:139]
  v_mul_f32 v27, v27, v3
  v_accvgpr_read_b32 v22, a10
  v_accvgpr_read_b32 v23, a11
  v_mfma_f32_16x16x32_bf16 v[140:143], a[224:227], a[92:95], v[140:143]
  v_cvt_pk_bf16_f32 v30, v122, v123
  v_cvt_pk_bf16_f32 v31, v22, v23
  v_pk_max_i16 v30, v30, 0
  s_waitcnt lgkmcnt(6)
  v_mfma_f32_16x16x32_bf16 a[16:19], a[192:195], a[80:83], a[16:19]
  ds_read_b64_tr_b16 a[208:209], v19 offset:26624
  v_lshlrev_b32 v2, 16, v31
  v_and_b32 v3, s40, v31
  v_lshlrev_b32 v28, 16, v30
  v_mfma_f32_16x16x32_bf16 a[20:23], a[192:195], a[84:87], a[20:23]
  ds_read_b64_tr_b16 a[210:211], v19 offset:30720
  v_and_b32 v29, s40, v30
  v_mul_f32 v28, v28, v2
  v_mul_f32 v29, v29, v3
  v_mfma_f32_16x16x32_bf16 a[24:27], a[192:195], a[88:91], a[24:27]
  v_cvt_pk_bf16_f32 v106, v26, v27
  v_cvt_pk_bf16_f32 v107, v28, v29
  buffer_store_dwordx4 v[104:107], v6, s[32:35], s38 offen offset:2048 sc1
  v_mfma_f32_16x16x32_bf16 a[28:31], a[192:195], a[92:95], a[28:31]
  v_accvgpr_read_b32 v22, a12
  v_accvgpr_read_b32 v23, a13
  v_cvt_pk_bf16_f32 v30, v124, v125
  s_waitcnt lgkmcnt(6)
  v_mfma_f32_16x16x32_bf16 v[144:147], a[196:199], a[160:163], v[144:147]
  v_add_u32 v0, 0xfffe5000, v19
  ds_read_b64_tr_b16 a[212:213], v0 offset:0
  v_cvt_pk_bf16_f32 v31, v22, v23
  v_pk_max_i16 v30, v30, 0
  v_lshlrev_b32 v2, 16, v31
  v_mfma_f32_16x16x32_bf16 v[148:151], a[196:199], a[164:167], v[148:151]
  ds_read_b64_tr_b16 a[214:215], v0 offset:4096
  v_and_b32 v3, s40, v31
  v_lshlrev_b32 v26, 16, v30
  v_and_b32 v27, s40, v30
  v_mfma_f32_16x16x32_bf16 v[152:155], a[196:199], a[168:171], v[152:155]
  v_mul_f32 v26, v26, v2
  v_mul_f32 v27, v27, v3
  v_accvgpr_read_b32 v22, a14
  v_mfma_f32_16x16x32_bf16 v[156:159], a[196:199], a[172:175], v[156:159]
  v_accvgpr_read_b32 v23, a15
  v_cvt_pk_bf16_f32 v30, v126, v127
  v_cvt_pk_bf16_f32 v31, v22, v23
  s_waitcnt lgkmcnt(6)
  v_mfma_f32_16x16x32_bf16 a[32:35], a[200:203], a[160:163], a[32:35]
  ds_read_b64_tr_b16 a[216:217], v0 offset:18432
  v_pk_max_i16 v30, v30, 0
  v_lshlrev_b32 v2, 16, v31
  v_and_b32 v3, s40, v31
  v_mfma_f32_16x16x32_bf16 a[36:39], a[200:203], a[164:167], a[36:39]
  ds_read_b64_tr_b16 a[218:219], v0 offset:22528
  v_lshlrev_b32 v28, 16, v30
  v_and_b32 v29, s40, v30
  v_mul_f32 v28, v28, v2
  v_mfma_f32_16x16x32_bf16 a[40:43], a[200:203], a[168:171], a[40:43]
  v_mul_f32 v29, v29, v3
  v_cvt_pk_bf16_f32 v110, v26, v27
  v_cvt_pk_bf16_f32 v111, v28, v29
  v_mfma_f32_16x16x32_bf16 a[44:47], a[200:203], a[172:175], a[44:47]
  buffer_store_dwordx4 v[108:111], v7, s[32:35], s38 offen offset:2048 sc1
  v_accvgpr_read_b32 v22, a16
  v_accvgpr_read_b32 v23, a17
  s_waitcnt lgkmcnt(6)
  v_mfma_f32_16x16x32_bf16 v[144:147], a[204:207], a[176:179], v[144:147]
  ds_read_b64_tr_b16 a[220:221], v0 offset:8192
  v_cvt_pk_bf16_f32 v30, v128, v129
  v_cvt_pk_bf16_f32 v31, v22, v23
  v_pk_max_i16 v30, v30, 0
  v_mfma_f32_16x16x32_bf16 v[148:151], a[204:207], a[180:183], v[148:151]
  ds_read_b64_tr_b16 a[222:223], v0 offset:12288
  v_lshlrev_b32 v2, 16, v31
  v_and_b32 v3, s40, v31
  v_lshlrev_b32 v26, 16, v30
  v_mfma_f32_16x16x32_bf16 v[152:155], a[204:207], a[184:187], v[152:155]
  v_and_b32 v27, s40, v30
  v_mul_f32 v26, v26, v2
  v_mul_f32 v27, v27, v3
  v_mfma_f32_16x16x32_bf16 v[156:159], a[204:207], a[188:191], v[156:159]
  v_accvgpr_read_b32 v22, a18
  v_accvgpr_read_b32 v23, a19
  v_cvt_pk_bf16_f32 v30, v130, v131
  s_waitcnt lgkmcnt(6)
  v_mfma_f32_16x16x32_bf16 a[32:35], a[208:211], a[176:179], a[32:35]
  ds_read_b64_tr_b16 a[224:225], v0 offset:26624
  v_cvt_pk_bf16_f32 v31, v22, v23
  v_pk_max_i16 v30, v30, 0
  v_lshlrev_b32 v2, 16, v31
  v_mfma_f32_16x16x32_bf16 a[36:39], a[208:211], a[180:183], a[36:39]
  ds_read_b64_tr_b16 a[226:227], v0 offset:30720
  v_and_b32 v3, s40, v31
  v_lshlrev_b32 v28, 16, v30
  v_and_b32 v29, s40, v30
  v_mfma_f32_16x16x32_bf16 a[40:43], a[208:211], a[184:187], a[40:43]
  v_mul_f32 v28, v28, v2
  v_mul_f32 v29, v29, v3
  v_cvt_pk_bf16_f32 v128, v26, v27
  v_mfma_f32_16x16x32_bf16 a[44:47], a[208:211], a[188:191], a[44:47]
  v_cvt_pk_bf16_f32 v129, v28, v29
  v_accvgpr_read_b32 v22, a20
  v_accvgpr_read_b32 v23, a21
  s_waitcnt lgkmcnt(6)
  v_mfma_f32_16x16x32_bf16 v[144:147], a[212:215], a[64:67], v[144:147]
  v_cvt_pk_bf16_f32 v30, v132, v133
  v_cvt_pk_bf16_f32 v31, v22, v23
  v_pk_max_i16 v30, v30, 0
  v_mfma_f32_16x16x32_bf16 v[148:151], a[212:215], a[68:71], v[148:151]
  v_lshlrev_b32 v2, 16, v31
  v_and_b32 v3, s40, v31
  v_lshlrev_b32 v26, 16, v30
  v_mfma_f32_16x16x32_bf16 v[152:155], a[212:215], a[72:75], v[152:155]
  v_and_b32 v27, s40, v30
  v_mul_f32 v26, v26, v2
  v_mul_f32 v27, v27, v3
  v_mfma_f32_16x16x32_bf16 v[156:159], a[212:215], a[76:79], v[156:159]
  v_accvgpr_read_b32 v22, a22
  v_accvgpr_read_b32 v23, a23
  v_cvt_pk_bf16_f32 v30, v134, v135
  s_waitcnt lgkmcnt(4)
  v_mfma_f32_16x16x32_bf16 a[32:35], a[216:219], a[64:67], a[32:35]
  v_cvt_pk_bf16_f32 v31, v22, v23
  v_pk_max_i16 v30, v30, 0
  v_lshlrev_b32 v2, 16, v31
  v_mfma_f32_16x16x32_bf16 a[36:39], a[216:219], a[68:71], a[36:39]
  v_and_b32 v3, s40, v31
  v_lshlrev_b32 v28, 16, v30
  v_and_b32 v29, s40, v30
  v_mfma_f32_16x16x32_bf16 a[40:43], a[216:219], a[72:75], a[40:43]
  v_mul_f32 v28, v28, v2
  v_mul_f32 v29, v29, v3
  v_cvt_pk_bf16_f32 v132, v26, v27
  v_mfma_f32_16x16x32_bf16 a[44:47], a[216:219], a[76:79], a[44:47]
  v_cvt_pk_bf16_f32 v133, v28, v29
  v_accvgpr_read_b32 v22, a24
  v_accvgpr_read_b32 v23, a25
  s_waitcnt lgkmcnt(2)
  v_mfma_f32_16x16x32_bf16 v[144:147], a[220:223], a[80:83], v[144:147]
  v_cvt_pk_bf16_f32 v30, v136, v137
  v_cvt_pk_bf16_f32 v31, v22, v23
  v_pk_max_i16 v30, v30, 0
  v_mfma_f32_16x16x32_bf16 v[148:151], a[220:223], a[84:87], v[148:151]
  v_lshlrev_b32 v2, 16, v31
  v_and_b32 v3, s40, v31
  v_lshlrev_b32 v26, 16, v30
  v_mfma_f32_16x16x32_bf16 v[152:155], a[220:223], a[88:91], v[152:155]
  v_and_b32 v27, s40, v30
  v_mul_f32 v26, v26, v2
  v_mul_f32 v27, v27, v3
  v_mfma_f32_16x16x32_bf16 v[156:159], a[220:223], a[92:95], v[156:159]
  v_accvgpr_read_b32 v22, a26
  v_accvgpr_read_b32 v23, a27
  v_cvt_pk_bf16_f32 v30, v138, v139
  s_waitcnt lgkmcnt(0)
  v_mfma_f32_16x16x32_bf16 a[32:35], a[224:227], a[80:83], a[32:35]
  v_cvt_pk_bf16_f32 v31, v22, v23
  v_pk_max_i16 v30, v30, 0
  v_lshlrev_b32 v2, 16, v31
  v_mfma_f32_16x16x32_bf16 a[36:39], a[224:227], a[84:87], a[36:39]
  v_and_b32 v3, s40, v31
  v_lshlrev_b32 v28, 16, v30
  v_and_b32 v29, s40, v30
  v_mfma_f32_16x16x32_bf16 a[40:43], a[224:227], a[88:91], a[40:43]
  v_mul_f32 v28, v28, v2
  v_mul_f32 v29, v29, v3
  v_cvt_pk_bf16_f32 v136, v26, v27
  v_mfma_f32_16x16x32_bf16 a[44:47], a[224:227], a[92:95], a[44:47]
  v_cvt_pk_bf16_f32 v137, v28, v29
  v_accvgpr_read_b32 v22, a28
  v_accvgpr_read_b32 v23, a29
  s_nop 7
  s_nop 3
  v_cvt_pk_bf16_f32 v30, v140, v141
  v_cvt_pk_bf16_f32 v31, v22, v23
  v_pk_max_i16 v30, v30, 0
  v_lshlrev_b32 v2, 16, v31
  v_and_b32 v3, s40, v31
  v_lshlrev_b32 v26, 16, v30
  v_and_b32 v27, s40, v30
  v_mul_f32 v26, v26, v2
  v_mul_f32 v27, v27, v3
  v_accvgpr_read_b32 v22, a30
  v_accvgpr_read_b32 v23, a31
  v_cvt_pk_bf16_f32 v30, v142, v143
  v_cvt_pk_bf16_f32 v31, v22, v23
  v_pk_max_i16 v30, v30, 0
  v_lshlrev_b32 v2, 16, v31
  v_and_b32 v3, s40, v31
  v_lshlrev_b32 v28, 16, v30
  v_and_b32 v29, s40, v30
  v_mul_f32 v28, v28, v2
  v_mul_f32 v29, v29, v3
  v_cvt_pk_bf16_f32 v140, v26, v27
  v_cvt_pk_bf16_f32 v141, v28, v29
  v_accvgpr_read_b32 v22, a32
  v_accvgpr_read_b32 v23, a33
  v_cvt_pk_bf16_f32 v30, v144, v145
  v_cvt_pk_bf16_f32 v31, v22, v23
  v_pk_max_i16 v30, v30, 0
  v_lshlrev_b32 v2, 16, v31
  v_and_b32 v3, s40, v31
  v_lshlrev_b32 v26, 16, v30
  v_and_b32 v27, s40, v30
  v_mul_f32 v26, v26, v2
  v_mul_f32 v27, v27, v3
  v_accvgpr_read_b32 v22, a34
  v_accvgpr_read_b32 v23, a35
  v_cvt_pk_bf16_f32 v30, v146, v147
  v_cvt_pk_bf16_f32 v31, v22, v23
  v_pk_max_i16 v30, v30, 0
  v_lshlrev_b32 v2, 16, v31
  v_and_b32 v3, s40, v31
  v_lshlrev_b32 v28, 16, v30
  v_and_b32 v29, s40, v30
  v_mul_f32 v28, v28, v2
  v_mul_f32 v29, v29, v3
  v_cvt_pk_bf16_f32 v130, v26, v27
  v_cvt_pk_bf16_f32 v131, v28, v29
  buffer_store_dwordx4 v[128:131], v4, s[32:35], s38 offen offset:3072 sc1
  v_accvgpr_read_b32 v22, a36
  v_accvgpr_read_b32 v23, a37
  v_cvt_pk_bf16_f32 v30, v148, v149
  v_cvt_pk_bf16_f32 v31, v22, v23
  v_pk_max_i16 v30, v30, 0
  v_lshlrev_b32 v2, 16, v31
  v_and_b32 v3, s40, v31
  v_lshlrev_b32 v26, 16, v30
  v_and_b32 v27, s40, v30
  v_mul_f32 v26, v26, v2
  v_mul_f32 v27, v27, v3
  v_accvgpr_read_b32 v22, a38
  v_accvgpr_read_b32 v23, a39
  v_cvt_pk_bf16_f32 v30, v150, v151
  v_cvt_pk_bf16_f32 v31, v22, v23
  v_pk_max_i16 v30, v30, 0
  v_lshlrev_b32 v2, 16, v31
  v_and_b32 v3, s40, v31
  v_lshlrev_b32 v28, 16, v30
  v_and_b32 v29, s40, v30
  v_mul_f32 v28, v28, v2
  v_mul_f32 v29, v29, v3
  v_cvt_pk_bf16_f32 v134, v26, v27
  v_cvt_pk_bf16_f32 v135, v28, v29
  buffer_store_dwordx4 v[132:135], v5, s[32:35], s38 offen offset:3072 sc1
  v_accvgpr_read_b32 v22, a40
  v_accvgpr_read_b32 v23, a41
  v_cvt_pk_bf16_f32 v30, v152, v153
  v_cvt_pk_bf16_f32 v31, v22, v23
  v_pk_max_i16 v30, v30, 0
  v_lshlrev_b32 v2, 16, v31
  v_and_b32 v3, s40, v31
  v_lshlrev_b32 v26, 16, v30
  v_and_b32 v27, s40, v30
  v_mul_f32 v26, v26, v2
  v_mul_f32 v27, v27, v3
  v_accvgpr_read_b32 v22, a42
  v_accvgpr_read_b32 v23, a43
  v_cvt_pk_bf16_f32 v30, v154, v155
  v_cvt_pk_bf16_f32 v31, v22, v23
  v_pk_max_i16 v30, v30, 0
  v_lshlrev_b32 v2, 16, v31
  v_and_b32 v3, s40, v31
  v_lshlrev_b32 v28, 16, v30
  v_and_b32 v29, s40, v30
  v_mul_f32 v28, v28, v2
  v_mul_f32 v29, v29, v3
  v_cvt_pk_bf16_f32 v138, v26, v27
  v_cvt_pk_bf16_f32 v139, v28, v29
  buffer_store_dwordx4 v[136:139], v6, s[32:35], s38 offen offset:3072 sc1
  v_accvgpr_read_b32 v22, a44
  v_accvgpr_read_b32 v23, a45
  v_cvt_pk_bf16_f32 v30, v156, v157
  v_cvt_pk_bf16_f32 v31, v22, v23
  v_pk_max_i16 v30, v30, 0
  v_lshlrev_b32 v2, 16, v31
  v_and_b32 v3, s40, v31
  v_lshlrev_b32 v26, 16, v30
  v_and_b32 v27, s40, v30
  v_mul_f32 v26, v26, v2
  v_mul_f32 v27, v27, v3
  v_accvgpr_read_b32 v22, a46
  v_accvgpr_read_b32 v23, a47
  v_cvt_pk_bf16_f32 v30, v158, v159
  v_cvt_pk_bf16_f32 v31, v22, v23
  v_pk_max_i16 v30, v30, 0
  v_lshlrev_b32 v2, 16, v31
  v_and_b32 v3, s40, v31
  v_lshlrev_b32 v28, 16, v30
  v_and_b32 v29, s40, v30
  v_mul_f32 v28, v28, v2
  v_mul_f32 v29, v29, v3
  v_cvt_pk_bf16_f32 v142, v26, v27
  v_cvt_pk_bf16_f32 v143, v28, v29
  buffer_store_dwordx4 v[140:143], v7, s[32:35], s38 offen offset:3072 sc1
  s_waitcnt vmcnt(0) lgkmcnt(0)
  s_barrier
  s_cmp_lg_u32 s18, 0
  s_cbranch_scc1 mega_kernel_h_notw051
  s_lshl_b32 s36, s22, 5
  s_lshl_b32 s37, s52, 2
  s_add_u32 s36, s36, s37
  s_add_u32 s36, s36, s53
  s_lshl_b32 s36, s36, 2
  s_add_u32 s36, s36, 4096
  s_mov_b64 exec, 1
  v_mov_b32 v2, s36
  v_mov_b32 v3, s3
  global_store_dword v2, v3, s[12:13] sc1
  s_lshl_b32 s36, s2, 2
  s_add_u32 s36, s36, 7168
  v_mov_b32 v2, s36
  global_store_dword v2, v3, s[12:13] sc1
  s_mov_b64 exec, -1
mega_kernel_h_notw051:
  s_add_u32 s28, s10, 13631488
  s_addc_u32 s29, s11, 0
  s_mov_b32 s30, 18874368
  s_mov_b32 s31, 0x00020000
  s_mul_i32 s36, s64, 147456
  s_mul_i32 s37, s62, 36864
  s_add_u32 s36, s36, s37
  v_lshl_add_u32 v4, v1, 4, s36
  s_mov_b32 s36, 0xfffee000
  s_mov_b32 s46, 0
  s_mov_b32 s48, 36864
  s_mov_b32 s51, 0
  v_add_u32 v5, 147456, v4
  v_add_u32 v6, 147456, v5
  v_add_u32 v7, 147456, v6
  v_add_u32 v12, s36, v12
  v_add_u32 v13, s36, v13
  v_add_u32 v14, s36, v14
  v_add_u32 v15, s36, v15
  v_add_u32 v16, s36, v16
  v_add_u32 v17, s36, v17
  v_add_u32 v18, s36, v18
  v_add_u32 v19, s36, v19
  v_add_u32 v20, s36, v20
  v_mov_b32 v32, 0
  v_mov_b32 v33, 0
  v_mov_b32 v34, 0
  v_mov_b32 v35, 0
  v_mov_b32 v36, 0
  v_mov_b32 v37, 0
  v_mov_b32 v38, 0
  v_mov_b32 v39, 0
  v_mov_b32 v40, 0
  v_mov_b32 v41, 0
  v_mov_b32 v42, 0
  v_mov_b32 v43, 0
  v_mov_b32 v44, 0
  v_mov_b32 v45, 0
  v_mov_b32 v46, 0
  v_mov_b32 v47, 0
  v_mov_b32 v48, 0
  v_mov_b32 v49, 0
  v_mov_b32 v50, 0
  v_mov_b32 v51, 0
  v_mov_b32 v52, 0
  v_mov_b32 v53, 0
  v_mov_b32 v54, 0
  v_mov_b32 v55, 0
  v_mov_b32 v56, 0
  v_mov_b32 v57, 0
  v_mov_b32 v58, 0
  v_mov_b32 v59, 0
  v_mov_b32 v60, 0
  v_mov_b32 v61, 0
  v_mov_b32 v62, 0
  v_mov_b32 v63, 0
  v_mov_b32 v64, 0
  v_mov_b32 v65, 0
  v_mov_b32 v66, 0
  v_mov_b32 v67, 0
  v_mov_b32 v68, 0
  v_mov_b32 v69, 0
  v_mov_b32 v70, 0
  v_mov_b32 v71, 0
  v_mov_b32 v72, 0
  v_mov_b32 v73, 0
  v_mov_b32 v74, 0
  v_mov_b32 v75, 0
  v_mov_b32 v76, 0
  v_mov_b32 v77, 0
  v_mov_b32 v78, 0
  v_mov_b32 v79, 0
  v_mov_b32 v80, 0
  v_mov_b32 v81, 0
  v_mov_b32 v82, 0
  v_mov_b32 v83, 0
  v_mov_b32 v84, 0
  v_mov_b32 v85, 0
  v_mov_b32 v86, 0
  v_mov_b32 v87, 0
  v_mov_b32 v88, 0
  v_mov_b32 v89, 0
  v_mov_b32 v90, 0
  v_mov_b32 v91, 0
  v_mov_b32 v92, 0
  v_mov_b32 v93, 0
  v_mov_b32 v94, 0
  v_mov_b32 v95, 0
  v_mov_b32 v96, 0
  v_mov_b32 v97, 0
  v_mov_b32 v98, 0
  v_mov_b32 v99, 0
  v_mov_b32 v100, 0
  v_mov_b32 v101, 0
  v_mov_b32 v102, 0
  v_mov_b32 v103, 0
  s_lshr_b32 s37, s63, 1
  s_lshl_b32 s37, s37, 7
  s_lshl_b32 s36, s62, 5
  s_add_u32 s37, s37, s36
  s_add_u32 s37, s37, 4096
  s_cmp_lg_u32 s18, 0
  s_cbranch_scc1 mega_kernel_wskip52
  v_min_u32 v2, 1, v1
  v_lshlrev_b32 v2, 4, v2
  v_add_u32 v2, s37, v2
  s_and_b32 s36, s2, 31
  s_mul_i32 s36, s36, 0
  v_add_u32 v2, s36, v2
  s_mov_b32 s36, 0
mega_kernel_poll53:
  global_load_dwordx4 v[28:31], v2, s[12:13] sc1
  s_add_u32 s36, s36, 1
  s_waitcnt vmcnt(0)
  v_xor_b32 v28, s3, v28
  v_xor_b32 v29, s3, v29
  v_xor_b32 v30, s3, v30
  v_xor_b32 v31, s3, v31
  v_or3_b32 v28, v28, v29, v30
  v_or_b32 v28, v28, v31
  v_cmp_ne_u32 vcc, 0, v28
  s_cmp_ge_u32 s36, 1048576
  s_cbranch_scc1 mega_kernel_pdone54
  s_cbranch_vccz mega_kernel_pdone54
  s_sleep 1
  s_branch mega_kernel_poll53
mega_kernel_pdone54:
mega_kernel_wskip52:
  s_waitcnt vmcnt(0)
  s_barrier
  buffer_load_dwordx4 a[0:3], v4, s[28:31], s46 offen offset:0 sc1
  buffer_load_dwordx4 a[4:7], v5, s[28:31], s46 offen offset:0 sc1
  buffer_load_dwordx4 a[8:11], v4, s[28:31], s46 offen offset:1024 sc1
  buffer_load_dwordx4 a[12:15], v5, s[28:31], s46 offen offset:1024 sc1
  buffer_load_dwordx4 a[16:19], v4, s[28:31], s46 offen offset:2048 sc1
  buffer_load_dwordx4 a[20:23], v5, s[28:31], s46 offen offset:2048 sc1
  buffer_load_dwordx4 a[24:27], v4, s[28:31], s46 offen offset:3072 sc1
  buffer_load_dwordx4 a[28:31], v5, s[28:31], s46 offen offset:3072 sc1
  s_add_u32 s46, s46, 4096
  buffer_load_dwordx4 a[32:35], v4, s[28:31], s46 offen offset:0 sc1
  buffer_load_dwordx4 a[36:39], v5, s[28:31], s46 offen offset:0 sc1
  buffer_load_dwordx4 a[40:43], v4, s[28:31], s46 offen offset:1024 sc1
  buffer_load_dwordx4 a[44:47], v5, s[28:31], s46 offen offset:1024 sc1
  buffer_load_dwordx4 a[48:51], v4, s[28:31], s46 offen offset:2048 sc1
  buffer_load_dwordx4 a[52:55], v5, s[28:31], s46 offen offset:2048 sc1
  buffer_load_dwordx4 a[56:59], v4, s[28:31], s46 offen offset:3072 sc1
  buffer_load_dwordx4 a[60:63], v5, s[28:31], s46 offen offset:3072 sc1
  s_add_u32 s46, s46, 4096
  buffer_load_dwordx4 a[64:67], v4, s[28:31], s46 offen offset:0 sc1
  buffer_load_dwordx4 a[68:71], v5, s[28:31], s46 offen offset:0 sc1
  buffer_load_dwordx4 a[72:75], v4, s[28:31], s46 offen offset:1024 sc1
  buffer_load_dwordx4 a[76:79], v5, s[28:31], s46 offen offset:1024 sc1
  buffer_load_dwordx4 a[80:83], v4, s[28:31], s46 offen offset:2048 sc1
  buffer_load_dwordx4 a[84:87], v5, s[28:31], s46 offen offset:2048 sc1
  buffer_load_dwordx4 a[88:91], v4, s[28:31], s46 offen offset:3072 sc1
  buffer_load_dwordx4 a[92:95], v5, s[28:31], s46 offen offset:3072 sc1
  s_add_u32 s46, s46, 4096
  ds_read_b64_tr_b16 a[192:193], v12 offset:0
  ds_read_b64_tr_b16 a[194:195], v12 offset:4096
  ds_read_b64_tr_b16 a[196:197], v13 offset:0
  ds_read_b64_tr_b16 a[198:199], v13 offset:4096
  ds_read_b64_tr_b16 a[200:201], v14 offset:0
  ds_read_b64_tr_b16 a[202:203], v14 offset:4096
  ds_read_b64_tr_b16 a[204:205], v15 offset:0
  ds_read_b64_tr_b16 a[206:207], v15 offset:4096
  ds_read_b64_tr_b16 a[208:209], v16 offset:0
  ds_read_b64_tr_b16 a[210:211], v16 offset:4096
  ds_read_b64_tr_b16 a[212:213], v17 offset:0
  ds_read_b64_tr_b16 a[214:215], v17 offset:4096
  ds_read_b64_tr_b16 a[216:217], v18 offset:0
  ds_read_b64_tr_b16 a[218:219], v18 offset:4096
  s_waitcnt vmcnt(16)
mega_kernel_loop255:
  s_add_u32 s48, s48, 36864
  s_cmp_ge_u32 s48, 147456
  s_cselect_b32 s49, 0xfffe5000, s50
  s_cselect_b32 s48, 0, s48
  s_waitcnt lgkmcnt(12)
  v_mfma_f32_16x16x32_bf16 v[32:35], a[192:195], a[0:3], v[32:35]
  ds_read_b64_tr_b16 a[220:221], v19 offset:0
  v_mfma_f32_16x16x32_bf16 v[36:39], a[192:195], a[4:7], v[36:39]
  ds_read_b64_tr_b16 a[222:223], v19 offset:4096
  s_add_u32 s60, s55, s42
  s_mov_b32 s61, s54
  s_add_u32 m0, s60, 0
  s_nop 0
  buffer_load_dwordx4 v8, s[24:27], s61 offen lds
  s_waitcnt lgkmcnt(12)
  v_mfma_f32_16x16x32_bf16 v[40:43], a[196:199], a[0:3], v[40:43]
  ds_read_b64_tr_b16 a[224:225], v20 offset:0
  v_mfma_f32_16x16x32_bf16 v[44:47], a[196:199], a[4:7], v[44:47]
  ds_read_b64_tr_b16 a[226:227], v20 offset:512
  s_add_u32 m0, s60, 1024
  s_nop 0
  buffer_load_dwordx4 v9, s[24:27], s61 offen lds
  s_add_u32 s61, s61, s65
  s_waitcnt lgkmcnt(12)
  v_mfma_f32_16x16x32_bf16 v[48:51], a[200:203], a[0:3], v[48:51]
  ds_read_b64_tr_b16 a[192:193], v12 offset:8192
  v_mfma_f32_16x16x32_bf16 v[52:55], a[200:203], a[4:7], v[52:55]
  ds_read_b64_tr_b16 a[194:195], v12 offset:12288
  s_waitcnt lgkmcnt(12)
  v_mfma_f32_16x16x32_bf16 v[56:59], a[204:207], a[0:3], v[56:59]
  ds_read_b64_tr_b16 a[196:197], v13 offset:8192
  v_mfma_f32_16x16x32_bf16 v[60:63], a[204:207], a[4:7], v[60:63]
  ds_read_b64_tr_b16 a[198:199], v13 offset:12288
  s_add_u32 m0, s60, 2048
  s_nop 0
  buffer_load_dwordx4 v8, s[24:27], s61 offen lds
  s_waitcnt lgkmcnt(12)
  v_mfma_f32_16x16x32_bf16 v[64:67], a[208:211], a[0:3], v[64:67]
  ds_read_b64_tr_b16 a[200:201], v14 offset:8192
  v_mfma_f32_16x16x32_bf16 v[68:71], a[208:211], a[4:7], v[68:71]
  ds_read_b64_tr_b16 a[202:203], v14 offset:12288
  s_waitcnt lgkmcnt(12)
  v_mfma_f32_16x16x32_bf16 v[72:75], a[212:215], a[0:3], v[72:75]
  ds_read_b64_tr_b16 a[204:205], v15 offset:8192
  v_mfma_f32_16x16x32_bf16 v[76:79], a[212:215], a[4:7], v[76:79]
  ds_read_b64_tr_b16 a[206:207], v15 offset:12288
  s_add_u32 m0, s60, 3072
  s_nop 0
  buffer_load_dwordx4 v9, s[24:27], s61 offen lds
  s_add_u32 s61, s61, s65
  s_waitcnt lgkmcnt(12)
  v_mfma_f32_16x16x32_bf16 v[80:83], a[216:219], a[0:3], v[80:83]
  ds_read_b64_tr_b16 a[208:209], v16 offset:8192
  v_mfma_f32_16x16x32_bf16 v[84:87], a[216:219], a[4:7], v[84:87]
  ds_read_b64_tr_b16 a[210:211], v16 offset:12288
  s_add_u32 m0, s60, 4096
  s_nop 0
  buffer_load_dwordx4 v8, s[24:27], s61 offen lds
  s_waitcnt lgkmcnt(12)
  v_mfma_f32_16x16x32_bf16 v[88:91], a[220:223], a[0:3], v[88:91]
  ds_read_b64_tr_b16 a[212:213], v17 offset:8192
  v_mfma_f32_16x16x32_bf16 v[92:95], a[220:223], a[4:7], v[92:95]
  ds_read_b64_tr_b16 a[214:215], v17 offset:12288
  s_waitcnt lgkmcnt(12)
  v_mfma_f32_16x16x32_bf16 v[96:99], a[224:227], a[0:3], v[96:99]
  ds_read_b64_tr_b16 a[216:217], v18 offset:8192
  v_mfma_f32_16x16x32_bf16 v[100:103], a[224:227], a[4:7], v[100:103]
  ds_read_b64_tr_b16 a[218:219], v18 offset:12288
  s_add_u32 m0, s60, 5120
  s_nop 0
  buffer_load_dwordx4 v9, s[24:27], s61 offen lds
  s_add_u32 s61, s61, s65
  s_waitcnt lgkmcnt(12)
  v_mfma_f32_16x16x32_bf16 v[32:35], a[192:195], a[8:11], v[32:35]
  ds_read_b64_tr_b16 a[220:221], v19 offset:8192
  v_mfma_f32_16x16x32_bf16 v[36:39], a[192:195], a[12:15], v[36:39]
  ds_read_b64_tr_b16 a[222:223], v19 offset:12288
  s_waitcnt lgkmcnt(12)
  v_mfma_f32_16x16x32_bf16 v[40:43], a[196:199], a[8:11], v[40:43]
  ds_read_b64_tr_b16 a[224:225], v20 offset:1024
  v_mfma_f32_16x16x32_bf16 v[44:47], a[196:199], a[12:15], v[44:47]
  ds_read_b64_tr_b16 a[226:227], v20 offset:1536
  s_add_u32 m0, s60, 6144
  s_nop 0
  buffer_load_dwordx4 v8, s[24:27], s61 offen lds
  s_waitcnt lgkmcnt(12)
  v_mfma_f32_16x16x32_bf16 v[48:51], a[200:203], a[8:11], v[48:51]
  ds_read_b64_tr_b16 a[192:193], v12 offset:18432
  v_mfma_f32_16x16x32_bf16 v[52:55], a[200:203], a[12:15], v[52:55]
  ds_read_b64_tr_b16 a[194:195], v12 offset:22528
  s_add_u32 m0, s60, 7168
  s_nop 0
  buffer_load_dwordx4 v9, s[24:27], s61 offen lds
  s_waitcnt lgkmcnt(12)
  v_mfma_f32_16x16x32_bf16 v[56:59], a[204:207], a[8:11], v[56:59]
  ds_read_b64_tr_b16 a[196:197], v13 offset:18432
  v_mfma_f32_16x16x32_bf16 v[60:63], a[204:207], a[12:15], v[60:63]
  ds_read_b64_tr_b16 a[198:199], v13 offset:22528
  s_waitcnt lgkmcnt(12)
  v_mfma_f32_16x16x32_bf16 v[64:67], a[208:211], a[8:11], v[64:67]
  ds_read_b64_tr_b16 a[200:201], v14 offset:18432
  v_mfma_f32_16x16x32_bf16 v[68:71], a[208:211], a[12:15], v[68:71]
  ds_read_b64_tr_b16 a[202:203], v14 offset:22528
  s_add_u32 m0, s55, s43
  s_nop 0
  buffer_load_dwordx4 v10, s[24:27], s54 offen lds
  s_add_u32 s54, s54, s66
  s_add_u32 s55, s55, 36864
  s_cmp_ge_u32 s55, 147456
  s_cselect_b32 s55, 0, s55
  s_waitcnt lgkmcnt(12)
  v_mfma_f32_16x16x32_bf16 v[72:75], a[212:215], a[8:11], v[72:75]
  ds_read_b64_tr_b16 a[204:205], v15 offset:18432
  v_mfma_f32_16x16x32_bf16 v[76:79], a[212:215], a[12:15], v[76:79]
  ds_read_b64_tr_b16 a[206:207], v15 offset:22528
  s_waitcnt lgkmcnt(12)
  v_mfma_f32_16x16x32_bf16 v[80:83], a[216:219], a[8:11], v[80:83]
  ds_read_b64_tr_b16 a[208:209], v16 offset:18432
  v_mfma_f32_16x16x32_bf16 v[84:87], a[216:219], a[12:15], v[84:87]
  ds_read_b64_tr_b16 a[210:211], v16 offset:22528
  buffer_load_dwordx4 a[96:99], v4, s[28:31], s46 offen offset:0 sc1
  s_waitcnt lgkmcnt(12)
  v_mfma_f32_16x16x32_bf16 v[88:91], a[220:223], a[8:11], v[88:91]
  ds_read_b64_tr_b16 a[212:213], v17 offset:18432
  v_mfma_f32_16x16x32_bf16 v[92:95], a[220:223], a[12:15], v[92:95]
  ds_read_b64_tr_b16 a[214:215], v17 offset:22528
  s_waitcnt lgkmcnt(12)
  v_mfma_f32_16x16x32_bf16 v[96:99], a[224:227], a[8:11], v[96:99]
  ds_read_b64_tr_b16 a[216:217], v18 offset:18432
  v_mfma_f32_16x16x32_bf16 v[100:103], a[224:227], a[12:15], v[100:103]
  ds_read_b64_tr_b16 a[218:219], v18 offset:22528
  buffer_load_dwordx4 a[100:103], v5, s[28:31], s46 offen offset:0 sc1
  s_waitcnt lgkmcnt(12)
  v_mfma_f32_16x16x32_bf16 v[32:35], a[192:195], a[16:19], v[32:35]
  ds_read_b64_tr_b16 a[220:221], v19 offset:18432
  v_mfma_f32_16x16x32_bf16 v[36:39], a[192:195], a[20:23], v[36:39]
  ds_read_b64_tr_b16 a[222:223], v19 offset:22528
  buffer_load_dwordx4 a[104:107], v4, s[28:31], s46 offen offset:1024 sc1
  s_waitcnt lgkmcnt(12)
  v_mfma_f32_16x16x32_bf16 v[40:43], a[196:199], a[16:19], v[40:43]
  ds_read_b64_tr_b16 a[224:225], v20 offset:18432
  v_mfma_f32_16x16x32_bf16 v[44:47], a[196:199], a[20:23], v[44:47]
  ds_read_b64_tr_b16 a[226:227], v20 offset:18944
  s_waitcnt lgkmcnt(12)
  v_mfma_f32_16x16x32_bf16 v[48:51], a[200:203], a[16:19], v[48:51]
  ds_read_b64_tr_b16 a[192:193], v12 offset:26624
  v_mfma_f32_16x16x32_bf16 v[52:55], a[200:203], a[20:23], v[52:55]
  ds_read_b64_tr_b16 a[194:195], v12 offset:30720
  v_add_u32 v12, s49, v12
  buffer_load_dwordx4 a[108:111], v5, s[28:31], s46 offen offset:1024 sc1
  s_waitcnt lgkmcnt(12)
  v_mfma_f32_16x16x32_bf16 v[56:59], a[204:207], a[16:19], v[56:59]
  ds_read_b64_tr_b16 a[196:197], v13 offset:26624
  v_mfma_f32_16x16x32_bf16 v[60:63], a[204:207], a[20:23], v[60:63]
  ds_read_b64_tr_b16 a[198:199], v13 offset:30720
  v_add_u32 v13, s49, v13
  s_waitcnt lgkmcnt(12)
  v_mfma_f32_16x16x32_bf16 v[64:67], a[208:211], a[16:19], v[64:67]
  ds_read_b64_tr_b16 a[200:201], v14 offset:26624
  v_mfma_f32_16x16x32_bf16 v[68:71], a[208:211], a[20:23], v[68:71]
  ds_read_b64_tr_b16 a[202:203], v14 offset:30720
  v_add_u32 v14, s49, v14
  buffer_load_dwordx4 a[112:115], v4, s[28:31], s46 offen offset:2048 sc1
  s_waitcnt lgkmcnt(12)
  v_mfma_f32_16x16x32_bf16 v[72:75], a[212:215], a[16:19], v[72:75]
  ds_read_b64_tr_b16 a[204:205], v15 offset:26624
  v_mfma_f32_16x16x32_bf16 v[76:79], a[212:215], a[20:23], v[76:79]
  ds_read_b64_tr_b16 a[206:207], v15 offset:30720
  v_add_u32 v15, s49, v15
  buffer_load_dwordx4 a[116:119], v5, s[28:31], s46 offen offset:2048 sc1
  s_waitcnt lgkmcnt(12)
  v_mfma_f32_16x16x32_bf16 v[80:83], a[216:219], a[16:19], v[80:83]
  ds_read_b64_tr_b16 a[208:209], v16 offset:26624
  v_mfma_f32_16x16x32_bf16 v[84:87], a[216:219], a[20:23], v[84:87]
  ds_read_b64_tr_b16 a[210:211], v16 offset:30720
  v_add_u32 v16, s49, v16
  s_waitcnt lgkmcnt(12)
  v_mfma_f32_16x16x32_bf16 v[88:91], a[220:223], a[16:19], v[88:91]
  ds_read_b64_tr_b16 a[212:213], v17 offset:26624
  v_mfma_f32_16x16x32_bf16 v[92:95], a[220:223], a[20:23], v[92:95]
  ds_read_b64_tr_b16 a[214:215], v17 offset:30720
  v_add_u32 v17, s49, v17
  buffer_load_dwordx4 a[120:123], v4, s[28:31], s46 offen offset:3072 sc1
  s_waitcnt lgkmcnt(12)
  v_mfma_f32_16x16x32_bf16 v[96:99], a[224:227], a[16:19], v[96:99]
  ds_read_b64_tr_b16 a[216:217], v18 offset:26624
  v_mfma_f32_16x16x32_bf16 v[100:103], a[224:227], a[20:23], v[100:103]
  ds_read_b64_tr_b16 a[218:219], v18 offset:30720
  v_add_u32 v18, s49, v18
  s_waitcnt lgkmcnt(12)
  v_mfma_f32_16x16x32_bf16 v[32:35], a[192:195], a[24:27], v[32:35]
  ds_read_b64_tr_b16 a[220:221], v19 offset:26624
  v_mfma_f32_16x16x32_bf16 v[36:39], a[192:195], a[28:31], v[36:39]
  ds_read_b64_tr_b16 a[222:223], v19 offset:30720
  v_add_u32 v19, s49, v19
  buffer_load_dwordx4 a[124:127], v5, s[28:31], s46 offen offset:3072 sc1
  s_add_u32 s46, s46, 4096
  s_waitcnt lgkmcnt(12)
  v_mfma_f32_16x16x32_bf16 v[40:43], a[196:199], a[24:27], v[40:43]
  ds_read_b64_tr_b16 a[224:225], v20 offset:19456
  v_mfma_f32_16x16x32_bf16 v[44:47], a[196:199], a[28:31], v[44:47]
  ds_read_b64_tr_b16 a[226:227], v20 offset:19968
  v_add_u32 v20, s49, v20
  s_waitcnt vmcnt(25)
  s_barrier
  s_waitcnt lgkmcnt(12)
  v_mfma_f32_16x16x32_bf16 v[48:51], a[200:203], a[24:27], v[48:51]
  ds_read_b64_tr_b16 a[192:193], v12 offset:0
  v_mfma_f32_16x16x32_bf16 v[52:55], a[200:203], a[28:31], v[52:55]
  ds_read_b64_tr_b16 a[194:195], v12 offset:4096
  s_waitcnt lgkmcnt(12)
  v_mfma_f32_16x16x32_bf16 v[56:59], a[204:207], a[24:27], v[56:59]
  ds_read_b64_tr_b16 a[196:197], v13 offset:0
  v_mfma_f32_16x16x32_bf16 v[60:63], a[204:207], a[28:31], v[60:63]
  ds_read_b64_tr_b16 a[198:199], v13 offset:4096
  s_waitcnt lgkmcnt(12)
  v_mfma_f32_16x16x32_bf16 v[64:67], a[208:211], a[24:27], v[64:67]
  ds_read_b64_tr_b16 a[200:201], v14 offset:0
  v_mfma_f32_16x16x32_bf16 v[68:71], a[208:211], a[28:31], v[68:71]
  ds_read_b64_tr_b16 a[202:203], v14 offset:4096
  s_waitcnt lgkmcnt(12)
  v_mfma_f32_16x16x32_bf16 v[72:75], a[212:215], a[24:27], v[72:75]
  ds_read_b64_tr_b16 a[204:205], v15 offset:0
  v_mfma_f32_16x16x32_bf16 v[76:79], a[212:215], a[28:31], v[76:79]
  ds_read_b64_tr_b16 a[206:207], v15 offset:4096
  s_waitcnt lgkmcnt(12)
  v_mfma_f32_16x16x32_bf16 v[80:83], a[216:219], a[24:27], v[80:83]
  ds_read_b64_tr_b16 a[208:209], v16 offset:0
  v_mfma_f32_16x16x32_bf16 v[84:87], a[216:219], a[28:31], v[84:87]
  ds_read_b64_tr_b16 a[210:211], v16 offset:4096
  s_waitcnt lgkmcnt(12)
  v_mfma_f32_16x16x32_bf16 v[88:91], a[220:223], a[24:27], v[88:91]
  ds_read_b64_tr_b16 a[212:213], v17 offset:0
  v_mfma_f32_16x16x32_bf16 v[92:95], a[220:223], a[28:31], v[92:95]
  ds_read_b64_tr_b16 a[214:215], v17 offset:4096
  s_waitcnt lgkmcnt(12)
  v_mfma_f32_16x16x32_bf16 v[96:99], a[224:227], a[24:27], v[96:99]
  ds_read_b64_tr_b16 a[216:217], v18 offset:0
  v_mfma_f32_16x16x32_bf16 v[100:103], a[224:227], a[28:31], v[100:103]
  ds_read_b64_tr_b16 a[218:219], v18 offset:4096
  s_add_u32 s48, s48, 36864
  s_cmp_ge_u32 s48, 147456
  s_cselect_b32 s49, 0xfffe5000, s50
  s_cselect_b32 s48, 0, s48
  s_waitcnt lgkmcnt(12)
  v_mfma_f32_16x16x32_bf16 v[32:35], a[192:195], a[32:35], v[32:35]
  ds_read_b64_tr_b16 a[220:221], v19 offset:0
  v_mfma_f32_16x16x32_bf16 v[36:39], a[192:195], a[36:39], v[36:39]
  ds_read_b64_tr_b16 a[222:223], v19 offset:4096
  s_add_u32 s60, s55, s42
  s_mov_b32 s61, s54
  s_add_u32 m0, s60, 0
  s_nop 0
  buffer_load_dwordx4 v8, s[24:27], s61 offen lds
  s_waitcnt lgkmcnt(12)
  v_mfma_f32_16x16x32_bf16 v[40:43], a[196:199], a[32:35], v[40:43]
  ds_read_b64_tr_b16 a[224:225], v20 offset:0
  v_mfma_f32_16x16x32_bf16 v[44:47], a[196:199], a[36:39], v[44:47]
  ds_read_b64_tr_b16 a[226:227], v20 offset:512
  s_add_u32 m0, s60, 1024
  s_nop 0
  buffer_load_dwordx4 v9, s[24:27], s61 offen lds
  s_add_u32 s61, s61, s65
  s_waitcnt lgkmcnt(12)
  v_mfma_f32_16x16x32_bf16 v[48:51], a[200:203], a[32:35], v[48:51]
  ds_read_b64_tr_b16 a[192:193], v12 offset:8192
  v_mfma_f32_16x16x32_bf16 v[52:55], a[200:203], a[36:39], v[52:55]
  ds_read_b64_tr_b16 a[194:195], v12 offset:12288
  s_waitcnt lgkmcnt(12)
  v_mfma_f32_16x16x32_bf16 v[56:59], a[204:207], a[32:35], v[56:59]
  ds_read_b64_tr_b16 a[196:197], v13 offset:8192
  v_mfma_f32_16x16x32_bf16 v[60:63], a[204:207], a[36:39], v[60:63]
  ds_read_b64_tr_b16 a[198:199], v13 offset:12288
  s_add_u32 m0, s60, 2048
  s_nop 0
  buffer_load_dwordx4 v8, s[24:27], s61 offen lds
  s_waitcnt lgkmcnt(12)
  v_mfma_f32_16x16x32_bf16 v[64:67], a[208:211], a[32:35], v[64:67]
  ds_read_b64_tr_b16 a[200:201], v14 offset:8192
  v_mfma_f32_16x16x32_bf16 v[68:71], a[208:211], a[36:39], v[68:71]
  ds_read_b64_tr_b16 a[202:203], v14 offset:12288
  s_waitcnt lgkmcnt(12)
  v_mfma_f32_16x16x32_bf16 v[72:75], a[212:215], a[32:35], v[72:75]
  ds_read_b64_tr_b16 a[204:205], v15 offset:8192
  v_mfma_f32_16x16x32_bf16 v[76:79], a[212:215], a[36:39], v[76:79]
  ds_read_b64_tr_b16 a[206:207], v15 offset:12288
  s_add_u32 m0, s60, 3072
  s_nop 0
  buffer_load_dwordx4 v9, s[24:27], s61 offen lds
  s_add_u32 s61, s61, s65
  s_waitcnt lgkmcnt(12)
  v_mfma_f32_16x16x32_bf16 v[80:83], a[216:219], a[32:35], v[80:83]
  ds_read_b64_tr_b16 a[208:209], v16 offset:8192
  v_mfma_f32_16x16x32_bf16 v[84:87], a[216:219], a[36:39], v[84:87]
  ds_read_b64_tr_b16 a[210:211], v16 offset:12288
  s_add_u32 m0, s60, 4096
  s_nop 0
  buffer_load_dwordx4 v8, s[24:27], s61 offen lds
  s_waitcnt lgkmcnt(12)
  v_mfma_f32_16x16x32_bf16 v[88:91], a[220:223], a[32:35], v[88:91]
  ds_read_b64_tr_b16 a[212:213], v17 offset:8192
  v_mfma_f32_16x16x32_bf16 v[92:95], a[220:223], a[36:39], v[92:95]
  ds_read_b64_tr_b16 a[214:215], v17 offset:12288
  s_waitcnt lgkmcnt(12)
  v_mfma_f32_16x16x32_bf16 v[96:99], a[224:227], a[32:35], v[96:99]
  ds_read_b64_tr_b16 a[216:217], v18 offset:8192
  v_mfma_f32_16x16x32_bf16 v[100:103], a[224:227], a[36:39], v[100:103]
  ds_read_b64_tr_b16 a[218:219], v18 offset:12288
  s_add_u32 m0, s60, 5120
  s_nop 0
  buffer_load_dwordx4 v9, s[24:27], s61 offen lds
  s_add_u32 s61, s61, s65
  s_waitcnt lgkmcnt(12)
  v_mfma_f32_16x16x32_bf16 v[32:35], a[192:195], a[40:43], v[32:35]
  ds_read_b64_tr_b16 a[220:221], v19 offset:8192
  v_mfma_f32_16x16x32_bf16 v[36:39], a[192:195], a[44:47], v[36:39]
  ds_read_b64_tr_b16 a[222:223], v19 offset:12288
  s_waitcnt lgkmcnt(12)
  v_mfma_f32_16x16x32_bf16 v[40:43], a[196:199], a[40:43], v[40:43]
  ds_read_b64_tr_b16 a[224:225], v20 offset:1024
  v_mfma_f32_16x16x32_bf16 v[44:47], a[196:199], a[44:47], v[44:47]
  ds_read_b64_tr_b16 a[226:227], v20 offset:1536
  s_add_u32 m0, s60, 6144
  s_nop 0
  buffer_load_dwordx4 v8, s[24:27], s61 offen lds
  s_waitcnt lgkmcnt(12)
  v_mfma_f32_16x16x32_bf16 v[48:51], a[200:203], a[40:43], v[48:51]
  ds_read_b64_tr_b16 a[192:193], v12 offset:18432
  v_mfma_f32_16x16x32_bf16 v[52:55], a[200:203], a[44:47], v[52:55]
  ds_read_b64_tr_b16 a[194:195], v12 offset:22528
  s_add_u32 m0, s60, 7168
  s_nop 0
  buffer_load_dwordx4 v9, s[24:27], s61 offen lds
  s_waitcnt lgkmcnt(12)
  v_mfma_f32_16x16x32_bf16 v[56:59], a[204:207], a[40:43], v[56:59]
  ds_read_b64_tr_b16 a[196:197], v13 offset:18432
  v_mfma_f32_16x16x32_bf16 v[60:63], a[204:207], a[44:47], v[60:63]
  ds_read_b64_tr_b16 a[198:199], v13 offset:22528
  s_waitcnt lgkmcnt(12)
  v_mfma_f32_16x16x32_bf16 v[64:67], a[208:211], a[40:43], v[64:67]
  ds_read_b64_tr_b16 a[200:201], v14 offset:18432
  v_mfma_f32_16x16x32_bf16 v[68:71], a[208:211], a[44:47], v[68:71]
  ds_read_b64_tr_b16 a[202:203], v14 offset:22528
  s_add_u32 m0, s55, s43
  s_nop 0
  buffer_load_dwordx4 v10, s[24:27], s54 offen lds
  s_add_u32 s54, s54, s66
  s_add_u32 s55, s55, 36864
  s_cmp_ge_u32 s55, 147456
  s_cselect_b32 s55, 0, s55
  s_waitcnt lgkmcnt(12)
  v_mfma_f32_16x16x32_bf16 v[72:75], a[212:215], a[40:43], v[72:75]
  ds_read_b64_tr_b16 a[204:205], v15 offset:18432
  v_mfma_f32_16x16x32_bf16 v[76:79], a[212:215], a[44:47], v[76:79]
  ds_read_b64_tr_b16 a[206:207], v15 offset:22528
  s_waitcnt lgkmcnt(12)
  v_mfma_f32_16x16x32_bf16 v[80:83], a[216:219], a[40:43], v[80:83]
  ds_read_b64_tr_b16 a[208:209], v16 offset:18432
  v_mfma_f32_16x16x32_bf16 v[84:87], a[216:219], a[44:47], v[84:87]
  ds_read_b64_tr_b16 a[210:211], v16 offset:22528
  buffer_load_dwordx4 a[0:3], v4, s[28:31], s46 offen offset:0 sc1
  s_waitcnt lgkmcnt(12)
  v_mfma_f32_16x16x32_bf16 v[88:91], a[220:223], a[40:43], v[88:91]
  ds_read_b64_tr_b16 a[212:213], v17 offset:18432
  v_mfma_f32_16x16x32_bf16 v[92:95], a[220:223], a[44:47], v[92:95]
  ds_read_b64_tr_b16 a[214:215], v17 offset:22528
  s_waitcnt lgkmcnt(12)
  v_mfma_f32_16x16x32_bf16 v[96:99], a[224:227], a[40:43], v[96:99]
  ds_read_b64_tr_b16 a[216:217], v18 offset:18432
  v_mfma_f32_16x16x32_bf16 v[100:103], a[224:227], a[44:47], v[100:103]
  ds_read_b64_tr_b16 a[218:219], v18 offset:22528
  buffer_load_dwordx4 a[4:7], v5, s[28:31], s46 offen offset:0 sc1
  s_waitcnt lgkmcnt(12)
  v_mfma_f32_16x16x32_bf16 v[32:35], a[192:195], a[48:51], v[32:35]
  ds_read_b64_tr_b16 a[220:221], v19 offset:18432
  v_mfma_f32_16x16x32_bf16 v[36:39], a[192:195], a[52:55], v[36:39]
  ds_read_b64_tr_b16 a[222:223], v19 offset:22528
  buffer_load_dwordx4 a[8:11], v4, s[28:31], s46 offen offset:1024 sc1
  s_waitcnt lgkmcnt(12)
  v_mfma_f32_16x16x32_bf16 v[40:43], a[196:199], a[48:51], v[40:43]
  ds_read_b64_tr_b16 a[224:225], v20 offset:18432
  v_mfma_f32_16x16x32_bf16 v[44:47], a[196:199], a[52:55], v[44:47]
  ds_read_b64_tr_b16 a[226:227], v20 offset:18944
  s_waitcnt lgkmcnt(12)
  v_mfma_f32_16x16x32_bf16 v[48:51], a[200:203], a[48:51], v[48:51]
  ds_read_b64_tr_b16 a[192:193], v12 offset:26624
  v_mfma_f32_16x16x32_bf16 v[52:55], a[200:203], a[52:55], v[52:55]
  ds_read_b64_tr_b16 a[194:195], v12 offset:30720
  v_add_u32 v12, s49, v12
  buffer_load_dwordx4 a[12:15], v5, s[28:31], s46 offen offset:1024 sc1
  s_waitcnt lgkmcnt(12)
  v_mfma_f32_16x16x32_bf16 v[56:59], a[204:207], a[48:51], v[56:59]
  ds_read_b64_tr_b16 a[196:197], v13 offset:26624
  v_mfma_f32_16x16x32_bf16 v[60:63], a[204:207], a[52:55], v[60:63]
  ds_read_b64_tr_b16 a[198:199], v13 offset:30720
  v_add_u32 v13, s49, v13
  s_waitcnt lgkmcnt(12)
  v_mfma_f32_16x16x32_bf16 v[64:67], a[208:211], a[48:51], v[64:67]
  ds_read_b64_tr_b16 a[200:201], v14 offset:26624
  v_mfma_f32_16x16x32_bf16 v[68:71], a[208:211], a[52:55], v[68:71]
  ds_read_b64_tr_b16 a[202:203], v14 offset:30720
  v_add_u32 v14, s49, v14
  buffer_load_dwordx4 a[16:19], v4, s[28:31], s46 offen offset:2048 sc1
  s_waitcnt lgkmcnt(12)
  v_mfma_f32_16x16x32_bf16 v[72:75], a[212:215], a[48:51], v[72:75]
  ds_read_b64_tr_b16 a[204:205], v15 offset:26624
  v_mfma_f32_16x16x32_bf16 v[76:79], a[212:215], a[52:55], v[76:79]
  ds_read_b64_tr_b16 a[206:207], v15 offset:30720
  v_add_u32 v15, s49, v15
  buffer_load_dwordx4 a[20:23], v5, s[28:31], s46 offen offset:2048 sc1
  s_waitcnt lgkmcnt(12)
  v_mfma_f32_16x16x32_bf16 v[80:83], a[216:219], a[48:51], v[80:83]
  ds_read_b64_tr_b16 a[208:209], v16 offset:26624
  v_mfma_f32_16x16x32_bf16 v[84:87], a[216:219], a[52:55], v[84:87]
  ds_read_b64_tr_b16 a[210:211], v16 offset:30720
  v_add_u32 v16, s49, v16
  s_waitcnt lgkmcnt(12)
  v_mfma_f32_16x16x32_bf16 v[88:91], a[220:223], a[48:51], v[88:91]
  ds_read_b64_tr_b16 a[212:213], v17 offset:26624
  v_mfma_f32_16x16x32_bf16 v[92:95], a[220:223], a[52:55], v[92:95]
  ds_read_b64_tr_b16 a[214:215], v17 offset:30720
  v_add_u32 v17, s49, v17
  buffer_load_dwordx4 a[24:27], v4, s[28:31], s46 offen offset:3072 sc1
  s_waitcnt lgkmcnt(12)
  v_mfma_f32_16x16x32_bf16 v[96:99], a[224:227], a[48:51], v[96:99]
  ds_read_b64_tr_b16 a[216:217], v18 offset:26624
  v_mfma_f32_16x16x32_bf16 v[100:103], a[224:227], a[52:55], v[100:103]
  ds_read_b64_tr_b16 a[218:219], v18 offset:30720
  v_add_u32 v18, s49, v18
  s_waitcnt lgkmcnt(12)
  v_mfma_f32_16x16x32_bf16 v[32:35], a[192:195], a[56:59], v[32:35]
  ds_read_b64_tr_b16 a[220:221], v19 offset:26624
  v_mfma_f32_16x16x32_bf16 v[36:39], a[192:195], a[60:63], v[36:39]
  ds_read_b64_tr_b16 a[222:223], v19 offset:30720
  v_add_u32 v19, s49, v19
  buffer_load_dwordx4 a[28:31], v5, s[28:31], s46 offen offset:3072 sc1
  s_add_u32 s46, s46, 4096
  s_waitcnt lgkmcnt(12)
  v_mfma_f32_16x16x32_bf16 v[40:43], a[196:199], a[56:59], v[40:43]
  ds_read_b64_tr_b16 a[224:225], v20 offset:19456
  v_mfma_f32_16x16x32_bf16 v[44:47], a[196:199], a[60:63], v[44:47]
  ds_read_b64_tr_b16 a[226:227], v20 offset:19968
  v_add_u32 v20, s49, v20
  s_waitcnt vmcnt(25)
  s_barrier
  s_waitcnt lgkmcnt(12)
  v_mfma_f32_16x16x32_bf16 v[48:51], a[200:203], a[56:59], v[48:51]
  ds_read_b64_tr_b16 a[192:193], v12 offset:0
  v_mfma_f32_16x16x32_bf16 v[52:55], a[200:203], a[60:63], v[52:55]
  ds_read_b64_tr_b16 a[194:195], v12 offset:4096
  s_waitcnt lgkmcnt(12)
  v_mfma_f32_16x16x32_bf16 v[56:59], a[204:207], a[56:59], v[56:59]
  ds_read_b64_tr_b16 a[196:197], v13 offset:0
  v_mfma_f32_16x16x32_bf16 v[60:63], a[204:207], a[60:63], v[60:63]
  ds_read_b64_tr_b16 a[198:199], v13 offset:4096
  s_waitcnt lgkmcnt(12)
  v_mfma_f32_16x16x32_bf16 v[64:67], a[208:211], a[56:59], v[64:67]
  ds_read_b64_tr_b16 a[200:201], v14 offset:0
  v_mfma_f32_16x16x32_bf16 v[68:71], a[208:211], a[60:63], v[68:71]
  ds_read_b64_tr_b16 a[202:203], v14 offset:4096
  s_waitcnt lgkmcnt(12)
  v_mfma_f32_16x16x32_bf16 v[72:75], a[212:215], a[56:59], v[72:75]
  ds_read_b64_tr_b16 a[204:205], v15 offset:0
  v_mfma_f32_16x16x32_bf16 v[76:79], a[212:215], a[60:63], v[76:79]
  ds_read_b64_tr_b16 a[206:207], v15 offset:4096
  s_waitcnt lgkmcnt(12)
  v_mfma_f32_16x16x32_bf16 v[80:83], a[216:219], a[56:59], v[80:83]
  ds_read_b64_tr_b16 a[208:209], v16 offset:0
  v_mfma_f32_16x16x32_bf16 v[84:87], a[216:219], a[60:63], v[84:87]
  ds_read_b64_tr_b16 a[210:211], v16 offset:4096
  s_waitcnt lgkmcnt(12)
  v_mfma_f32_16x16x32_bf16 v[88:91], a[220:223], a[56:59], v[88:91]
  ds_read_b64_tr_b16 a[212:213], v17 offset:0
  v_mfma_f32_16x16x32_bf16 v[92:95], a[220:223], a[60:63], v[92:95]
  ds_read_b64_tr_b16 a[214:215], v17 offset:4096
  s_waitcnt lgkmcnt(12)
  v_mfma_f32_16x16x32_bf16 v[96:99], a[224:227], a[56:59], v[96:99]
  ds_read_b64_tr_b16 a[216:217], v18 offset:0
  v_mfma_f32_16x16x32_bf16 v[100:103], a[224:227], a[60:63], v[100:103]
  ds_read_b64_tr_b16 a[218:219], v18 offset:4096
  s_cmp_eq_u32 s51, 1
  s_cselect_b32 s30, 0, s30
  s_add_u32 s48, s48, 36864
  s_cmp_ge_u32 s48, 147456
  s_cselect_b32 s49, 0xfffe5000, s50
  s_cselect_b32 s48, 0, s48
  s_waitcnt lgkmcnt(12)
  v_mfma_f32_16x16x32_bf16 v[32:35], a[192:195], a[64:67], v[32:35]
  ds_read_b64_tr_b16 a[220:221], v19 offset:0
  v_mfma_f32_16x16x32_bf16 v[36:39], a[192:195], a[68:71], v[36:39]
  ds_read_b64_tr_b16 a[222:223], v19 offset:4096
  s_add_u32 s60, s55, s42
  s_mov_b32 s61, s54
  s_add_u32 m0, s60, 0
  s_nop 0
  buffer_load_dwordx4 v8, s[24:27], s61 offen lds
  s_waitcnt lgkmcnt(12)
  v_mfma_f32_16x16x32_bf16 v[40:43], a[196:199], a[64:67], v[40:43]
  ds_read_b64_tr_b16 a[224:225], v20 offset:0
  v_mfma_f32_16x16x32_bf16 v[44:47], a[196:199], a[68:71], v[44:47]
  ds_read_b64_tr_b16 a[226:227], v20 offset:512
  s_add_u32 m0, s60, 1024
  s_nop 0
  buffer_load_dwordx4 v9, s[24:27], s61 offen lds
  s_add_u32 s61, s61, s65
  s_waitcnt lgkmcnt(12)
  v_mfma_f32_16x16x32_bf16 v[48:51], a[200:203], a[64:67], v[48:51]
  ds_read_b64_tr_b16 a[192:193], v12 offset:8192
  v_mfma_f32_16x16x32_bf16 v[52:55], a[200:203], a[68:71], v[52:55]
  ds_read_b64_tr_b16 a[194:195], v12 offset:12288
  s_waitcnt lgkmcnt(12)
  v_mfma_f32_16x16x32_bf16 v[56:59], a[204:207], a[64:67], v[56:59]
  ds_read_b64_tr_b16 a[196:197], v13 offset:8192
  v_mfma_f32_16x16x32_bf16 v[60:63], a[204:207], a[68:71], v[60:63]
  ds_read_b64_tr_b16 a[198:199], v13 offset:12288
  s_add_u32 m0, s60, 2048
  s_nop 0
  buffer_load_dwordx4 v8, s[24:27], s61 offen lds
  s_waitcnt lgkmcnt(12)
  v_mfma_f32_16x16x32_bf16 v[64:67], a[208:211], a[64:67], v[64:67]
  ds_read_b64_tr_b16 a[200:201], v14 offset:8192
  v_mfma_f32_16x16x32_bf16 v[68:71], a[208:211], a[68:71], v[68:71]
  ds_read_b64_tr_b16 a[202:203], v14 offset:12288
  s_waitcnt lgkmcnt(12)
  v_mfma_f32_16x16x32_bf16 v[72:75], a[212:215], a[64:67], v[72:75]
  ds_read_b64_tr_b16 a[204:205], v15 offset:8192
  v_mfma_f32_16x16x32_bf16 v[76:79], a[212:215], a[68:71], v[76:79]
  ds_read_b64_tr_b16 a[206:207], v15 offset:12288
  s_add_u32 m0, s60, 3072
  s_nop 0
  buffer_load_dwordx4 v9, s[24:27], s61 offen lds
  s_add_u32 s61, s61, s65
  s_waitcnt lgkmcnt(12)
  v_mfma_f32_16x16x32_bf16 v[80:83], a[216:219], a[64:67], v[80:83]
  ds_read_b64_tr_b16 a[208:209], v16 offset:8192
  v_mfma_f32_16x16x32_bf16 v[84:87], a[216:219], a[68:71], v[84:87]
  ds_read_b64_tr_b16 a[210:211], v16 offset:12288
  s_add_u32 m0, s60, 4096
  s_nop 0
  buffer_load_dwordx4 v8, s[24:27], s61 offen lds
  s_waitcnt lgkmcnt(12)
  v_mfma_f32_16x16x32_bf16 v[88:91], a[220:223], a[64:67], v[88:91]
  ds_read_b64_tr_b16 a[212:213], v17 offset:8192
  v_mfma_f32_16x16x32_bf16 v[92:95], a[220:223], a[68:71], v[92:95]
  ds_read_b64_tr_b16 a[214:215], v17 offset:12288
  s_waitcnt lgkmcnt(12)
  v_mfma_f32_16x16x32_bf16 v[96:99], a[224:227], a[64:67], v[96:99]
  ds_read_b64_tr_b16 a[216:217], v18 offset:8192
  v_mfma_f32_16x16x32_bf16 v[100:103], a[224:227], a[68:71], v[100:103]
  ds_read_b64_tr_b16 a[218:219], v18 offset:12288
  s_add_u32 m0, s60, 5120
  s_nop 0
  buffer_load_dwordx4 v9, s[24:27], s61 offen lds
  s_add_u32 s61, s61, s65
  s_waitcnt lgkmcnt(12)
  v_mfma_f32_16x16x32_bf16 v[32:35], a[192:195], a[72:75], v[32:35]
  ds_read_b64_tr_b16 a[220:221], v19 offset:8192
  v_mfma_f32_16x16x32_bf16 v[36:39], a[192:195], a[76:79], v[36:39]
  ds_read_b64_tr_b16 a[222:223], v19 offset:12288
  s_waitcnt lgkmcnt(12)
  v_mfma_f32_16x16x32_bf16 v[40:43], a[196:199], a[72:75], v[40:43]
  ds_read_b64_tr_b16 a[224:225], v20 offset:1024
  v_mfma_f32_16x16x32_bf16 v[44:47], a[196:199], a[76:79], v[44:47]
  ds_read_b64_tr_b16 a[226:227], v20 offset:1536
  s_add_u32 m0, s60, 6144
  s_nop 0
  buffer_load_dwordx4 v8, s[24:27], s61 offen lds
  s_waitcnt lgkmcnt(12)
  v_mfma_f32_16x16x32_bf16 v[48:51], a[200:203], a[72:75], v[48:51]
  ds_read_b64_tr_b16 a[192:193], v12 offset:18432
  v_mfma_f32_16x16x32_bf16 v[52:55], a[200:203], a[76:79], v[52:55]
  ds_read_b64_tr_b16 a[194:195], v12 offset:22528
  s_add_u32 m0, s60, 7168
  s_nop 0
  buffer_load_dwordx4 v9, s[24:27], s61 offen lds
  s_waitcnt lgkmcnt(12)
  v_mfma_f32_16x16x32_bf16 v[56:59], a[204:207], a[72:75], v[56:59]
  ds_read_b64_tr_b16 a[196:197], v13 offset:18432
  v_mfma_f32_16x16x32_bf16 v[60:63], a[204:207], a[76:79], v[60:63]
  ds_read_b64_tr_b16 a[198:199], v13 offset:22528
  s_waitcnt lgkmcnt(12)
  v_mfma_f32_16x16x32_bf16 v[64:67], a[208:211], a[72:75], v[64:67]
  ds_read_b64_tr_b16 a[200:201], v14 offset:18432
  v_mfma_f32_16x16x32_bf16 v[68:71], a[208:211], a[76:79], v[68:71]
  ds_read_b64_tr_b16 a[202:203], v14 offset:22528
  s_add_u32 m0, s55, s43
  s_nop 0
  buffer_load_dwordx4 v10, s[24:27], s54 offen lds
  s_add_u32 s54, s54, s66
  s_add_u32 s55, s55, 36864
  s_cmp_ge_u32 s55, 147456
  s_cselect_b32 s55, 0, s55
  s_waitcnt lgkmcnt(12)
  v_mfma_f32_16x16x32_bf16 v[72:75], a[212:215], a[72:75], v[72:75]
  ds_read_b64_tr_b16 a[204:205], v15 offset:18432
  v_mfma_f32_16x16x32_bf16 v[76:79], a[212:215], a[76:79], v[76:79]
  ds_read_b64_tr_b16 a[206:207], v15 offset:22528
  s_waitcnt lgkmcnt(12)
  v_mfma_f32_16x16x32_bf16 v[80:83], a[216:219], a[72:75], v[80:83]
  ds_read_b64_tr_b16 a[208:209], v16 offset:18432
  v_mfma_f32_16x16x32_bf16 v[84:87], a[216:219], a[76:79], v[84:87]
  ds_read_b64_tr_b16 a[210:211], v16 offset:22528
  buffer_load_dwordx4 a[32:35], v4, s[28:31], s46 offen offset:0 sc1
  s_waitcnt lgkmcnt(12)
  v_mfma_f32_16x16x32_bf16 v[88:91], a[220:223], a[72:75], v[88:91]
  ds_read_b64_tr_b16 a[212:213], v17 offset:18432
  v_mfma_f32_16x16x32_bf16 v[92:95], a[220:223], a[76:79], v[92:95]
  ds_read_b64_tr_b16 a[214:215], v17 offset:22528
  s_waitcnt lgkmcnt(12)
  v_mfma_f32_16x16x32_bf16 v[96:99], a[224:227], a[72:75], v[96:99]
  ds_read_b64_tr_b16 a[216:217], v18 offset:18432
  v_mfma_f32_16x16x32_bf16 v[100:103], a[224:227], a[76:79], v[100:103]
  ds_read_b64_tr_b16 a[218:219], v18 offset:22528
  buffer_load_dwordx4 a[36:39], v5, s[28:31], s46 offen offset:0 sc1
  s_waitcnt lgkmcnt(12)
  v_mfma_f32_16x16x32_bf16 v[32:35], a[192:195], a[80:83], v[32:35]
  ds_read_b64_tr_b16 a[220:221], v19 offset:18432
  v_mfma_f32_16x16x32_bf16 v[36:39], a[192:195], a[84:87], v[36:39]
  ds_read_b64_tr_b16 a[222:223], v19 offset:22528
  buffer_load_dwordx4 a[40:43], v4, s[28:31], s46 offen offset:1024 sc1
  s_waitcnt lgkmcnt(12)
  v_mfma_f32_16x16x32_bf16 v[40:43], a[196:199], a[80:83], v[40:43]
  ds_read_b64_tr_b16 a[224:225], v20 offset:18432
  v_mfma_f32_16x16x32_bf16 v[44:47], a[196:199], a[84:87], v[44:47]
  ds_read_b64_tr_b16 a[226:227], v20 offset:18944
  s_waitcnt lgkmcnt(12)
  v_mfma_f32_16x16x32_bf16 v[48:51], a[200:203], a[80:83], v[48:51]
  ds_read_b64_tr_b16 a[192:193], v12 offset:26624
  v_mfma_f32_16x16x32_bf16 v[52:55], a[200:203], a[84:87], v[52:55]
  ds_read_b64_tr_b16 a[194:195], v12 offset:30720
  v_add_u32 v12, s49, v12
  buffer_load_dwordx4 a[44:47], v5, s[28:31], s46 offen offset:1024 sc1
  s_waitcnt lgkmcnt(12)
  v_mfma_f32_16x16x32_bf16 v[56:59], a[204:207], a[80:83], v[56:59]
  ds_read_b64_tr_b16 a[196:197], v13 offset:26624
  v_mfma_f32_16x16x32_bf16 v[60:63], a[204:207], a[84:87], v[60:63]
  ds_read_b64_tr_b16 a[198:199], v13 offset:30720
  v_add_u32 v13, s49, v13
  s_waitcnt lgkmcnt(12)
  v_mfma_f32_16x16x32_bf16 v[64:67], a[208:211], a[80:83], v[64:67]
  ds_read_b64_tr_b16 a[200:201], v14 offset:26624
  v_mfma_f32_16x16x32_bf16 v[68:71], a[208:211], a[84:87], v[68:71]
  ds_read_b64_tr_b16 a[202:203], v14 offset:30720
  v_add_u32 v14, s49, v14
  buffer_load_dwordx4 a[48:51], v4, s[28:31], s46 offen offset:2048 sc1
  s_waitcnt lgkmcnt(12)
  v_mfma_f32_16x16x32_bf16 v[72:75], a[212:215], a[80:83], v[72:75]
  ds_read_b64_tr_b16 a[204:205], v15 offset:26624
  v_mfma_f32_16x16x32_bf16 v[76:79], a[212:215], a[84:87], v[76:79]
  ds_read_b64_tr_b16 a[206:207], v15 offset:30720
  v_add_u32 v15, s49, v15
  buffer_load_dwordx4 a[52:55], v5, s[28:31], s46 offen offset:2048 sc1
  s_waitcnt lgkmcnt(12)
  v_mfma_f32_16x16x32_bf16 v[80:83], a[216:219], a[80:83], v[80:83]
  ds_read_b64_tr_b16 a[208:209], v16 offset:26624
  v_mfma_f32_16x16x32_bf16 v[84:87], a[216:219], a[84:87], v[84:87]
  ds_read_b64_tr_b16 a[210:211], v16 offset:30720
  v_add_u32 v16, s49, v16
  s_waitcnt lgkmcnt(12)
  v_mfma_f32_16x16x32_bf16 v[88:91], a[220:223], a[80:83], v[88:91]
  ds_read_b64_tr_b16 a[212:213], v17 offset:26624
  v_mfma_f32_16x16x32_bf16 v[92:95], a[220:223], a[84:87], v[92:95]
  ds_read_b64_tr_b16 a[214:215], v17 offset:30720
  v_add_u32 v17, s49, v17
  buffer_load_dwordx4 a[56:59], v4, s[28:31], s46 offen offset:3072 sc1
  s_waitcnt lgkmcnt(12)
  v_mfma_f32_16x16x32_bf16 v[96:99], a[224:227], a[80:83], v[96:99]
  ds_read_b64_tr_b16 a[216:217], v18 offset:26624
  v_mfma_f32_16x16x32_bf16 v[100:103], a[224:227], a[84:87], v[100:103]
  ds_read_b64_tr_b16 a[218:219], v18 offset:30720
  v_add_u32 v18, s49, v18
  s_waitcnt lgkmcnt(12)
  v_mfma_f32_16x16x32_bf16 v[32:35], a[192:195], a[88:91], v[32:35]
  ds_read_b64_tr_b16 a[220:221], v19 offset:26624
  v_mfma_f32_16x16x32_bf16 v[36:39], a[192:195], a[92:95], v[36:39]
  ds_read_b64_tr_b16 a[222:223], v19 offset:30720
  v_add_u32 v19, s49, v19
  buffer_load_dwordx4 a[60:63], v5, s[28:31], s46 offen offset:3072 sc1
  s_add_u32 s46, s46, 4096
  s_waitcnt lgkmcnt(12)
  v_mfma_f32_16x16x32_bf16 v[40:43], a[196:199], a[88:91], v[40:43]
  ds_read_b64_tr_b16 a[224:225], v20 offset:19456
  v_mfma_f32_16x16x32_bf16 v[44:47], a[196:199], a[92:95], v[44:47]
  ds_read_b64_tr_b16 a[226:227], v20 offset:19968
  v_add_u32 v20, s49, v20
  s_waitcnt vmcnt(25)
  s_barrier
  s_waitcnt lgkmcnt(12)
  v_mfma_f32_16x16x32_bf16 v[48:51], a[200:203], a[88:91], v[48:51]
  ds_read_b64_tr_b16 a[192:193], v12 offset:0
  v_mfma_f32_16x16x32_bf16 v[52:55], a[200:203], a[92:95], v[52:55]
  ds_read_b64_tr_b16 a[194:195], v12 offset:4096
  s_waitcnt lgkmcnt(12)
  v_mfma_f32_16x16x32_bf16 v[56:59], a[204:207], a[88:91], v[56:59]
  ds_read_b64_tr_b16 a[196:197], v13 offset:0
  v_mfma_f32_16x16x32_bf16 v[60:63], a[204:207], a[92:95], v[60:63]
  ds_read_b64_tr_b16 a[198:199], v13 offset:4096
  s_waitcnt lgkmcnt(12)
  v_mfma_f32_16x16x32_bf16 v[64:67], a[208:211], a[88:91], v[64:67]
  ds_read_b64_tr_b16 a[200:201], v14 offset:0
  v_mfma_f32_16x16x32_bf16 v[68:71], a[208:211], a[92:95], v[68:71]
  ds_read_b64_tr_b16 a[202:203], v14 offset:4096
  s_waitcnt lgkmcnt(12)
  v_mfma_f32_16x16x32_bf16 v[72:75], a[212:215], a[88:91], v[72:75]
  ds_read_b64_tr_b16 a[204:205], v15 offset:0
  v_mfma_f32_16x16x32_bf16 v[76:79], a[212:215], a[92:95], v[76:79]
  ds_read_b64_tr_b16 a[206:207], v15 offset:4096
  s_waitcnt lgkmcnt(12)
  v_mfma_f32_16x16x32_bf16 v[80:83], a[216:219], a[88:91], v[80:83]
  ds_read_b64_tr_b16 a[208:209], v16 offset:0
  v_mfma_f32_16x16x32_bf16 v[84:87], a[216:219], a[92:95], v[84:87]
  ds_read_b64_tr_b16 a[210:211], v16 offset:4096
  s_waitcnt lgkmcnt(12)
  v_mfma_f32_16x16x32_bf16 v[88:91], a[220:223], a[88:91], v[88:91]
  ds_read_b64_tr_b16 a[212:213], v17 offset:0
  v_mfma_f32_16x16x32_bf16 v[92:95], a[220:223], a[92:95], v[92:95]
  ds_read_b64_tr_b16 a[214:215], v17 offset:4096
  s_waitcnt lgkmcnt(12)
  v_mfma_f32_16x16x32_bf16 v[96:99], a[224:227], a[88:91], v[96:99]
  ds_read_b64_tr_b16 a[216:217], v18 offset:0
  v_mfma_f32_16x16x32_bf16 v[100:103], a[224:227], a[92:95], v[100:103]
  ds_read_b64_tr_b16 a[218:219], v18 offset:4096
  s_cmp_eq_u32 s51, 1
  s_cbranch_scc1 mega_kernel_super256
  s_add_u32 s48, s48, 36864
  s_cmp_ge_u32 s48, 147456
  s_cselect_b32 s49, 0xfffe5000, s50
  s_cselect_b32 s48, 0, s48
  s_waitcnt lgkmcnt(12)
  v_mfma_f32_16x16x32_bf16 v[32:35], a[192:195], a[96:99], v[32:35]
  ds_read_b64_tr_b16 a[220:221], v19 offset:0
  v_mfma_f32_16x16x32_bf16 v[36:39], a[192:195], a[100:103], v[36:39]
  ds_read_b64_tr_b16 a[222:223], v19 offset:4096
  s_add_u32 s60, s55, s42
  s_mov_b32 s61, s54
  s_add_u32 m0, s60, 0
  s_nop 0
  buffer_load_dwordx4 v8, s[24:27], s61 offen lds
  s_waitcnt lgkmcnt(12)
  v_mfma_f32_16x16x32_bf16 v[40:43], a[196:199], a[96:99], v[40:43]
  ds_read_b64_tr_b16 a[224:225], v20 offset:0
  v_mfma_f32_16x16x32_bf16 v[44:47], a[196:199], a[100:103], v[44:47]
  ds_read_b64_tr_b16 a[226:227], v20 offset:512
  s_add_u32 m0, s60, 1024
  s_nop 0
  buffer_load_dwordx4 v9, s[24:27], s61 offen lds
  s_add_u32 s61, s61, s65
  s_waitcnt lgkmcnt(12)
  v_mfma_f32_16x16x32_bf16 v[48:51], a[200:203], a[96:99], v[48:51]
  ds_read_b64_tr_b16 a[192:193], v12 offset:8192
  v_mfma_f32_16x16x32_bf16 v[52:55], a[200:203], a[100:103], v[52:55]
  ds_read_b64_tr_b16 a[194:195], v12 offset:12288
  s_waitcnt lgkmcnt(12)
  v_mfma_f32_16x16x32_bf16 v[56:59], a[204:207], a[96:99], v[56:59]
  ds_read_b64_tr_b16 a[196:197], v13 offset:8192
  v_mfma_f32_16x16x32_bf16 v[60:63], a[204:207], a[100:103], v[60:63]
  ds_read_b64_tr_b16 a[198:199], v13 offset:12288
  s_add_u32 m0, s60, 2048
  s_nop 0
  buffer_load_dwordx4 v8, s[24:27], s61 offen lds
  s_waitcnt lgkmcnt(12)
  v_mfma_f32_16x16x32_bf16 v[64:67], a[208:211], a[96:99], v[64:67]
  ds_read_b64_tr_b16 a[200:201], v14 offset:8192
  v_mfma_f32_16x16x32_bf16 v[68:71], a[208:211], a[100:103], v[68:71]
  ds_read_b64_tr_b16 a[202:203], v14 offset:12288
  s_waitcnt lgkmcnt(12)
  v_mfma_f32_16x16x32_bf16 v[72:75], a[212:215], a[96:99], v[72:75]
  ds_read_b64_tr_b16 a[204:205], v15 offset:8192
  v_mfma_f32_16x16x32_bf16 v[76:79], a[212:215], a[100:103], v[76:79]
  ds_read_b64_tr_b16 a[206:207], v15 offset:12288
  s_add_u32 m0, s60, 3072
  s_nop 0
  buffer_load_dwordx4 v9, s[24:27], s61 offen lds
  s_add_u32 s61, s61, s65
  s_waitcnt lgkmcnt(12)
  v_mfma_f32_16x16x32_bf16 v[80:83], a[216:219], a[96:99], v[80:83]
  ds_read_b64_tr_b16 a[208:209], v16 offset:8192
  v_mfma_f32_16x16x32_bf16 v[84:87], a[216:219], a[100:103], v[84:87]
  ds_read_b64_tr_b16 a[210:211], v16 offset:12288
  s_add_u32 m0, s60, 4096
  s_nop 0
  buffer_load_dwordx4 v8, s[24:27], s61 offen lds
  s_waitcnt lgkmcnt(12)
  v_mfma_f32_16x16x32_bf16 v[88:91], a[220:223], a[96:99], v[88:91]
  ds_read_b64_tr_b16 a[212:213], v17 offset:8192
  v_mfma_f32_16x16x32_bf16 v[92:95], a[220:223], a[100:103], v[92:95]
  ds_read_b64_tr_b16 a[214:215], v17 offset:12288
  s_waitcnt lgkmcnt(12)
  v_mfma_f32_16x16x32_bf16 v[96:99], a[224:227], a[96:99], v[96:99]
  ds_read_b64_tr_b16 a[216:217], v18 offset:8192
  v_mfma_f32_16x16x32_bf16 v[100:103], a[224:227], a[100:103], v[100:103]
  ds_read_b64_tr_b16 a[218:219], v18 offset:12288
  s_add_u32 m0, s60, 5120
  s_nop 0
  buffer_load_dwordx4 v9, s[24:27], s61 offen lds
  s_add_u32 s61, s61, s65
  s_waitcnt lgkmcnt(12)
  v_mfma_f32_16x16x32_bf16 v[32:35], a[192:195], a[104:107], v[32:35]
  ds_read_b64_tr_b16 a[220:221], v19 offset:8192
  v_mfma_f32_16x16x32_bf16 v[36:39], a[192:195], a[108:111], v[36:39]
  ds_read_b64_tr_b16 a[222:223], v19 offset:12288
  s_waitcnt lgkmcnt(12)
  v_mfma_f32_16x16x32_bf16 v[40:43], a[196:199], a[104:107], v[40:43]
  ds_read_b64_tr_b16 a[224:225], v20 offset:1024
  v_mfma_f32_16x16x32_bf16 v[44:47], a[196:199], a[108:111], v[44:47]
  ds_read_b64_tr_b16 a[226:227], v20 offset:1536
  s_add_u32 m0, s60, 6144
  s_nop 0
  buffer_load_dwordx4 v8, s[24:27], s61 offen lds
  s_waitcnt lgkmcnt(12)
  v_mfma_f32_16x16x32_bf16 v[48:51], a[200:203], a[104:107], v[48:51]
  ds_read_b64_tr_b16 a[192:193], v12 offset:18432
  v_mfma_f32_16x16x32_bf16 v[52:55], a[200:203], a[108:111], v[52:55]
  ds_read_b64_tr_b16 a[194:195], v12 offset:22528
  s_add_u32 m0, s60, 7168
  s_nop 0
  buffer_load_dwordx4 v9, s[24:27], s61 offen lds
  s_waitcnt lgkmcnt(12)
  v_mfma_f32_16x16x32_bf16 v[56:59], a[204:207], a[104:107], v[56:59]
  ds_read_b64_tr_b16 a[196:197], v13 offset:18432
  v_mfma_f32_16x16x32_bf16 v[60:63], a[204:207], a[108:111], v[60:63]
  ds_read_b64_tr_b16 a[198:199], v13 offset:22528
  s_waitcnt lgkmcnt(12)
  v_mfma_f32_16x16x32_bf16 v[64:67], a[208:211], a[104:107], v[64:67]
  ds_read_b64_tr_b16 a[200:201], v14 offset:18432
  v_mfma_f32_16x16x32_bf16 v[68:71], a[208:211], a[108:111], v[68:71]
  ds_read_b64_tr_b16 a[202:203], v14 offset:22528
  s_add_u32 m0, s55, s43
  s_nop 0
  buffer_load_dwordx4 v10, s[24:27], s54 offen lds
  s_add_u32 s54, s54, s66
  s_add_u32 s55, s55, 36864
  s_cmp_ge_u32 s55, 147456
  s_cselect_b32 s55, 0, s55
  s_waitcnt lgkmcnt(12)
  v_mfma_f32_16x16x32_bf16 v[72:75], a[212:215], a[104:107], v[72:75]
  ds_read_b64_tr_b16 a[204:205], v15 offset:18432
  v_mfma_f32_16x16x32_bf16 v[76:79], a[212:215], a[108:111], v[76:79]
  ds_read_b64_tr_b16 a[206:207], v15 offset:22528
  s_waitcnt lgkmcnt(12)
  v_mfma_f32_16x16x32_bf16 v[80:83], a[216:219], a[104:107], v[80:83]
  ds_read_b64_tr_b16 a[208:209], v16 offset:18432
  v_mfma_f32_16x16x32_bf16 v[84:87], a[216:219], a[108:111], v[84:87]
  ds_read_b64_tr_b16 a[210:211], v16 offset:22528
  buffer_load_dwordx4 a[64:67], v4, s[28:31], s46 offen offset:0 sc1
  s_waitcnt lgkmcnt(12)
  v_mfma_f32_16x16x32_bf16 v[88:91], a[220:223], a[104:107], v[88:91]
  ds_read_b64_tr_b16 a[212:213], v17 offset:18432
  v_mfma_f32_16x16x32_bf16 v[92:95], a[220:223], a[108:111], v[92:95]
  ds_read_b64_tr_b16 a[214:215], v17 offset:22528
  s_waitcnt lgkmcnt(12)
  v_mfma_f32_16x16x32_bf16 v[96:99], a[224:227], a[104:107], v[96:99]
  ds_read_b64_tr_b16 a[216:217], v18 offset:18432
  v_mfma_f32_16x16x32_bf16 v[100:103], a[224:227], a[108:111], v[100:103]
  ds_read_b64_tr_b16 a[218:219], v18 offset:22528
  buffer_load_dwordx4 a[68:71], v5, s[28:31], s46 offen offset:0 sc1
  s_waitcnt lgkmcnt(12)
  v_mfma_f32_16x16x32_bf16 v[32:35], a[192:195], a[112:115], v[32:35]
  ds_read_b64_tr_b16 a[220:221], v19 offset:18432
  v_mfma_f32_16x16x32_bf16 v[36:39], a[192:195], a[116:119], v[36:39]
  ds_read_b64_tr_b16 a[222:223], v19 offset:22528
  buffer_load_dwordx4 a[72:75], v4, s[28:31], s46 offen offset:1024 sc1
  s_waitcnt lgkmcnt(12)
  v_mfma_f32_16x16x32_bf16 v[40:43], a[196:199], a[112:115], v[40:43]
  ds_read_b64_tr_b16 a[224:225], v20 offset:18432
  v_mfma_f32_16x16x32_bf16 v[44:47], a[196:199], a[116:119], v[44:47]
  ds_read_b64_tr_b16 a[226:227], v20 offset:18944
  s_waitcnt lgkmcnt(12)
  v_mfma_f32_16x16x32_bf16 v[48:51], a[200:203], a[112:115], v[48:51]
  ds_read_b64_tr_b16 a[192:193], v12 offset:26624
  v_mfma_f32_16x16x32_bf16 v[52:55], a[200:203], a[116:119], v[52:55]
  ds_read_b64_tr_b16 a[194:195], v12 offset:30720
  v_add_u32 v12, s49, v12
  buffer_load_dwordx4 a[76:79], v5, s[28:31], s46 offen offset:1024 sc1
  s_waitcnt lgkmcnt(12)
  v_mfma_f32_16x16x32_bf16 v[56:59], a[204:207], a[112:115], v[56:59]
  ds_read_b64_tr_b16 a[196:197], v13 offset:26624
  v_mfma_f32_16x16x32_bf16 v[60:63], a[204:207], a[116:119], v[60:63]
  ds_read_b64_tr_b16 a[198:199], v13 offset:30720
  v_add_u32 v13, s49, v13
  s_waitcnt lgkmcnt(12)
  v_mfma_f32_16x16x32_bf16 v[64:67], a[208:211], a[112:115], v[64:67]
  ds_read_b64_tr_b16 a[200:201], v14 offset:26624
  v_mfma_f32_16x16x32_bf16 v[68:71], a[208:211], a[116:119], v[68:71]
  ds_read_b64_tr_b16 a[202:203], v14 offset:30720
  v_add_u32 v14, s49, v14
  buffer_load_dwordx4 a[80:83], v4, s[28:31], s46 offen offset:2048 sc1
  s_waitcnt lgkmcnt(12)
  v_mfma_f32_16x16x32_bf16 v[72:75], a[212:215], a[112:115], v[72:75]
  ds_read_b64_tr_b16 a[204:205], v15 offset:26624
  v_mfma_f32_16x16x32_bf16 v[76:79], a[212:215], a[116:119], v[76:79]
  ds_read_b64_tr_b16 a[206:207], v15 offset:30720
  v_add_u32 v15, s49, v15
  buffer_load_dwordx4 a[84:87], v5, s[28:31], s46 offen offset:2048 sc1
  s_waitcnt lgkmcnt(12)
  v_mfma_f32_16x16x32_bf16 v[80:83], a[216:219], a[112:115], v[80:83]
  ds_read_b64_tr_b16 a[208:209], v16 offset:26624
  v_mfma_f32_16x16x32_bf16 v[84:87], a[216:219], a[116:119], v[84:87]
  ds_read_b64_tr_b16 a[210:211], v16 offset:30720
  v_add_u32 v16, s49, v16
  s_waitcnt lgkmcnt(12)
  v_mfma_f32_16x16x32_bf16 v[88:91], a[220:223], a[112:115], v[88:91]
  ds_read_b64_tr_b16 a[212:213], v17 offset:26624
  v_mfma_f32_16x16x32_bf16 v[92:95], a[220:223], a[116:119], v[92:95]
  ds_read_b64_tr_b16 a[214:215], v17 offset:30720
  v_add_u32 v17, s49, v17
  buffer_load_dwordx4 a[88:91], v4, s[28:31], s46 offen offset:3072 sc1
  s_waitcnt lgkmcnt(12)
  v_mfma_f32_16x16x32_bf16 v[96:99], a[224:227], a[112:115], v[96:99]
  ds_read_b64_tr_b16 a[216:217], v18 offset:26624
  v_mfma_f32_16x16x32_bf16 v[100:103], a[224:227], a[116:119], v[100:103]
  ds_read_b64_tr_b16 a[218:219], v18 offset:30720
  v_add_u32 v18, s49, v18
  s_waitcnt lgkmcnt(12)
  v_mfma_f32_16x16x32_bf16 v[32:35], a[192:195], a[120:123], v[32:35]
  ds_read_b64_tr_b16 a[220:221], v19 offset:26624
  v_mfma_f32_16x16x32_bf16 v[36:39], a[192:195], a[124:127], v[36:39]
  ds_read_b64_tr_b16 a[222:223], v19 offset:30720
  v_add_u32 v19, s49, v19
  buffer_load_dwordx4 a[92:95], v5, s[28:31], s46 offen offset:3072 sc1
  s_add_u32 s46, s46, 4096
  s_waitcnt lgkmcnt(12)
  v_mfma_f32_16x16x32_bf16 v[40:43], a[196:199], a[120:123], v[40:43]
  ds_read_b64_tr_b16 a[224:225], v20 offset:19456
  v_mfma_f32_16x16x32_bf16 v[44:47], a[196:199], a[124:127], v[44:47]
  ds_read_b64_tr_b16 a[226:227], v20 offset:19968
  v_add_u32 v20, s49, v20
  s_waitcnt vmcnt(25)
  s_barrier
  s_waitcnt lgkmcnt(12)
  v_mfma_f32_16x16x32_bf16 v[48:51], a[200:203], a[120:123], v[48:51]
  ds_read_b64_tr_b16 a[192:193], v12 offset:0
  v_mfma_f32_16x16x32_bf16 v[52:55], a[200:203], a[124:127], v[52:55]
  ds_read_b64_tr_b16 a[194:195], v12 offset:4096
  s_waitcnt lgkmcnt(12)
  v_mfma_f32_16x16x32_bf16 v[56:59], a[204:207], a[120:123], v[56:59]
  ds_read_b64_tr_b16 a[196:197], v13 offset:0
  v_mfma_f32_16x16x32_bf16 v[60:63], a[204:207], a[124:127], v[60:63]
  ds_read_b64_tr_b16 a[198:199], v13 offset:4096
  s_waitcnt lgkmcnt(12)
  v_mfma_f32_16x16x32_bf16 v[64:67], a[208:211], a[120:123], v[64:67]
  ds_read_b64_tr_b16 a[200:201], v14 offset:0
  v_mfma_f32_16x16x32_bf16 v[68:71], a[208:211], a[124:127], v[68:71]
  ds_read_b64_tr_b16 a[202:203], v14 offset:4096
  s_waitcnt lgkmcnt(12)
  v_mfma_f32_16x16x32_bf16 v[72:75], a[212:215], a[120:123], v[72:75]
  ds_read_b64_tr_b16 a[204:205], v15 offset:0
  v_mfma_f32_16x16x32_bf16 v[76:79], a[212:215], a[124:127], v[76:79]
  ds_read_b64_tr_b16 a[206:207], v15 offset:4096
  s_waitcnt lgkmcnt(12)
  v_mfma_f32_16x16x32_bf16 v[80:83], a[216:219], a[120:123], v[80:83]
  ds_read_b64_tr_b16 a[208:209], v16 offset:0
  v_mfma_f32_16x16x32_bf16 v[84:87], a[216:219], a[124:127], v[84:87]
  ds_read_b64_tr_b16 a[210:211], v16 offset:4096
  s_waitcnt lgkmcnt(12)
  v_mfma_f32_16x16x32_bf16 v[88:91], a[220:223], a[120:123], v[88:91]
  ds_read_b64_tr_b16 a[212:213], v17 offset:0
  v_mfma_f32_16x16x32_bf16 v[92:95], a[220:223], a[124:127], v[92:95]
  ds_read_b64_tr_b16 a[214:215], v17 offset:4096
  s_waitcnt lgkmcnt(12)
  v_mfma_f32_16x16x32_bf16 v[96:99], a[224:227], a[120:123], v[96:99]
  ds_read_b64_tr_b16 a[216:217], v18 offset:0
  v_mfma_f32_16x16x32_bf16 v[100:103], a[224:227], a[124:127], v[100:103]
  ds_read_b64_tr_b16 a[218:219], v18 offset:4096
  s_add_u32 s51, s51, 1
  s_branch mega_kernel_loop255
mega_kernel_super256:
  s_lshl_b32 s67, s63, 2
  s_add_u32 s67, s67, s53
  s_add_u32 s56, s10, 7864320
  s_addc_u32 s57, s11, 0
  s_mov_b32 s58, 2359296
  s_mov_b32 s59, 0x00020000
  s_add_u32 s24, s10, 13123584
  s_addc_u32 s25, s11, 0
  s_mov_b32 s26, 2304
  s_mov_b32 s27, 0x00020000
  v_and_b32 v4, 15, v1
  v_lshrrev_b32 v5, 4, v1
  v_mul_u32_u24 v4, 1152, v4
  v_lshl_add_u32 v4, v5, 3, v4
  v_lshlrev_b32 v5, 4, v5
  s_lshl_b32 s36, s67, 2
  s_add_u32 s36, s36, s62
  s_mul_i32 s36, s36, 51200
  v_lshl_add_u32 v6, v1, 4, s36
  s_add_u32 s36, s36, 10240
  v_lshl_add_u32 v7, v1, 2, s36
  s_add_u32 s44, s62, 1
  s_and_b32 s44, s44, 3
  s_mul_i32 s44, s44, 12800
  s_add_u32 s45, s62, 2
  s_and_b32 s45, s45, 3
  s_mul_i32 s45, s45, 12800
  s_add_u32 s46, s62, 3
  s_and_b32 s46, s46, 3
  s_mul_i32 s46, s46, 12800
  s_add_u32 s36, s18, 0
  s_cmp_ge_u32 s36, 5
  s_cselect_b32 s37, 1, 0
  s_cselect_b32 s38, 5, 0
  s_sub_u32 s38, s36, s38
  s_lshl_b32 s39, s53, 3
  s_lshl_b32 s41, s38, 1
  s_add_u32 s39, s39, s41
  s_add_u32 s41, s53, 32
  s_cmp_eq_u32 s38, 4
  s_cselect_b32 s39, s41, s39
  s_cselect_b32 s41, 0x7fffff00, 32
  s_lshl_b32 s42, s63, 3
  s_add_u32 s37, s37, s42
  s_lshl_b32 s42, s62, 1
  s_add_u32 s37, s37, s42
  s_mul_i32 s37, s37, 18432
  s_lshl_b32 s42, s39, 5
  s_add_u32 s48, s37, s42
  s_add_u32 s49, s48, s41
  s_lshl_b32 s50, s39, 6
  s_cmp_ge_u32 s36, 10
  s_cselect_b32 s48, 0x7fffff00, s48
  s_cselect_b32 s49, 0x7fffff00, s49
  s_add_u32 s36, s18, 4
  s_cmp_ge_u32 s36, 5
  s_cselect_b32 s37, 1, 0
  s_cselect_b32 s38, 5, 0
  s_sub_u32 s38, s36, s38
  s_lshl_b32 s39, s53, 3
  s_lshl_b32 s41, s38, 1
  s_add_u32 s39, s39, s41
  s_add_u32 s41, s53, 32
  s_cmp_eq_u32 s38, 4
  s_cselect_b32 s39, s41, s39
  s_cselect_b32 s41, 0x7fffff00, 32
  s_lshl_b32 s42, s63, 3
  s_add_u32 s37, s37, s42
  s_lshl_b32 s42, s62, 1
  s_add_u32 s37, s37, s42
  s_mul_i32 s37, s37, 18432
  s_lshl_b32 s42, s39, 5
  s_add_u32 s51, s37, s42
  s_add_u32 s52, s51, s41
  s_lshl_b32 s54, s39, 6
  s_cmp_ge_u32 s36, 10
  s_cselect_b32 s51, 0x7fffff00, s51
  s_cselect_b32 s52, 0x7fffff00, s52
  s_add_u32 s36, s18, 8
  s_cmp_ge_u32 s36, 5
  s_cselect_b32 s37, 1, 0
  s_cselect_b32 s38, 5, 0
  s_sub_u32 s38, s36, s38
  s_lshl_b32 s39, s53, 3
  s_lshl_b32 s41, s38, 1
  s_add_u32 s39, s39, s41
  s_add_u32 s41, s53, 32
  s_cmp_eq_u32 s38, 4
  s_cselect_b32 s39, s41, s39
  s_cselect_b32 s41, 0x7fffff00, 32
  s_lshl_b32 s42, s63, 3
  s_add_u32 s37, s37, s42
  s_lshl_b32 s42, s62, 1
  s_add_u32 s37, s37, s42
  s_mul_i32 s37, s37, 18432
  s_lshl_b32 s42, s39, 5
  s_add_u32 s14, s37, s42
  s_add_u32 s15, s14, s41
  s_lshl_b32 s47, s39, 6
  s_cmp_ge_u32 s36, 10
  s_cselect_b32 s14, 0x7fffff00, s14
  s_cselect_b32 s15, 0x7fffff00, s15
  s_lshl_b32 s37, s63, 2
  s_add_u32 s37, s37, s62
  s_lshl_b32 s37, s37, 4
  s_add_u32 s37, s37, 7168
  v_and_b32 v2, 3, v1
  v_lshl_add_u32 v2, v2, 2, s37
  s_waitcnt vmcnt(8) lgkmcnt(0)
  s_barrier
  s_add_u32 s32, s10, 33554432
  s_addc_u32 s33, s11, 0
  s_mov_b32 s34, 13107200
  s_mov_b32 s35, 0x00020000
  global_load_dword v23, v2, s[12:13] sc1
  s_lshl_b32 s36, s67, 2
  s_add_u32 s36, s36, s18
  s_lshl_b32 s36, s36, 2
  s_add_u32 s36, s36, s62
  s_mul_i32 s36, s36, 12800
  v_lshl_add_u32 v24, v1, 4, s36
  v_add_u32 v25, 5120, v24
  s_add_u32 s36, s36, 10240
  v_lshl_add_u32 v26, v1, 2, s36
  v_lshlrev_b32 v21, 4, v1
  s_mov_b32 s37, 73728
  s_cmp_eq_u32 s18, s62
  s_cselect_b32 s36, 110592, s37
  s_cselect_b32 s34, 0, s34
  v_add_u32 v22, s36, v21
  v_add_u32 v21, 110592, v21
  s_movk_i32 s38, 4096
  ds_read_b64_tr_b16 a[192:193], v12 offset:0
  ds_read_b64_tr_b16 a[194:195], v12 offset:4096
  ds_read_b64_tr_b16 a[196:197], v12 offset:8192
  ds_read_b64_tr_b16 a[198:199], v12 offset:12288
  ds_read_b64_tr_b16 a[200:201], v12 offset:18432
  ds_read_b64_tr_b16 a[202:203], v12 offset:22528
  ds_read_b64_tr_b16 a[204:205], v12 offset:26624
  ds_read_b64_tr_b16 a[206:207], v12 offset:30720
  v_add_u32 v11, 0x9000, v12
  ds_read_b64_tr_b16 a[208:209], v11 offset:0
  ds_read_b64_tr_b16 a[210:211], v11 offset:4096
  ds_read_b64_tr_b16 a[212:213], v11 offset:8192
  ds_read_b64_tr_b16 a[214:215], v11 offset:12288
  ds_read_b64_tr_b16 a[216:217], v11 offset:18432
  ds_read_b64_tr_b16 a[218:219], v11 offset:22528
  s_waitcnt lgkmcnt(12)
  v_mfma_f32_16x16x32_bf16 v[32:35], a[192:195], a[96:99], v[32:35]
  ds_read_b64_tr_b16 a[220:221], v11 offset:26624
  v_mfma_f32_16x16x32_bf16 v[36:39], a[192:195], a[100:103], v[36:39]
  ds_read_b64_tr_b16 a[222:223], v11 offset:30720
  s_waitcnt lgkmcnt(12)
  v_mfma_f32_16x16x32_bf16 v[32:35], a[196:199], a[104:107], v[32:35]
  ds_read_b64_tr_b16 a[224:225], v13 offset:0
  v_mfma_f32_16x16x32_bf16 v[36:39], a[196:199], a[108:111], v[36:39]
  ds_read_b64_tr_b16 a[226:227], v13 offset:4096
  s_waitcnt lgkmcnt(12)
  v_mfma_f32_16x16x32_bf16 v[32:35], a[200:203], a[112:115], v[32:35]
  ds_read_b64_tr_b16 a[192:193], v13 offset:8192
  v_mfma_f32_16x16x32_bf16 v[36:39], a[200:203], a[116:119], v[36:39]
  ds_read_b64_tr_b16 a[194:195], v13 offset:12288
  s_waitcnt lgkmcnt(12)
  v_mfma_f32_16x16x32_bf16 v[32:35], a[204:207], a[120:123], v[32:35]
  ds_read_b64_tr_b16 a[196:197], v13 offset:18432
  v_mfma_f32_16x16x32_bf16 v[36:39], a[204:207], a[124:127], v[36:39]
  ds_read_b64_tr_b16 a[198:199], v13 offset:22528
  s_waitcnt lgkmcnt(12)
  v_mfma_f32_16x16x32_bf16 v[32:35], a[208:211], a[0:3], v[32:35]
  ds_read_b64_tr_b16 a[200:201], v13 offset:26624
  v_mfma_f32_16x16x32_bf16 v[36:39], a[208:211], a[4:7], v[36:39]
  ds_read_b64_tr_b16 a[202:203], v13 offset:30720
  s_waitcnt lgkmcnt(12)
  v_mfma_f32_16x16x32_bf16 v[32:35], a[212:215], a[8:11], v[32:35]
  v_add_u32 v0, 0x9000, v13
  ds_read_b64_tr_b16 a[204:205], v0 offset:0
  v_mfma_f32_16x16x32_bf16 v[36:39], a[212:215], a[12:15], v[36:39]
  ds_read_b64_tr_b16 a[206:207], v0 offset:4096
  s_waitcnt lgkmcnt(12)
  v_mfma_f32_16x16x32_bf16 v[32:35], a[216:219], a[16:19], v[32:35]
  ds_read_b64_tr_b16 a[208:209], v0 offset:8192
  v_mfma_f32_16x16x32_bf16 v[36:39], a[216:219], a[20:23], v[36:39]
  ds_read_b64_tr_b16 a[210:211], v0 offset:12288
  s_waitcnt lgkmcnt(12)
  v_mfma_f32_16x16x32_bf16 v[32:35], a[220:223], a[24:27], v[32:35]
  ds_read_b64_tr_b16 a[212:213], v0 offset:18432
  v_mfma_f32_16x16x32_bf16 v[36:39], a[220:223], a[28:31], v[36:39]
  ds_read_b64_tr_b16 a[214:215], v0 offset:22528
  s_waitcnt lgkmcnt(12)
  v_mfma_f32_16x16x32_bf16 v[40:43], a[224:227], a[96:99], v[40:43]
  ds_read_b64_tr_b16 a[216:217], v0 offset:26624
  v_mfma_f32_16x16x32_bf16 v[44:47], a[224:227], a[100:103], v[44:47]
  ds_read_b64_tr_b16 a[218:219], v0 offset:30720
  s_waitcnt lgkmcnt(12)
  v_mfma_f32_16x16x32_bf16 v[40:43], a[192:195], a[104:107], v[40:43]
  ds_read_b64_tr_b16 a[220:221], v14 offset:0
  v_mfma_f32_16x16x32_bf16 v[44:47], a[192:195], a[108:111], v[44:47]
  ds_read_b64_tr_b16 a[222:223], v14 offset:4096
  s_waitcnt lgkmcnt(12)
  v_mfma_f32_16x16x32_bf16 v[40:43], a[196:199], a[112:115], v[40:43]
  ds_read_b64_tr_b16 a[224:225], v14 offset:8192
  v_mfma_f32_16x16x32_bf16 v[44:47], a[196:199], a[116:119], v[44:47]
  ds_read_b64_tr_b16 a[226:227], v14 offset:12288
  s_waitcnt lgkmcnt(12)
  v_mfma_f32_16x16x32_bf16 v[40:43], a[200:203], a[120:123], v[40:43]
  ds_read_b64_tr_b16 a[192:193], v14 offset:18432
  v_mfma_f32_16x16x32_bf16 v[44:47], a[200:203], a[124:127], v[44:47]
  ds_read_b64_tr_b16 a[194:195], v14 offset:22528
  s_waitcnt lgkmcnt(12)
  v_mfma_f32_16x16x32_bf16 v[40:43], a[204:207], a[0:3], v[40:43]
  ds_read_b64_tr_b16 a[196:197], v14 offset:26624
  v_mfma_f32_16x16x32_bf16 v[44:47], a[204:207], a[4:7], v[44:47]
  ds_read_b64_tr_b16 a[198:199], v14 offset:30720
  s_waitcnt lgkmcnt(12)
  v_mfma_f32_16x16x32_bf16 v[40:43], a[208:211], a[8:11], v[40:43]
  v_add_u32 v11, 0x9000, v14
  ds_read_b64_tr_b16 a[200:201], v11 offset:0
  v_mfma_f32_16x16x32_bf16 v[44:47], a[208:211], a[12:15], v[44:47]
  ds_read_b64_tr_b16 a[202:203], v11 offset:4096
  s_waitcnt lgkmcnt(12)
  v_mfma_f32_16x16x32_bf16 v[40:43], a[212:215], a[16:19], v[40:43]
  ds_read_b64_tr_b16 a[204:205], v11 offset:8192
  v_mfma_f32_16x16x32_bf16 v[44:47], a[212:215], a[20:23], v[44:47]
  ds_read_b64_tr_b16 a[206:207], v11 offset:12288
  s_waitcnt lgkmcnt(12)
  v_mfma_f32_16x16x32_bf16 v[40:43], a[216:219], a[24:27], v[40:43]
  ds_read_b64_tr_b16 a[208:209], v11 offset:18432
  v_mfma_f32_16x16x32_bf16 v[44:47], a[216:219], a[28:31], v[44:47]
  ds_read_b64_tr_b16 a[210:211], v11 offset:22528
  s_waitcnt lgkmcnt(12)
  v_mfma_f32_16x16x32_bf16 v[48:51], a[220:223], a[96:99], v[48:51]
  ds_read_b64_tr_b16 a[212:213], v11 offset:26624
  v_mfma_f32_16x16x32_bf16 v[52:55], a[220:223], a[100:103], v[52:55]
  ds_read_b64_tr_b16 a[214:215], v11 offset:30720
  s_waitcnt lgkmcnt(12)
  v_mfma_f32_16x16x32_bf16 v[48:51], a[224:227], a[104:107], v[48:51]
  ds_read_b64_tr_b16 a[216:217], v15 offset:0
  v_mfma_f32_16x16x32_bf16 v[52:55], a[224:227], a[108:111], v[52:55]
  ds_read_b64_tr_b16 a[218:219], v15 offset:4096
  s_waitcnt lgkmcnt(12)
  v_mfma_f32_16x16x32_bf16 v[48:51], a[192:195], a[112:115], v[48:51]
  ds_read_b64_tr_b16 a[220:221], v15 offset:8192
  v_mfma_f32_16x16x32_bf16 v[52:55], a[192:195], a[116:119], v[52:55]
  ds_read_b64_tr_b16 a[222:223], v15 offset:12288
  s_waitcnt lgkmcnt(12)
  v_mfma_f32_16x16x32_bf16 v[48:51], a[196:199], a[120:123], v[48:51]
  ds_read_b64_tr_b16 a[224:225], v15 offset:18432
  ds_write_b128 v22, v[32:35] offset:0
  ds_write_b128 v22, v[40:43] offset:1024
  v_max3_f32 v27, |v32|, |v33|, |v34|
  v_mfma_f32_16x16x32_bf16 v[52:55], a[196:199], a[124:127], v[52:55]
  ds_read_b64_tr_b16 a[226:227], v15 offset:22528
  v_max_f32 v27, |v35|, v27
  v_max3_f32 v27, |v40|, |v41|, v27
  v_max3_f32 v27, |v42|, |v43|, v27
  s_waitcnt lgkmcnt(12)
  v_mfma_f32_16x16x32_bf16 v[48:51], a[200:203], a[0:3], v[48:51]
  ds_read_b64_tr_b16 a[192:193], v15 offset:26624
  v_frexp_exp_i32_f32 v27, v27
  v_max_i32 v27, 0xffffff9c, v27
  v_sub_u32 v160, 15, v27
  v_mfma_f32_16x16x32_bf16 v[52:55], a[200:203], a[4:7], v[52:55]
  ds_read_b64_tr_b16 a[194:195], v15 offset:30720
  v_add_u32 v161, -15, v27
  v_ldexp_f32 v160, 1.0, v160
  v_ldexp_f32 v161, 1.0, v161
  s_waitcnt lgkmcnt(12)
  v_mfma_f32_16x16x32_bf16 v[48:51], a[204:207], a[8:11], v[48:51]
  v_add_u32 v0, 0x9000, v15
  ds_read_b64_tr_b16 a[196:197], v0 offset:0
  buffer_store_dword v161, v26, s[32:35], 0 offen offset:0 sc1
  v_mul_f32 v28, v32, v160
  v_mul_f32 v29, v33, v160
  v_mfma_f32_16x16x32_bf16 v[52:55], a[204:207], a[12:15], v[52:55]
  ds_read_b64_tr_b16 a[198:199], v0 offset:4096
  v_mul_f32 v30, v34, v160
  v_mul_f32 v31, v35, v160
  v_cvt_pk_f16_f32 v120, v28, v29
  s_waitcnt lgkmcnt(12)
  v_mfma_f32_16x16x32_bf16 v[48:51], a[208:211], a[16:19], v[48:51]
  ds_read_b64_tr_b16 a[200:201], v0 offset:8192
  v_cvt_pk_f16_f32 v121, v30, v31
  v_mul_f32 v28, v40, v160
  v_mul_f32 v29, v41, v160
  v_mfma_f32_16x16x32_bf16 v[52:55], a[208:211], a[20:23], v[52:55]
  ds_read_b64_tr_b16 a[202:203], v0 offset:12288
  v_mul_f32 v30, v42, v160
  v_mul_f32 v31, v43, v160
  v_cvt_pk_f16_f32 v122, v28, v29
  s_waitcnt lgkmcnt(12)
  v_mfma_f32_16x16x32_bf16 v[48:51], a[212:215], a[24:27], v[48:51]
  ds_read_b64_tr_b16 a[204:205], v0 offset:18432
  v_cvt_pk_f16_f32 v123, v30, v31
  buffer_store_dwordx4 v[120:123], v24, s[32:35], 0 offen offset:0 sc1
  ds_write_b128 v22, v[36:39] offset:10240
  v_mfma_f32_16x16x32_bf16 v[52:55], a[212:215], a[28:31], v[52:55]
  ds_read_b64_tr_b16 a[206:207], v0 offset:22528
  ds_write_b128 v22, v[44:47] offset:11264
  v_max3_f32 v27, |v36|, |v37|, |v38|
  v_max_f32 v27, |v39|, v27
  s_waitcnt lgkmcnt(12)
  v_mfma_f32_16x16x32_bf16 v[56:59], a[216:219], a[96:99], v[56:59]
  ds_read_b64_tr_b16 a[208:209], v0 offset:26624
  v_max3_f32 v27, |v44|, |v45|, v27
  v_max3_f32 v27, |v46|, |v47|, v27
  v_frexp_exp_i32_f32 v27, v27
  v_mfma_f32_16x16x32_bf16 v[60:63], a[216:219], a[100:103], v[60:63]
  ds_read_b64_tr_b16 a[210:211], v0 offset:30720
  v_max_i32 v27, 0xffffff9c, v27
  v_sub_u32 v162, 15, v27
  v_add_u32 v163, -15, v27
  s_waitcnt lgkmcnt(12)
  v_mfma_f32_16x16x32_bf16 v[56:59], a[220:223], a[104:107], v[56:59]
  ds_read_b64_tr_b16 a[212:213], v16 offset:0
  v_ldexp_f32 v162, 1.0, v162
  v_ldexp_f32 v163, 1.0, v163
  buffer_store_dword v163, v26, s[32:35], 0 offen offset:1280 sc1
  v_mfma_f32_16x16x32_bf16 v[60:63], a[220:223], a[108:111], v[60:63]
  ds_read_b64_tr_b16 a[214:215], v16 offset:4096
  v_mul_f32 v28, v36, v162
  v_mul_f32 v29, v37, v162
  v_mul_f32 v30, v38, v162
  s_waitcnt lgkmcnt(12)
  v_mfma_f32_16x16x32_bf16 v[56:59], a[224:227], a[112:115], v[56:59]
  ds_read_b64_tr_b16 a[216:217], v16 offset:8192
  v_mul_f32 v31, v39, v162
  v_cvt_pk_f16_f32 v140, v28, v29
  v_cvt_pk_f16_f32 v141, v30, v31
  v_mfma_f32_16x16x32_bf16 v[60:63], a[224:227], a[116:119], v[60:63]
  ds_read_b64_tr_b16 a[218:219], v16 offset:12288
  v_mul_f32 v28, v44, v162
  v_mul_f32 v29, v45, v162
  v_mul_f32 v30, v46, v162
  s_waitcnt lgkmcnt(12)
  v_mfma_f32_16x16x32_bf16 v[56:59], a[192:195], a[120:123], v[56:59]
  ds_read_b64_tr_b16 a[220:221], v16 offset:18432
  v_mul_f32 v31, v47, v162
  v_cvt_pk_f16_f32 v142, v28, v29
  v_cvt_pk_f16_f32 v143, v30, v31
  v_mfma_f32_16x16x32_bf16 v[60:63], a[192:195], a[124:127], v[60:63]
  ds_read_b64_tr_b16 a[222:223], v16 offset:22528
  buffer_store_dwordx4 v[140:143], v25, s[32:35], 0 offen offset:0 sc1
  s_waitcnt lgkmcnt(12)
  v_mfma_f32_16x16x32_bf16 v[56:59], a[196:199], a[0:3], v[56:59]
  ds_read_b64_tr_b16 a[224:225], v16 offset:26624
  v_mfma_f32_16x16x32_bf16 v[60:63], a[196:199], a[4:7], v[60:63]
  ds_read_b64_tr_b16 a[226:227], v16 offset:30720
  s_waitcnt lgkmcnt(12)
  v_mfma_f32_16x16x32_bf16 v[56:59], a[200:203], a[8:11], v[56:59]
  v_add_u32 v11, 0x9000, v16
  ds_read_b64_tr_b16 a[192:193], v11 offset:0
  v_mfma_f32_16x16x32_bf16 v[60:63], a[200:203], a[12:15], v[60:63]
  ds_read_b64_tr_b16 a[194:195], v11 offset:4096
  s_waitcnt lgkmcnt(12)
  v_mfma_f32_16x16x32_bf16 v[56:59], a[204:207], a[16:19], v[56:59]
  ds_read_b64_tr_b16 a[196:197], v11 offset:8192
  v_mfma_f32_16x16x32_bf16 v[60:63], a[204:207], a[20:23], v[60:63]
  ds_read_b64_tr_b16 a[198:199], v11 offset:12288
  s_waitcnt lgkmcnt(12)
  v_mfma_f32_16x16x32_bf16 v[56:59], a[208:211], a[24:27], v[56:59]
  ds_read_b64_tr_b16 a[200:201], v11 offset:18432
  v_mfma_f32_16x16x32_bf16 v[60:63], a[208:211], a[28:31], v[60:63]
  ds_read_b64_tr_b16 a[202:203], v11 offset:22528
  s_waitcnt lgkmcnt(12)
  v_mfma_f32_16x16x32_bf16 v[64:67], a[212:215], a[96:99], v[64:67]
  ds_read_b64_tr_b16 a[204:205], v11 offset:26624
  v_mfma_f32_16x16x32_bf16 v[68:71], a[212:215], a[100:103], v[68:71]
  ds_read_b64_tr_b16 a[206:207], v11 offset:30720
  s_waitcnt lgkmcnt(12)
  v_mfma_f32_16x16x32_bf16 v[64:67], a[216:219], a[104:107], v[64:67]
  ds_read_b64_tr_b16 a[208:209], v17 offset:0
  v_mfma_f32_16x16x32_bf16 v[68:71], a[216:219], a[108:111], v[68:71]
  ds_read_b64_tr_b16 a[210:211], v17 offset:4096
  s_waitcnt lgkmcnt(12)
  v_mfma_f32_16x16x32_bf16 v[64:67], a[220:223], a[112:115], v[64:67]
  ds_read_b64_tr_b16 a[212:213], v17 offset:8192
  v_mfma_f32_16x16x32_bf16 v[68:71], a[220:223], a[116:119], v[68:71]
  ds_read_b64_tr_b16 a[214:215], v17 offset:12288
  s_waitcnt lgkmcnt(12)
  v_mfma_f32_16x16x32_bf16 v[64:67], a[224:227], a[120:123], v[64:67]
  ds_read_b64_tr_b16 a[216:217], v17 offset:18432
  ds_write_b128 v22, v[48:51] offset:2048
  ds_write_b128 v22, v[56:59] offset:3072
  v_max3_f32 v27, |v48|, |v49|, |v50|
  v_mfma_f32_16x16x32_bf16 v[68:71], a[224:227], a[124:127], v[68:71]
  ds_read_b64_tr_b16 a[218:219], v17 offset:22528
  v_max_f32 v27, |v51|, v27
  v_max3_f32 v27, |v56|, |v57|, v27
  v_max3_f32 v27, |v58|, |v59|, v27
  s_waitcnt lgkmcnt(12)
  v_mfma_f32_16x16x32_bf16 v[64:67], a[192:195], a[0:3], v[64:67]
  ds_read_b64_tr_b16 a[220:221], v17 offset:26624
  v_frexp_exp_i32_f32 v27, v27
  v_max_i32 v27, 0xffffff9c, v27
  v_sub_u32 v162, 15, v27
  v_mfma_f32_16x16x32_bf16 v[68:71], a[192:195], a[4:7], v[68:71]
  ds_read_b64_tr_b16 a[222:223], v17 offset:30720
  v_add_u32 v163, -15, v27
  v_ldexp_f32 v162, 1.0, v162
  v_ldexp_f32 v163, 1.0, v163
  s_waitcnt lgkmcnt(12)
  v_mfma_f32_16x16x32_bf16 v[64:67], a[196:199], a[8:11], v[64:67]
  v_add_u32 v0, 0x9000, v17
  ds_read_b64_tr_b16 a[224:225], v0 offset:0
  buffer_store_dword v163, v26, s[32:35], 0 offen offset:256 sc1
  v_mul_f32 v28, v48, v162
  v_mul_f32 v29, v49, v162
  v_mfma_f32_16x16x32_bf16 v[68:71], a[196:199], a[12:15], v[68:71]
  ds_read_b64_tr_b16 a[226:227], v0 offset:4096
  v_mul_f32 v30, v50, v162
  v_mul_f32 v31, v51, v162
  v_cvt_pk_f16_f32 v124, v28, v29
  s_waitcnt lgkmcnt(12)
  v_mfma_f32_16x16x32_bf16 v[64:67], a[200:203], a[16:19], v[64:67]
  ds_read_b64_tr_b16 a[192:193], v0 offset:8192
  v_cvt_pk_f16_f32 v125, v30, v31
  v_mul_f32 v28, v56, v162
  v_mul_f32 v29, v57, v162
  v_mfma_f32_16x16x32_bf16 v[68:71], a[200:203], a[20:23], v[68:71]
  ds_read_b64_tr_b16 a[194:195], v0 offset:12288
  v_mul_f32 v30, v58, v162
  v_mul_f32 v31, v59, v162
  v_cvt_pk_f16_f32 v126, v28, v29
  s_waitcnt lgkmcnt(12)
  v_mfma_f32_16x16x32_bf16 v[64:67], a[204:207], a[24:27], v[64:67]
  ds_read_b64_tr_b16 a[196:197], v0 offset:18432
  v_cvt_pk_f16_f32 v127, v30, v31
  buffer_store_dwordx4 v[124:127], v24, s[32:35], 0 offen offset:1024 sc1
  ds_write_b128 v22, v[52:55] offset:12288
  v_mfma_f32_16x16x32_bf16 v[68:71], a[204:207], a[28:31], v[68:71]
  ds_read_b64_tr_b16 a[198:199], v0 offset:22528
  ds_write_b128 v22, v[60:63] offset:13312
  v_max3_f32 v27, |v52|, |v53|, |v54|
  v_max_f32 v27, |v55|, v27
  s_waitcnt lgkmcnt(12)
  v_mfma_f32_16x16x32_bf16 v[72:75], a[208:211], a[96:99], v[72:75]
  ds_read_b64_tr_b16 a[200:201], v0 offset:26624
  v_max3_f32 v27, |v60|, |v61|, v27
  v_max3_f32 v27, |v62|, |v63|, v27
  v_frexp_exp_i32_f32 v27, v27
  v_mfma_f32_16x16x32_bf16 v[76:79], a[208:211], a[100:103], v[76:79]
  ds_read_b64_tr_b16 a[202:203], v0 offset:30720
  v_max_i32 v27, 0xffffff9c, v27
  v_sub_u32 v164, 15, v27
  v_add_u32 v165, -15, v27
  s_waitcnt lgkmcnt(12)
  v_mfma_f32_16x16x32_bf16 v[72:75], a[212:215], a[104:107], v[72:75]
  ds_read_b64_tr_b16 a[204:205], v18 offset:0
  v_ldexp_f32 v164, 1.0, v164
  v_ldexp_f32 v165, 1.0, v165
  buffer_store_dword v165, v26, s[32:35], 0 offen offset:1536 sc1
  v_mfma_f32_16x16x32_bf16 v[76:79], a[212:215], a[108:111], v[76:79]
  ds_read_b64_tr_b16 a[206:207], v18 offset:4096
  v_mul_f32 v28, v52, v164
  v_mul_f32 v29, v53, v164
  v_mul_f32 v30, v54, v164
  s_waitcnt lgkmcnt(12)
  v_mfma_f32_16x16x32_bf16 v[72:75], a[216:219], a[112:115], v[72:75]
  ds_read_b64_tr_b16 a[208:209], v18 offset:8192
  v_mul_f32 v31, v55, v164
  v_cvt_pk_f16_f32 v144, v28, v29
  v_cvt_pk_f16_f32 v145, v30, v31
  v_mfma_f32_16x16x32_bf16 v[76:79], a[216:219], a[116:119], v[76:79]
  ds_read_b64_tr_b16 a[210:211], v18 offset:12288
  v_mul_f32 v28, v60, v164
  v_mul_f32 v29, v61, v164
  v_mul_f32 v30, v62, v164
  s_waitcnt lgkmcnt(12)
  v_mfma_f32_16x16x32_bf16 v[72:75], a[220:223], a[120:123], v[72:75]
  ds_read_b64_tr_b16 a[212:213], v18 offset:18432
  v_mul_f32 v31, v63, v164
  v_cvt_pk_f16_f32 v146, v28, v29
  v_cvt_pk_f16_f32 v147, v30, v31
  v_mfma_f32_16x16x32_bf16 v[76:79], a[220:223], a[124:127], v[76:79]
  ds_read_b64_tr_b16 a[214:215], v18 offset:22528
  buffer_store_dwordx4 v[144:147], v25, s[32:35], 0 offen offset:1024 sc1
  s_waitcnt lgkmcnt(12)
  v_mfma_f32_16x16x32_bf16 v[72:75], a[224:227], a[0:3], v[72:75]
  ds_read_b64_tr_b16 a[216:217], v18 offset:26624
  v_mfma_f32_16x16x32_bf16 v[76:79], a[224:227], a[4:7], v[76:79]
  ds_read_b64_tr_b16 a[218:219], v18 offset:30720
  s_waitcnt lgkmcnt(12)
  v_mfma_f32_16x16x32_bf16 v[72:75], a[192:195], a[8:11], v[72:75]
  v_add_u32 v11, 0x9000, v18
  ds_read_b64_tr_b16 a[220:221], v11 offset:0
  v_mfma_f32_16x16x32_bf16 v[76:79], a[192:195], a[12:15], v[76:79]
  ds_read_b64_tr_b16 a[222:223], v11 offset:4096
  s_waitcnt lgkmcnt(12)
  v_mfma_f32_16x16x32_bf16 v[72:75], a[196:199], a[16:19], v[72:75]
  ds_read_b64_tr_b16 a[224:225], v11 offset:8192
  v_mfma_f32_16x16x32_bf16 v[76:79], a[196:199], a[20:23], v[76:79]
  ds_read_b64_tr_b16 a[226:227], v11 offset:12288
  s_waitcnt lgkmcnt(12)
  v_mfma_f32_16x16x32_bf16 v[72:75], a[200:203], a[24:27], v[72:75]
  ds_read_b64_tr_b16 a[192:193], v11 offset:18432
  v_mfma_f32_16x16x32_bf16 v[76:79], a[200:203], a[28:31], v[76:79]
  ds_read_b64_tr_b16 a[194:195], v11 offset:22528
  s_waitcnt lgkmcnt(12)
  v_mfma_f32_16x16x32_bf16 v[80:83], a[204:207], a[96:99], v[80:83]
  ds_read_b64_tr_b16 a[196:197], v11 offset:26624
  v_mfma_f32_16x16x32_bf16 v[84:87], a[204:207], a[100:103], v[84:87]
  ds_read_b64_tr_b16 a[198:199], v11 offset:30720
  s_waitcnt lgkmcnt(12)
  v_mfma_f32_16x16x32_bf16 v[80:83], a[208:211], a[104:107], v[80:83]
  ds_read_b64_tr_b16 a[200:201], v19 offset:0
  v_mfma_f32_16x16x32_bf16 v[84:87], a[208:211], a[108:111], v[84:87]
  ds_read_b64_tr_b16 a[202:203], v19 offset:4096
  s_waitcnt lgkmcnt(12)
  v_mfma_f32_16x16x32_bf16 v[80:83], a[212:215], a[112:115], v[80:83]
  ds_read_b64_tr_b16 a[204:205], v19 offset:8192
  v_mfma_f32_16x16x32_bf16 v[84:87], a[212:215], a[116:119], v[84:87]
  ds_read_b64_tr_b16 a[206:207], v19 offset:12288
  s_waitcnt lgkmcnt(12)
  v_mfma_f32_16x16x32_bf16 v[80:83], a[216:219], a[120:123], v[80:83]
  ds_read_b64_tr_b16 a[208:209], v19 offset:18432
  ds_write_b128 v22, v[64:67] offset:4096
  ds_write_b128 v22, v[72:75] offset:5120
  v_max3_f32 v27, |v64|, |v65|, |v66|
  v_mfma_f32_16x16x32_bf16 v[84:87], a[216:219], a[124:127], v[84:87]
  ds_read_b64_tr_b16 a[210:211], v19 offset:22528
  v_max_f32 v27, |v67|, v27
  v_max3_f32 v27, |v72|, |v73|, v27
  v_max3_f32 v27, |v74|, |v75|, v27
  s_waitcnt lgkmcnt(12)
  v_mfma_f32_16x16x32_bf16 v[80:83], a[220:223], a[0:3], v[80:83]
  ds_read_b64_tr_b16 a[212:213], v19 offset:26624
  v_frexp_exp_i32_f32 v27, v27
  v_max_i32 v27, 0xffffff9c, v27
  v_sub_u32 v164, 15, v27
  v_mfma_f32_16x16x32_bf16 v[84:87], a[220:223], a[4:7], v[84:87]
  ds_read_b64_tr_b16 a[214:215], v19 offset:30720
  v_add_u32 v165, -15, v27
  v_ldexp_f32 v164, 1.0, v164
  v_ldexp_f32 v165, 1.0, v165
  s_waitcnt lgkmcnt(12)
  v_mfma_f32_16x16x32_bf16 v[80:83], a[224:227], a[8:11], v[80:83]
  v_add_u32 v0, 0x9000, v19
  ds_read_b64_tr_b16 a[216:217], v0 offset:0
  buffer_store_dword v165, v26, s[32:35], 0 offen offset:512 sc1
  v_mul_f32 v28, v64, v164
  v_mul_f32 v29, v65, v164
  v_mfma_f32_16x16x32_bf16 v[84:87], a[224:227], a[12:15], v[84:87]
  ds_read_b64_tr_b16 a[218:219], v0 offset:4096
  v_mul_f32 v30, v66, v164
  v_mul_f32 v31, v67, v164
  v_cvt_pk_f16_f32 v128, v28, v29
  s_waitcnt lgkmcnt(12)
  v_mfma_f32_16x16x32_bf16 v[80:83], a[192:195], a[16:19], v[80:83]
  ds_read_b64_tr_b16 a[220:221], v0 offset:8192
  v_cvt_pk_f16_f32 v129, v30, v31
  v_mul_f32 v28, v72, v164
  v_mul_f32 v29, v73, v164
  v_mfma_f32_16x16x32_bf16 v[84:87], a[192:195], a[20:23], v[84:87]
  ds_read_b64_tr_b16 a[222:223], v0 offset:12288
  v_mul_f32 v30, v74, v164
  v_mul_f32 v31, v75, v164
  v_cvt_pk_f16_f32 v130, v28, v29
  s_waitcnt lgkmcnt(12)
  v_mfma_f32_16x16x32_bf16 v[80:83], a[196:199], a[24:27], v[80:83]
  ds_read_b64_tr_b16 a[224:225], v0 offset:18432
  v_cvt_pk_f16_f32 v131, v30, v31
  buffer_store_dwordx4 v[128:131], v24, s[32:35], 0 offen offset:2048 sc1
  ds_write_b128 v22, v[68:71] offset:14336
  v_mfma_f32_16x16x32_bf16 v[84:87], a[196:199], a[28:31], v[84:87]
  ds_read_b64_tr_b16 a[226:227], v0 offset:22528
  ds_write_b128 v22, v[76:79] offset:15360
  v_max3_f32 v27, |v68|, |v69|, |v70|
  v_max_f32 v27, |v71|, v27
  s_waitcnt lgkmcnt(12)
  v_mfma_f32_16x16x32_bf16 v[88:91], a[200:203], a[96:99], v[88:91]
  ds_read_b64_tr_b16 a[192:193], v0 offset:26624
  v_max3_f32 v27, |v76|, |v77|, v27
  v_max3_f32 v27, |v78|, |v79|, v27
  v_frexp_exp_i32_f32 v27, v27
  v_mfma_f32_16x16x32_bf16 v[92:95], a[200:203], a[100:103], v[92:95]
  ds_read_b64_tr_b16 a[194:195], v0 offset:30720
  v_max_i32 v27, 0xffffff9c, v27
  v_sub_u32 v166, 15, v27
  v_add_u32 v167, -15, v27
  s_waitcnt lgkmcnt(12)
  v_mfma_f32_16x16x32_bf16 v[88:91], a[204:207], a[104:107], v[88:91]
  ds_read_b64_tr_b16 a[196:197], v20 offset:0
  v_ldexp_f32 v166, 1.0, v166
  v_ldexp_f32 v167, 1.0, v167
  buffer_store_dword v167, v26, s[32:35], 0 offen offset:1792 sc1
  v_mfma_f32_16x16x32_bf16 v[92:95], a[204:207], a[108:111], v[92:95]
  ds_read_b64_tr_b16 a[198:199], v20 offset:512
  v_mul_f32 v28, v68, v166
  v_mul_f32 v29, v69, v166
  v_mul_f32 v30, v70, v166
  s_waitcnt lgkmcnt(12)
  v_mfma_f32_16x16x32_bf16 v[88:91], a[208:211], a[112:115], v[88:91]
  ds_read_b64_tr_b16 a[200:201], v20 offset:1024
  v_mul_f32 v31, v71, v166
  v_cvt_pk_f16_f32 v148, v28, v29
  v_cvt_pk_f16_f32 v149, v30, v31
  v_mfma_f32_16x16x32_bf16 v[92:95], a[208:211], a[116:119], v[92:95]
  ds_read_b64_tr_b16 a[202:203], v20 offset:1536
  v_mul_f32 v28, v76, v166
  v_mul_f32 v29, v77, v166
  v_mul_f32 v30, v78, v166
  s_waitcnt lgkmcnt(12)
  v_mfma_f32_16x16x32_bf16 v[88:91], a[212:215], a[120:123], v[88:91]
  ds_read_b64_tr_b16 a[204:205], v20 offset:18432
  v_mul_f32 v31, v79, v166
  v_cvt_pk_f16_f32 v150, v28, v29
  v_cvt_pk_f16_f32 v151, v30, v31
  v_mfma_f32_16x16x32_bf16 v[92:95], a[212:215], a[124:127], v[92:95]
  ds_read_b64_tr_b16 a[206:207], v20 offset:18944
  buffer_store_dwordx4 v[148:151], v25, s[32:35], 0 offen offset:2048 sc1
  s_waitcnt lgkmcnt(12)
  v_mfma_f32_16x16x32_bf16 v[88:91], a[216:219], a[0:3], v[88:91]
  ds_read_b64_tr_b16 a[208:209], v20 offset:19456
  v_mfma_f32_16x16x32_bf16 v[92:95], a[216:219], a[4:7], v[92:95]
  ds_read_b64_tr_b16 a[210:211], v20 offset:19968
  s_waitcnt lgkmcnt(12)
  v_mfma_f32_16x16x32_bf16 v[88:91], a[220:223], a[8:11], v[88:91]
  v_add_u32 v11, 0x9000, v20
  ds_read_b64_tr_b16 a[212:213], v11 offset:0
  v_mfma_f32_16x16x32_bf16 v[92:95], a[220:223], a[12:15], v[92:95]
  ds_read_b64_tr_b16 a[214:215], v11 offset:512
  s_waitcnt lgkmcnt(12)
  v_mfma_f32_16x16x32_bf16 v[88:91], a[224:227], a[16:19], v[88:91]
  ds_read_b64_tr_b16 a[216:217], v11 offset:1024
  v_mfma_f32_16x16x32_bf16 v[92:95], a[224:227], a[20:23], v[92:95]
  ds_read_b64_tr_b16 a[218:219], v11 offset:1536
  s_waitcnt lgkmcnt(12)
  v_mfma_f32_16x16x32_bf16 v[88:91], a[192:195], a[24:27], v[88:91]
  ds_read_b64_tr_b16 a[220:221], v11 offset:18432
  v_mfma_f32_16x16x32_bf16 v[92:95], a[192:195], a[28:31], v[92:95]
  ds_read_b64_tr_b16 a[222:223], v11 offset:18944
  s_waitcnt lgkmcnt(12)
  v_mfma_f32_16x16x32_bf16 v[96:99], a[196:199], a[96:99], v[96:99]
  ds_read_b64_tr_b16 a[224:225], v11 offset:19456
  v_mfma_f32_16x16x32_bf16 v[100:103], a[196:199], a[100:103], v[100:103]
  ds_read_b64_tr_b16 a[226:227], v11 offset:19968
  s_waitcnt lgkmcnt(12)
  v_mfma_f32_16x16x32_bf16 v[96:99], a[200:203], a[104:107], v[96:99]
  v_mfma_f32_16x16x32_bf16 v[100:103], a[200:203], a[108:111], v[100:103]
  s_waitcnt lgkmcnt(10)
  v_mfma_f32_16x16x32_bf16 v[96:99], a[204:207], a[112:115], v[96:99]
  v_mfma_f32_16x16x32_bf16 v[100:103], a[204:207], a[116:119], v[100:103]
  s_waitcnt lgkmcnt(8)
  v_mfma_f32_16x16x32_bf16 v[96:99], a[208:211], a[120:123], v[96:99]
  ds_write_b128 v22, v[80:83] offset:6144
  ds_write_b128 v22, v[88:91] offset:7168
  v_max3_f32 v27, |v80|, |v81|, |v82|
  v_mfma_f32_16x16x32_bf16 v[100:103], a[208:211], a[124:127], v[100:103]
  v_max_f32 v27, |v83|, v27
  v_max3_f32 v27, |v88|, |v89|, v27
  v_max3_f32 v27, |v90|, |v91|, v27
  s_waitcnt lgkmcnt(6)
  v_mfma_f32_16x16x32_bf16 v[96:99], a[212:215], a[0:3], v[96:99]
  v_frexp_exp_i32_f32 v27, v27
  v_max_i32 v27, 0xffffff9c, v27
  v_sub_u32 v166, 15, v27
  v_mfma_f32_16x16x32_bf16 v[100:103], a[212:215], a[4:7], v[100:103]
  v_add_u32 v167, -15, v27
  v_ldexp_f32 v166, 1.0, v166
  v_ldexp_f32 v167, 1.0, v167
  s_waitcnt lgkmcnt(4)
  v_mfma_f32_16x16x32_bf16 v[96:99], a[216:219], a[8:11], v[96:99]
  buffer_store_dword v167, v26, s[32:35], 0 offen offset:768 sc1
  v_mul_f32 v28, v80, v166
  v_mul_f32 v29, v81, v166
  v_mfma_f32_16x16x32_bf16 v[100:103], a[216:219], a[12:15], v[100:103]
  v_mul_f32 v30, v82, v166
  v_mul_f32 v31, v83, v166
  v_cvt_pk_f16_f32 v132, v28, v29
  s_waitcnt lgkmcnt(2)
  v_mfma_f32_16x16x32_bf16 v[96:99], a[220:223], a[16:19], v[96:99]
  v_cvt_pk_f16_f32 v133, v30, v31
  v_mul_f32 v28, v88, v166
  v_mul_f32 v29, v89, v166
  v_mfma_f32_16x16x32_bf16 v[100:103], a[220:223], a[20:23], v[100:103]
  v_mul_f32 v30, v90, v166
  v_mul_f32 v31, v91, v166
  v_cvt_pk_f16_f32 v134, v28, v29
  s_waitcnt lgkmcnt(0)
  v_mfma_f32_16x16x32_bf16 v[96:99], a[224:227], a[24:27], v[96:99]
  v_cvt_pk_f16_f32 v135, v30, v31
  buffer_store_dwordx4 v[132:135], v24, s[32:35], 0 offen offset:3072 sc1
  ds_write_b128 v22, v[84:87] offset:16384
  v_mfma_f32_16x16x32_bf16 v[100:103], a[224:227], a[28:31], v[100:103]
  ds_write_b128 v22, v[92:95] offset:17408
  v_max3_f32 v27, |v84|, |v85|, |v86|
  v_max_f32 v27, |v87|, v27
  s_nop 7
  s_nop 3
  v_max3_f32 v27, |v92|, |v93|, v27
  v_max3_f32 v27, |v94|, |v95|, v27
  v_frexp_exp_i32_f32 v27, v27
  v_max_i32 v27, 0xffffff9c, v27
  v_sub_u32 v160, 15, v27
  v_add_u32 v161, -15, v27
  v_ldexp_f32 v160, 1.0, v160
  v_ldexp_f32 v161, 1.0, v161
  buffer_store_dword v161, v26, s[32:35], 0 offen offset:2048 sc1
  v_mul_f32 v28, v84, v160
  v_mul_f32 v29, v85, v160
  v_mul_f32 v30, v86, v160
  v_mul_f32 v31, v87, v160
  v_cvt_pk_f16_f32 v152, v28, v29
  v_cvt_pk_f16_f32 v153, v30, v31
  v_mul_f32 v28, v92, v160
  v_mul_f32 v29, v93, v160
  v_mul_f32 v30, v94, v160
  v_mul_f32 v31, v95, v160
  v_cvt_pk_f16_f32 v154, v28, v29
  v_cvt_pk_f16_f32 v155, v30, v31
  buffer_store_dwordx4 v[152:155], v25, s[32:35], 0 offen offset:3072 sc1
  ds_write_b128 v22, v[96:99] offset:8192
  v_max3_f32 v27, |v96|, |v97|, |v98|
  v_max_f32 v27, |v99|, v27
  v_frexp_exp_i32_f32 v27, v27
  v_max_i32 v27, 0xffffff9c, v27
  v_sub_u32 v160, 15, v27
  v_add_u32 v161, -15, v27
  v_ldexp_f32 v160, 1.0, v160
  v_ldexp_f32 v161, 1.0, v161
  buffer_store_dword v161, v26, s[32:35], 0 offen offset:1024 sc1
  v_mul_f32 v28, v96, v160
  v_mul_f32 v29, v97, v160
  v_mul_f32 v30, v98, v160
  v_mul_f32 v31, v99, v160
  v_cvt_pk_f16_f32 v136, v28, v29
  v_cvt_pk_f16_f32 v137, v30, v31
  buffer_store_dwordx4 v[136:139], v24, s[32:35], s38 offen offset:0 sc1
  ds_write_b128 v22, v[100:103] offset:18432
  v_max3_f32 v27, |v100|, |v101|, |v102|
  v_max_f32 v27, |v103|, v27
  v_frexp_exp_i32_f32 v27, v27
  v_max_i32 v27, 0xffffff9c, v27
  v_sub_u32 v162, 15, v27
  v_add_u32 v163, -15, v27
  v_ldexp_f32 v162, 1.0, v162
  v_ldexp_f32 v163, 1.0, v163
  buffer_store_dword v163, v26, s[32:35], 0 offen offset:2304 sc1
  v_mul_f32 v28, v100, v162
  v_mul_f32 v29, v101, v162
  v_mul_f32 v30, v102, v162
  v_mul_f32 v31, v103, v162
  v_cvt_pk_f16_f32 v156, v28, v29
  v_cvt_pk_f16_f32 v157, v30, v31
  buffer_store_dwordx4 v[156:159], v25, s[32:35], s38 offen offset:0 sc1
  s_lshl_b32 s37, s67, 2
  s_add_u32 s37, s37, s62
  s_lshl_b32 s37, s37, 2
  s_add_u32 s37, s37, 6144
  v_mov_b32 v20, v2
  s_waitcnt vmcnt(0) lgkmcnt(0)
  s_barrier
  s_cmp_lg_u32 s18, 0
  s_cbranch_scc1 mega_kernel_pubskip59
  s_mov_b64 exec, 1
  v_mul_u32_u24 v2, 8960, v1
  v_add_u32 v2, s37, v2
  v_mov_b32 v3, s3
  global_store_dword v2, v3, s[12:13] sc1
  s_mov_b64 exec, -1
mega_kernel_pubskip59:
  s_load_dwordx2 s[4:5], s[0:1], 96
  s_mov_b32 s34, 13107200
  s_mov_b32 s36, 0
mega_kernel_poll557:
  s_add_u32 s36, s36, 1
  v_cmp_ne_u32 vcc, s3, v23
  s_cmp_ge_u32 s36, 1048576
  s_cbranch_scc1 mega_kernel_pdone558
  s_cbranch_vccz mega_kernel_pdone558
  s_sleep 2
  global_load_dword v23, v20, s[12:13] sc1
  s_waitcnt vmcnt(0)
  s_branch mega_kernel_poll557
mega_kernel_pdone558:
  buffer_load_dwordx2 v[168:169], v4, s[56:59], s48 offen sc1
  buffer_load_dwordx2 v[170:171], v4, s[56:59], s49 offen sc1
  buffer_load_dwordx4 v[172:175], v5, s[24:27], s50 offen sc1
  buffer_load_dwordx4 v[176:179], v5, s[24:27], s50 offen offset:64 sc1
  buffer_load_dwordx2 v[180:181], v4, s[56:59], s51 offen sc1
  buffer_load_dwordx2 v[182:183], v4, s[56:59], s52 offen sc1
  buffer_load_dwordx4 v[184:187], v5, s[24:27], s54 offen sc1
  buffer_load_dwordx4 v[188:191], v5, s[24:27], s54 offen offset:64 sc1
  buffer_load_dwordx2 v[192:193], v4, s[56:59], s14 offen sc1
  buffer_load_dwordx2 v[194:195], v4, s[56:59], s15 offen sc1
  buffer_load_dwordx4 v[196:199], v5, s[24:27], s47 offen sc1
  buffer_load_dwordx4 v[200:203], v5, s[24:27], s47 offen offset:64 sc1
  s_add_u32 s36, s18, 0
  s_min_u32 s36, s36, 9
  s_lshl_b32 s36, s36, 11
  v_add_u32 v8, s36, v21
  ds_read_b128 v[44:47], v8
  ds_read_b128 v[48:51], v8 offset:1024
  s_add_u32 s36, s18, 4
  s_min_u32 s36, s36, 9
  s_lshl_b32 s36, s36, 11
  v_add_u32 v8, s36, v21
  ds_read_b128 v[84:87], v8
  ds_read_b128 v[88:91], v8 offset:1024
  s_add_u32 s36, s18, 8
  s_min_u32 s36, s36, 9
  s_lshl_b32 s36, s36, 11
  v_add_u32 v8, s36, v21
  ds_read_b128 v[124:127], v8
  ds_read_b128 v[128:131], v8 offset:1024
  s_lshl_b32 s37, s67, 4
  s_add_u32 s37, s37, 6144
  s_cmp_lg_u32 s18, 0
  s_cbranch_scc1 mega_kernel_wskip60
  v_min_u32 v2, 0, v1
  v_lshlrev_b32 v2, 4, v2
  v_add_u32 v2, s37, v2
  s_and_b32 s36, s2, 31
  s_mul_i32 s36, s36, 0
  v_add_u32 v2, s36, v2
  s_mov_b32 s36, 0
mega_kernel_poll61:
  global_load_dwordx4 v[28:31], v2, s[12:13] sc1
  s_add_u32 s36, s36, 1
  s_waitcnt vmcnt(0)
  v_xor_b32 v28, s3, v28
  v_xor_b32 v29, s3, v29
  v_xor_b32 v30, s3, v30
  v_xor_b32 v31, s3, v31
  v_or3_b32 v28, v28, v29, v30
  v_or_b32 v28, v28, v31
  v_cmp_ne_u32 vcc, 0, v28
  s_cmp_ge_u32 s36, 1048576
  s_cbranch_scc1 mega_kernel_pdone62
  s_cbranch_vccz mega_kernel_pdone62
  s_sleep 1
  s_branch mega_kernel_poll61
mega_kernel_pdone62:
mega_kernel_wskip60:
  s_barrier
  s_waitcnt lgkmcnt(0)
  s_mov_b32 s28, s4
  s_mov_b32 s29, s5
  s_mov_b32 s30, 2359296
  s_mov_b32 s31, 0x00020000
  s_add_u32 s36, s18, 0
  s_min_u32 s36, s36, 9
  s_lshl_b32 s39, s36, 10
  s_lshl_b32 s42, s36, 8
  s_add_u32 s41, s39, s44
  buffer_load_dwordx4 v[32:35], v6, s[32:35], s41 offen sc1
  s_add_u32 s41, s42, s44
  buffer_load_dword v52, v7, s[32:35], s41 offen sc1
  s_add_u32 s41, s39, s45
  buffer_load_dwordx4 v[36:39], v6, s[32:35], s41 offen sc1
  s_add_u32 s41, s42, s45
  buffer_load_dword v53, v7, s[32:35], s41 offen sc1
  s_add_u32 s41, s39, s46
  buffer_load_dwordx4 v[40:43], v6, s[32:35], s41 offen sc1
  s_add_u32 s41, s42, s46
  buffer_load_dword v54, v7, s[32:35], s41 offen sc1
  s_add_u32 s36, s18, 4
  s_min_u32 s36, s36, 9
  s_lshl_b32 s39, s36, 10
  s_lshl_b32 s42, s36, 8
  s_add_u32 s41, s39, s44
  buffer_load_dwordx4 v[72:75], v6, s[32:35], s41 offen sc1
  s_add_u32 s41, s42, s44
  buffer_load_dword v92, v7, s[32:35], s41 offen sc1
  s_add_u32 s41, s39, s45
  buffer_load_dwordx4 v[76:79], v6, s[32:35], s41 offen sc1
  s_add_u32 s41, s42, s45
  buffer_load_dword v93, v7, s[32:35], s41 offen sc1
  s_add_u32 s41, s39, s46
  buffer_load_dwordx4 v[80:83], v6, s[32:35], s41 offen sc1
  s_add_u32 s41, s42, s46
  buffer_load_dword v94, v7, s[32:35], s41 offen sc1
  s_add_u32 s36, s18, 8
  s_min_u32 s36, s36, 9
  s_lshl_b32 s39, s36, 10
  s_lshl_b32 s42, s36, 8
  s_add_u32 s41, s39, s44
  buffer_load_dwordx4 v[112:115], v6, s[32:35], s41 offen sc1
  s_add_u32 s41, s42, s44
  buffer_load_dword v132, v7, s[32:35], s41 offen sc1
  s_add_u32 s41, s39, s45
  buffer_load_dwordx4 v[116:119], v6, s[32:35], s41 offen sc1
  s_add_u32 s41, s42, s45
  buffer_load_dword v133, v7, s[32:35], s41 offen sc1
  s_add_u32 s41, s39, s46
  buffer_load_dwordx4 v[120:123], v6, s[32:35], s41 offen sc1
  s_add_u32 s41, s42, s46
  buffer_load_dword v134, v7, s[32:35], s41 offen sc1
  s_waitcnt vmcnt(12)
  v_fma_mix_f32 v44, v32, v52, v44 op_sel:[0,0,0] op_sel_hi:[1,0,0]
  v_fma_mix_f32 v45, v32, v52, v45 op_sel:[1,0,0] op_sel_hi:[1,0,0]
  v_fma_mix_f32 v46, v33, v52, v46 op_sel:[0,0,0] op_sel_hi:[1,0,0]
  v_fma_mix_f32 v47, v33, v52, v47 op_sel:[1,0,0] op_sel_hi:[1,0,0]
  v_fma_mix_f32 v48, v34, v52, v48 op_sel:[0,0,0] op_sel_hi:[1,0,0]
  v_fma_mix_f32 v49, v34, v52, v49 op_sel:[1,0,0] op_sel_hi:[1,0,0]
  v_fma_mix_f32 v50, v35, v52, v50 op_sel:[0,0,0] op_sel_hi:[1,0,0]
  v_fma_mix_f32 v51, v35, v52, v51 op_sel:[1,0,0] op_sel_hi:[1,0,0]
  v_fma_mix_f32 v44, v36, v53, v44 op_sel:[0,0,0] op_sel_hi:[1,0,0]
  v_fma_mix_f32 v45, v36, v53, v45 op_sel:[1,0,0] op_sel_hi:[1,0,0]
  v_fma_mix_f32 v46, v37, v53, v46 op_sel:[0,0,0] op_sel_hi:[1,0,0]
  v_fma_mix_f32 v47, v37, v53, v47 op_sel:[1,0,0] op_sel_hi:[1,0,0]
  v_fma_mix_f32 v48, v38, v53, v48 op_sel:[0,0,0] op_sel_hi:[1,0,0]
  v_fma_mix_f32 v49, v38, v53, v49 op_sel:[1,0,0] op_sel_hi:[1,0,0]
  v_fma_mix_f32 v50, v39, v53, v50 op_sel:[0,0,0] op_sel_hi:[1,0,0]
  v_fma_mix_f32 v51, v39, v53, v51 op_sel:[1,0,0] op_sel_hi:[1,0,0]
  v_fma_mix_f32 v44, v40, v54, v44 op_sel:[0,0,0] op_sel_hi:[1,0,0]
  v_fma_mix_f32 v45, v40, v54, v45 op_sel:[1,0,0] op_sel_hi:[1,0,0]
  v_fma_mix_f32 v46, v41, v54, v46 op_sel:[0,0,0] op_sel_hi:[1,0,0]
  v_fma_mix_f32 v47, v41, v54, v47 op_sel:[1,0,0] op_sel_hi:[1,0,0]
  v_fma_mix_f32 v48, v42, v54, v48 op_sel:[0,0,0] op_sel_hi:[1,0,0]
  v_fma_mix_f32 v49, v42, v54, v49 op_sel:[1,0,0] op_sel_hi:[1,0,0]
  v_fma_mix_f32 v50, v43, v54, v50 op_sel:[0,0,0] op_sel_hi:[1,0,0]
  v_fma_mix_f32 v51, v43, v54, v51 op_sel:[1,0,0] op_sel_hi:[1,0,0]
  v_cvt_pk_bf16_f32 v64, v44, v45
  v_lshlrev_b32 v44, 16, v64
  v_and_b32 v45, s40, v64
  v_cvt_pk_bf16_f32 v65, v46, v47
  v_lshlrev_b32 v46, 16, v65
  v_and_b32 v47, s40, v65
  v_cvt_pk_bf16_f32 v66, v48, v49
  v_lshlrev_b32 v48, 16, v66
  v_and_b32 v49, s40, v66
  v_cvt_pk_bf16_f32 v67, v50, v51
  v_lshlrev_b32 v50, 16, v67
  v_and_b32 v51, s40, v67
  v_pk_mul_f32 v[44:45], v[44:45], v[172:173]
  v_pk_mul_f32 v[46:47], v[46:47], v[174:175]
  v_pk_mul_f32 v[48:49], v[48:49], v[176:177]
  v_pk_mul_f32 v[50:51], v[50:51], v[178:179]
  v_cvt_pk_bf16_f32 v64, v44, v45
  v_lshlrev_b32 v44, 16, v64
  v_and_b32 v45, s40, v64
  v_cvt_pk_bf16_f32 v65, v46, v47
  v_lshlrev_b32 v46, 16, v65
  v_and_b32 v47, s40, v65
  v_cvt_pk_bf16_f32 v66, v48, v49
  v_lshlrev_b32 v48, 16, v66
  v_and_b32 v49, s40, v66
  v_cvt_pk_bf16_f32 v67, v50, v51
  v_lshlrev_b32 v50, 16, v67
  v_and_b32 v51, s40, v67
  v_lshlrev_b32 v32, 16, v168
  v_and_b32 v33, s40, v168
  v_pk_add_f32 v[44:45], v[44:45], v[32:33]
  v_cvt_pk_bf16_f32 v64, v44, v45
  v_lshlrev_b32 v34, 16, v169
  v_and_b32 v35, s40, v169
  v_pk_add_f32 v[46:47], v[46:47], v[34:35]
  v_cvt_pk_bf16_f32 v65, v46, v47
  v_lshlrev_b32 v36, 16, v170
  v_and_b32 v37, s40, v170
  v_pk_add_f32 v[48:49], v[48:49], v[36:37]
  v_cvt_pk_bf16_f32 v66, v48, v49
  v_lshlrev_b32 v38, 16, v171
  v_and_b32 v39, s40, v171
  v_pk_add_f32 v[50:51], v[50:51], v[38:39]
  v_cvt_pk_bf16_f32 v67, v50, v51
  buffer_store_dwordx2 v[64:65], v4, s[28:31], s48 offen
  buffer_store_dwordx2 v[66:67], v4, s[28:31], s49 offen
  s_waitcnt vmcnt(8)
  v_fma_mix_f32 v84, v72, v92, v84 op_sel:[0,0,0] op_sel_hi:[1,0,0]
  v_fma_mix_f32 v85, v72, v92, v85 op_sel:[1,0,0] op_sel_hi:[1,0,0]
  v_fma_mix_f32 v86, v73, v92, v86 op_sel:[0,0,0] op_sel_hi:[1,0,0]
  v_fma_mix_f32 v87, v73, v92, v87 op_sel:[1,0,0] op_sel_hi:[1,0,0]
  v_fma_mix_f32 v88, v74, v92, v88 op_sel:[0,0,0] op_sel_hi:[1,0,0]
  v_fma_mix_f32 v89, v74, v92, v89 op_sel:[1,0,0] op_sel_hi:[1,0,0]
  v_fma_mix_f32 v90, v75, v92, v90 op_sel:[0,0,0] op_sel_hi:[1,0,0]
  v_fma_mix_f32 v91, v75, v92, v91 op_sel:[1,0,0] op_sel_hi:[1,0,0]
  v_fma_mix_f32 v84, v76, v93, v84 op_sel:[0,0,0] op_sel_hi:[1,0,0]
  v_fma_mix_f32 v85, v76, v93, v85 op_sel:[1,0,0] op_sel_hi:[1,0,0]
  v_fma_mix_f32 v86, v77, v93, v86 op_sel:[0,0,0] op_sel_hi:[1,0,0]
  v_fma_mix_f32 v87, v77, v93, v87 op_sel:[1,0,0] op_sel_hi:[1,0,0]
  v_fma_mix_f32 v88, v78, v93, v88 op_sel:[0,0,0] op_sel_hi:[1,0,0]
  v_fma_mix_f32 v89, v78, v93, v89 op_sel:[1,0,0] op_sel_hi:[1,0,0]
  v_fma_mix_f32 v90, v79, v93, v90 op_sel:[0,0,0] op_sel_hi:[1,0,0]
  v_fma_mix_f32 v91, v79, v93, v91 op_sel:[1,0,0] op_sel_hi:[1,0,0]
  v_fma_mix_f32 v84, v80, v94, v84 op_sel:[0,0,0] op_sel_hi:[1,0,0]
  v_fma_mix_f32 v85, v80, v94, v85 op_sel:[1,0,0] op_sel_hi:[1,0,0]
  v_fma_mix_f32 v86, v81, v94, v86 op_sel:[0,0,0] op_sel_hi:[1,0,0]
  v_fma_mix_f32 v87, v81, v94, v87 op_sel:[1,0,0] op_sel_hi:[1,0,0]
  v_fma_mix_f32 v88, v82, v94, v88 op_sel:[0,0,0] op_sel_hi:[1,0,0]
  v_fma_mix_f32 v89, v82, v94, v89 op_sel:[1,0,0] op_sel_hi:[1,0,0]
  v_fma_mix_f32 v90, v83, v94, v90 op_sel:[0,0,0] op_sel_hi:[1,0,0]
  v_fma_mix_f32 v91, v83, v94, v91 op_sel:[1,0,0] op_sel_hi:[1,0,0]
  v_cvt_pk_bf16_f32 v104, v84, v85
  v_lshlrev_b32 v84, 16, v104
  v_and_b32 v85, s40, v104
  v_cvt_pk_bf16_f32 v105, v86, v87
  v_lshlrev_b32 v86, 16, v105
  v_and_b32 v87, s40, v105
  v_cvt_pk_bf16_f32 v106, v88, v89
  v_lshlrev_b32 v88, 16, v106
  v_and_b32 v89, s40, v106
  v_cvt_pk_bf16_f32 v107, v90, v91
  v_lshlrev_b32 v90, 16, v107
  v_and_b32 v91, s40, v107
  v_pk_mul_f32 v[84:85], v[84:85], v[184:185]
  v_pk_mul_f32 v[86:87], v[86:87], v[186:187]
  v_pk_mul_f32 v[88:89], v[88:89], v[188:189]
  v_pk_mul_f32 v[90:91], v[90:91], v[190:191]
  v_cvt_pk_bf16_f32 v104, v84, v85
  v_lshlrev_b32 v84, 16, v104
  v_and_b32 v85, s40, v104
  v_cvt_pk_bf16_f32 v105, v86, v87
  v_lshlrev_b32 v86, 16, v105
  v_and_b32 v87, s40, v105
  v_cvt_pk_bf16_f32 v106, v88, v89
  v_lshlrev_b32 v88, 16, v106
  v_and_b32 v89, s40, v106
  v_cvt_pk_bf16_f32 v107, v90, v91
  v_lshlrev_b32 v90, 16, v107
  v_and_b32 v91, s40, v107
  v_lshlrev_b32 v72, 16, v180
  v_and_b32 v73, s40, v180
  v_pk_add_f32 v[84:85], v[84:85], v[72:73]
  v_cvt_pk_bf16_f32 v104, v84, v85
  v_lshlrev_b32 v74, 16, v181
  v_and_b32 v75, s40, v181
  v_pk_add_f32 v[86:87], v[86:87], v[74:75]
  v_cvt_pk_bf16_f32 v105, v86, v87
  v_lshlrev_b32 v76, 16, v182
  v_and_b32 v77, s40, v182
  v_pk_add_f32 v[88:89], v[88:89], v[76:77]
  v_cvt_pk_bf16_f32 v106, v88, v89
  v_lshlrev_b32 v78, 16, v183
  v_and_b32 v79, s40, v183
  v_pk_add_f32 v[90:91], v[90:91], v[78:79]
  v_cvt_pk_bf16_f32 v107, v90, v91
  buffer_store_dwordx2 v[104:105], v4, s[28:31], s51 offen
  buffer_store_dwordx2 v[106:107], v4, s[28:31], s52 offen
  s_waitcnt vmcnt(4)
  v_fma_mix_f32 v124, v112, v132, v124 op_sel:[0,0,0] op_sel_hi:[1,0,0]
  v_fma_mix_f32 v125, v112, v132, v125 op_sel:[1,0,0] op_sel_hi:[1,0,0]
  v_fma_mix_f32 v126, v113, v132, v126 op_sel:[0,0,0] op_sel_hi:[1,0,0]
  v_fma_mix_f32 v127, v113, v132, v127 op_sel:[1,0,0] op_sel_hi:[1,0,0]
  v_fma_mix_f32 v128, v114, v132, v128 op_sel:[0,0,0] op_sel_hi:[1,0,0]
  v_fma_mix_f32 v129, v114, v132, v129 op_sel:[1,0,0] op_sel_hi:[1,0,0]
  v_fma_mix_f32 v130, v115, v132, v130 op_sel:[0,0,0] op_sel_hi:[1,0,0]
  v_fma_mix_f32 v131, v115, v132, v131 op_sel:[1,0,0] op_sel_hi:[1,0,0]
  v_fma_mix_f32 v124, v116, v133, v124 op_sel:[0,0,0] op_sel_hi:[1,0,0]
  v_fma_mix_f32 v125, v116, v133, v125 op_sel:[1,0,0] op_sel_hi:[1,0,0]
  v_fma_mix_f32 v126, v117, v133, v126 op_sel:[0,0,0] op_sel_hi:[1,0,0]
  v_fma_mix_f32 v127, v117, v133, v127 op_sel:[1,0,0] op_sel_hi:[1,0,0]
  v_fma_mix_f32 v128, v118, v133, v128 op_sel:[0,0,0] op_sel_hi:[1,0,0]
  v_fma_mix_f32 v129, v118, v133, v129 op_sel:[1,0,0] op_sel_hi:[1,0,0]
  v_fma_mix_f32 v130, v119, v133, v130 op_sel:[0,0,0] op_sel_hi:[1,0,0]
  v_fma_mix_f32 v131, v119, v133, v131 op_sel:[1,0,0] op_sel_hi:[1,0,0]
  v_fma_mix_f32 v124, v120, v134, v124 op_sel:[0,0,0] op_sel_hi:[1,0,0]
  v_fma_mix_f32 v125, v120, v134, v125 op_sel:[1,0,0] op_sel_hi:[1,0,0]
  v_fma_mix_f32 v126, v121, v134, v126 op_sel:[0,0,0] op_sel_hi:[1,0,0]
  v_fma_mix_f32 v127, v121, v134, v127 op_sel:[1,0,0] op_sel_hi:[1,0,0]
  v_fma_mix_f32 v128, v122, v134, v128 op_sel:[0,0,0] op_sel_hi:[1,0,0]
  v_fma_mix_f32 v129, v122, v134, v129 op_sel:[1,0,0] op_sel_hi:[1,0,0]
  v_fma_mix_f32 v130, v123, v134, v130 op_sel:[0,0,0] op_sel_hi:[1,0,0]
  v_fma_mix_f32 v131, v123, v134, v131 op_sel:[1,0,0] op_sel_hi:[1,0,0]
  v_cvt_pk_bf16_f32 v144, v124, v125
  v_lshlrev_b32 v124, 16, v144
  v_and_b32 v125, s40, v144
  v_cvt_pk_bf16_f32 v145, v126, v127
  v_lshlrev_b32 v126, 16, v145
  v_and_b32 v127, s40, v145
  v_cvt_pk_bf16_f32 v146, v128, v129
  v_lshlrev_b32 v128, 16, v146
  v_and_b32 v129, s40, v146
  v_cvt_pk_bf16_f32 v147, v130, v131
  v_lshlrev_b32 v130, 16, v147
  v_and_b32 v131, s40, v147
  v_pk_mul_f32 v[124:125], v[124:125], v[196:197]
  v_pk_mul_f32 v[126:127], v[126:127], v[198:199]
  v_pk_mul_f32 v[128:129], v[128:129], v[200:201]
  v_pk_mul_f32 v[130:131], v[130:131], v[202:203]
  v_cvt_pk_bf16_f32 v144, v124, v125
  v_lshlrev_b32 v124, 16, v144
  v_and_b32 v125, s40, v144
  v_cvt_pk_bf16_f32 v145, v126, v127
  v_lshlrev_b32 v126, 16, v145
  v_and_b32 v127, s40, v145
  v_cvt_pk_bf16_f32 v146, v128, v129
  v_lshlrev_b32 v128, 16, v146
  v_and_b32 v129, s40, v146
  v_cvt_pk_bf16_f32 v147, v130, v131
  v_lshlrev_b32 v130, 16, v147
  v_and_b32 v131, s40, v147
  v_lshlrev_b32 v112, 16, v192
  v_and_b32 v113, s40, v192
  v_pk_add_f32 v[124:125], v[124:125], v[112:113]
  v_cvt_pk_bf16_f32 v144, v124, v125
  v_lshlrev_b32 v114, 16, v193
  v_and_b32 v115, s40, v193
  v_pk_add_f32 v[126:127], v[126:127], v[114:115]
  v_cvt_pk_bf16_f32 v145, v126, v127
  v_lshlrev_b32 v116, 16, v194
  v_and_b32 v117, s40, v194
  v_pk_add_f32 v[128:129], v[128:129], v[116:117]
  v_cvt_pk_bf16_f32 v146, v128, v129
  v_lshlrev_b32 v118, 16, v195
  v_and_b32 v119, s40, v195
  v_pk_add_f32 v[130:131], v[130:131], v[118:119]
  v_cvt_pk_bf16_f32 v147, v130, v131
  buffer_store_dwordx2 v[144:145], v4, s[28:31], s14 offen
  buffer_store_dwordx2 v[146:147], v4, s[28:31], s15 offen
mega_kernel_exit1:
  s_endpgm
code_end:
.section .rodata,"a"
.p2align 6
desc_begin:
.p2align 6
.amdhsa_kernel mega_kernel
  .amdhsa_next_free_vgpr 488
  .amdhsa_next_free_sgpr 70
  .amdhsa_accum_offset 256
  .amdhsa_group_segment_fixed_size 0
  .amdhsa_kernarg_size 120
  .amdhsa_user_sgpr_count 2
  .amdhsa_user_sgpr_kernarg_segment_ptr 1
  .amdhsa_system_sgpr_workgroup_id_x 1
  .amdhsa_float_denorm_mode_32 3
  .amdhsa_float_denorm_mode_16_64 3
.end_amdhsa_kernel
desc_end:
```
